```python
import torch

def _softmax(x, axis=-1):
    return torch.softmax(x, dim=axis)

def _gelu(x):
    return torch.nn.functional.gelu(x, approximate='tanh')

def _silu(x):
    return torch.nn.functional.silu(x)

def _sigmoid(x):
    return torch.sigmoid(x)

def _layernorm(x, axis=-1, eps=1e-05):
    m = x.mean(dim=axis, keepdim=True)
    v = x.var(dim=axis, keepdim=True, unbiased=False)
    return (x - m) / torch.sqrt(v + eps)

def _scatter_add(tgt, idx, src, axis=0):
    return tgt.clone().index_add_(axis, idx, src)

def _segment_sum(src, seg, n):
    out = torch.zeros((n,) + src.shape[1:], dtype=src.dtype)
    return out.index_add_(0, seg, src)

def _pad(x, pw):
    flat = tuple((v for pair in reversed(pw) for v in pair))
    return torch.nn.functional.pad(x, flat)
kernel_name = 'adaLN_cond__sliding_block__glu_gated_glu__prompt'

def setup_inputs():

    _w = lambda a: (lambda t: t.to(torch.bfloat16) if t.is_floating_point() else t)(torch.as_tensor(a))

    def _A_setup():
        B, S, D = (1, 2048, 512)
        return {'x': _w((lambda *s: torch.randn(*s, dtype=torch.bfloat16) * 0.05)(B, S, D)), 'wqkv': _w((lambda *s: torch.randn(*s, dtype=torch.bfloat16) * 0.05)(D, 3 * D)), 'wo': _w((lambda *s: torch.randn(*s, dtype=torch.bfloat16) * 0.05)(D, D))}
    _A_in = _A_setup()

    def _B_setup():
        B, S, D, F = (1, 2048, 512, 1376)
        return {'x': _w((lambda *s: torch.randn(*s, dtype=torch.bfloat16) * 0.05)(B, S, D)), 'w_gate': _w((lambda *s: torch.randn(*s, dtype=torch.bfloat16) * 0.05)(D, F)), 'w_up': _w((lambda *s: torch.randn(*s, dtype=torch.bfloat16) * 0.05)(D, F)), 'w_down': _w((lambda *s: torch.randn(*s, dtype=torch.bfloat16) * 0.05)(F, D))}
    _B_in = _B_setup()
    return {'A_x': _A_in['x'], 'A_wqkv': _A_in['wqkv'], 'A_wo': _A_in['wo'], 'B_x': _B_in['x'], 'B_w_gate': _B_in['w_gate'], 'B_w_up': _B_in['w_up'], 'B_w_down': _B_in['w_down'], 'c': _w((lambda *s: torch.randn(*s, dtype=torch.bfloat16) * 0.1)(1, 512) * 8.0), 'w_mod': _w((lambda *s: torch.randn(*s, dtype=torch.bfloat16) * 0.1)(512, 6 * 512) * 512 ** (-0.5) * 8.0)}

def reference(A_x, A_wqkv, A_wo, B_x, B_w_gate, B_w_up, B_w_down, c, w_mod):

    def _A_ref(x, wqkv, wo):
        B, S, D = x.shape
        H = 32
        Dh = D // H
        W = 256
        qkv = (lambda x, *d: x.permute(*d))((x @ wqkv).reshape(B, S, 3, H, Dh), 2, 0, 3, 1, 4)
        q, k, v = (qkv[0], qkv[1], qkv[2])
        scores = torch.einsum('bhqd,bhkd->bhqk', q, k) * Dh ** (-0.5)
        idx = torch.arange(S)
        mask = (idx[:, None] - idx[None, :] >= 0) & (idx[:, None] - idx[None, :] < W)
        scores = torch.where(mask[None, None], scores, -1000000000.0)
        p = _softmax(scores, axis=-1)
        o = torch.einsum('bhqk,bhkd->bhqd', p, v)
        return (lambda x, *d: x.permute(*d))(o, 0, 2, 1, 3).reshape(B, S, D) @ wo

    def _B_ref(x, w_gate, w_up, w_down):
        g = torch.einsum('bsd,df->bsf', x, w_gate)
        u = torch.einsum('bsd,df->bsf', x, w_up)
        h = _sigmoid(g) * u
        return torch.einsum('bsf,fd->bsd', h, w_down)
    x = A_x
    mod = (_silu(c) @ w_mod).reshape(c.shape[0], 6, 1, -1)
    sa, ca, ga, sb, cb, gb = (mod[:, 0].clone(), mod[:, 1].clone(), mod[:, 2].clone(), mod[:, 3].clone(), mod[:, 4].clone(), mod[:, 5].clone())
    h = _layernorm(x, axis=-1) * (1 + ca) + sa
    x = x + ga * _A_ref(h, A_wqkv, A_wo)
    h = _layernorm(x, axis=-1) * (1 + cb) + sb
    x = x + gb * _B_ref(h, B_w_gate, B_w_up, B_w_down)
    return x
```

```asm
; @launch grid=(256,1,1) block=(256,1,1) lds=163840
.amdgcn_target "amdgcn-amd-amdhsa--gfx950"
.text
.globl adaLN_cond__sliding_block__glu_gated_glu__prompt_kernel
.p2align 8
.type adaLN_cond__sliding_block__glu_gated_glu__prompt_kernel,@function
adaLN_cond__sliding_block__glu_gated_glu__prompt_kernel:
s_cmp_ge_u32 s2, 256
s_cbranch_scc1 L_end
s_load_dwordx16 s[16:31], s[0:1], 0
s_load_dwordx8 s[32:39], s[0:1], 64
v_lshrrev_b32 v1, 6, v0
v_mov_b32 v4, v0
v_readfirstlane_b32 s43, v1
v_and_b32 v0, 63, v0
v_lshlrev_b32 v1, 4, v0
s_and_b32 s4, s2, 6
s_lshl_b32 s4, s4, 1
s_lshr_b32 s5, s2, 6
s_add_u32 s41, s4, s5
s_lshr_b32 s42, s2, 3
s_and_b32 s42, s42, 7
s_and_b32 s4, s2, 1
s_lshl_b32 s5, s4, 3
s_add_u32 s3, s42, s5
s_mov_b32 s42, s3
s_lshl_b32 s44, s41, 2
s_add_u32 s44, s44, s43
s_lshr_b32 s4, s3, 3
s_lshl_b32 s4, s4, 1
s_and_b32 s5, s43, 1
s_add_u32 s46, s4, s5
s_lshl_b32 s45, s41, 2
s_add_u32 s45, s45, s46
s_lshr_b32 s93, s43, 1
s_mul_i32 s4, s3, 3
s_lshl_b32 s5, s3, 1
s_add_u32 s5, s5, 11
s_cmp_lt_u32 s3, 11
s_cselect_b32 s92, s4, s5
v_lshrrev_b32 v5, 5, v0
v_and_b32 v14, 16, v0
v_lshlrev_b32 v2, 1, v14
v_bfe_u32 v14, v0, 2, 2
v_lshl_add_u32 v2, v14, 6, v2
v_and_b32 v14, 3, v0
v_lshl_add_u32 v2, v14, 3, v2
v_lshl_add_u32 v3, v5, 8, v2
v_lshl_add_u32 v2, v5, 9, v2
s_waitcnt lgkmcnt(0)
s_load_dword s40, s[38:39], 0
s_mov_b32 s48, s16
s_mov_b32 s49, s17
s_mov_b32 s50, 2097152
s_mov_b32 s51, 0x20000
s_mov_b32 s52, s18
s_mov_b32 s53, s19
s_mov_b32 s54, 1572864
s_mov_b32 s55, 0x20000
s_mov_b32 s56, s20
s_mov_b32 s57, s21
s_mov_b32 s58, 524288
s_mov_b32 s59, 0x20000
s_mov_b32 s60, s24
s_mov_b32 s61, s25
s_mov_b32 s62, 1409024
s_mov_b32 s63, 0x20000
s_mov_b32 s64, s26
s_mov_b32 s65, s27
s_mov_b32 s66, 1409024
s_mov_b32 s67, 0x20000
s_mov_b32 s68, s28
s_mov_b32 s69, s29
s_mov_b32 s70, 1409024
s_mov_b32 s71, 0x20000
s_mov_b32 s72, s30
s_mov_b32 s73, s31
s_mov_b32 s74, 1024
s_mov_b32 s75, 0x20000
s_mov_b32 s76, s32
s_mov_b32 s77, s33
s_mov_b32 s78, 3145728
s_mov_b32 s79, 0x20000
s_mov_b32 s80, s34
s_mov_b32 s81, s35
s_mov_b32 s82, 2097152
s_mov_b32 s83, 0x20000
s_mov_b32 s84, s38
s_mov_b32 s85, s39
s_mov_b32 s86, 35651584
s_mov_b32 s87, 0x20000
v_bfe_u32 v14, v0, 2, 2
v_lshl_add_u32 v13, v5, 2, v14
v_lshlrev_b32 v13, 7, v13
v_lshrrev_b32 v14, 1, v14
v_lshlrev_b32 v14, 6, v14
v_and_b32 v15, 16, v0
v_lshlrev_b32 v15, 1, v15
v_add_u32 v14, v14, v15
v_and_b32 v15, 3, v0
v_lshl_add_u32 v14, v15, 3, v14
v_add_u32 v13, v13, v14
s_and_b32 s95, s2, 1
s_lshl_b32 s4, s95, 8
v_add_u32 v9, s4, v4
v_lshlrev_b32 v8, 1, v9
buffer_load_ushort v6, v8, s[72:75], 0 offen
s_bfe_u32 s4, s2, 0x10002
s_lshl_b32 s4, s4, 6
s_lshr_b32 s5, s2, 5
s_lshl_b32 s5, s5, 3
s_add_u32 s4, s4, s5
s_bfe_u32 s5, s2, 0x10001
s_lshl_b32 s5, s5, 2
s_add_u32 s4, s4, s5
s_bfe_u32 s5, s2, 0x20003
s_add_u32 s4, s4, s5
s_lshl_b32 s96, s4, 4
s_lshl_b32 s94, s4, 5
s_lshl_b32 s5, s95, 12
s_add_u32 s94, s94, s5
v_mul_u32_u24 v8, 6144, v9
buffer_load_dwordx4 v[16:19], v8, s[76:79], s96 offen
s_getpc_b64 s[4:5]
L_pc:
s_lshr_b32 s6, s2, 3
s_lshl_b32 s6, s6, 4
v_and_b32 v14, 15, v0
v_add_u32 v14, s6, v14
v_lshlrev_b32 v14, 7, v14
v_min_u32 v14, L_end-L_pc, v14
s_cmp_lg_u32 s43, 3
s_cbranch_scc1 nw_1
global_load_dword v10, v14, s[4:5]
nw_1:
v_lshrrev_b32 v14, 4, v0
v_lshlrev_b32 v15, 10, v14
v_add_u32 v9, 0, v14
v_xor_b32 v9, v9, v0
v_and_b32 v9, 15, v9
v_lshl_add_u32 v108, v9, 4, v15
v_add_u32 v9, 4, v14
v_xor_b32 v9, v9, v0
v_and_b32 v9, 15, v9
v_lshl_add_u32 v109, v9, 4, v15
v_add_u32 v9, 8, v14
v_xor_b32 v9, v9, v0
v_and_b32 v9, 15, v9
v_lshl_add_u32 v110, v9, 4, v15
v_add_u32 v9, 12, v14
v_xor_b32 v9, v9, v0
v_and_b32 v9, 15, v9
v_lshl_add_u32 v111, v9, 4, v15
s_lshl_b32 s13, s44, 15
s_lshl_b32 s14, s43, 15
s_cmp_ge_u32 s43, 2
s_cbranch_scc1 L_nxt
s_bfe_u32 s5, s2, 0x30003
s_lshl_b32 s5, s5, 4
s_lshl_b32 s6, s41, 7
s_add_u32 s5, s5, s6
v_lshrrev_b32 v14, 3, v4
v_add_u32 v14, s5, v14
v_mul_u32_u24 v14, 1024, v14
v_and_b32 v15, 7, v4
v_min_u32 v15, 7, v15
v_lshl_add_u32 v14, v15, 7, v14
buffer_load_dword v11, v14, s[48:51], 0 offen
L_nxt:
s_lshr_b32 s5, s2, 3
s_lshl_b32 s5, s5, 4
s_and_b32 s6, s2, 1
s_lshl_b32 s6, s6, 6
s_lshl_b32 s6, s6, 3
v_lshrrev_b32 v14, 4, v4
v_add_u32 v14, s5, v14
v_mul_u32_u24 v14, 3072, v14
v_and_b32 v15, 3, v4
v_lshl_add_u32 v14, v15, 7, v14
v_bfe_u32 v15, v4, 2, 2
v_min_u32 v15, 2, v15
v_lshl_add_u32 v14, v15, 10, v14
buffer_load_dword v10, v14, s[52:55], s6 offen
s_waitcnt vmcnt(1) lgkmcnt(0)
s_mul_i32 s40, s40, 1664525
s_add_u32 s40, s40, 1013904223
v_lshlrev_b32 v6, 16, v6
v_mul_f32 v14, 0xbfb8aa3b, v6
v_exp_f32 v14, v14
s_nop 0
v_add_f32 v14, 1.0, v14
v_rcp_f32 v14, v14
s_nop 0
v_mul_f32 v6, v6, v14
v_cvt_pk_bf16_f32 v6, v6, v6
v_lshlrev_b32 v6, 16, v6
v_accvgpr_write_b32 a250, v6
v_accvgpr_write_b32 a251, v8
v_lshlrev_b32 v20, 16, v16
v_and_b32 v21, 0xffff0000, v16
v_lshlrev_b32 v22, 16, v17
v_and_b32 v23, 0xffff0000, v17
v_lshlrev_b32 v24, 16, v18
v_and_b32 v25, 0xffff0000, v18
v_lshlrev_b32 v26, 16, v19
v_and_b32 v27, 0xffff0000, v19
v_mul_f32 v20, v6, v20
v_mul_f32 v21, v6, v21
v_mul_f32 v22, v6, v22
v_mul_f32 v23, v6, v23
v_mul_f32 v24, v6, v24
v_mul_f32 v25, v6, v25
v_mul_f32 v26, v6, v26
v_mul_f32 v27, v6, v27
v_add_f32_dpp v20, v20, v20 row_shr:1 row_mask:0xf bank_mask:0xf
v_add_f32_dpp v21, v21, v21 row_shr:1 row_mask:0xf bank_mask:0xf
v_add_f32_dpp v22, v22, v22 row_shr:1 row_mask:0xf bank_mask:0xf
v_add_f32_dpp v23, v23, v23 row_shr:1 row_mask:0xf bank_mask:0xf
v_add_f32_dpp v24, v24, v24 row_shr:1 row_mask:0xf bank_mask:0xf
v_add_f32_dpp v25, v25, v25 row_shr:1 row_mask:0xf bank_mask:0xf
v_add_f32_dpp v26, v26, v26 row_shr:1 row_mask:0xf bank_mask:0xf
v_add_f32_dpp v27, v27, v27 row_shr:1 row_mask:0xf bank_mask:0xf
v_add_f32_dpp v20, v20, v20 row_shr:2 row_mask:0xf bank_mask:0xf
v_add_f32_dpp v21, v21, v21 row_shr:2 row_mask:0xf bank_mask:0xf
v_add_f32_dpp v22, v22, v22 row_shr:2 row_mask:0xf bank_mask:0xf
v_add_f32_dpp v23, v23, v23 row_shr:2 row_mask:0xf bank_mask:0xf
v_add_f32_dpp v24, v24, v24 row_shr:2 row_mask:0xf bank_mask:0xf
v_add_f32_dpp v25, v25, v25 row_shr:2 row_mask:0xf bank_mask:0xf
v_add_f32_dpp v26, v26, v26 row_shr:2 row_mask:0xf bank_mask:0xf
v_add_f32_dpp v27, v27, v27 row_shr:2 row_mask:0xf bank_mask:0xf
v_add_f32_dpp v20, v20, v20 row_shr:4 row_mask:0xf bank_mask:0xf
v_add_f32_dpp v21, v21, v21 row_shr:4 row_mask:0xf bank_mask:0xf
v_add_f32_dpp v22, v22, v22 row_shr:4 row_mask:0xf bank_mask:0xf
v_add_f32_dpp v23, v23, v23 row_shr:4 row_mask:0xf bank_mask:0xf
v_add_f32_dpp v24, v24, v24 row_shr:4 row_mask:0xf bank_mask:0xf
v_add_f32_dpp v25, v25, v25 row_shr:4 row_mask:0xf bank_mask:0xf
v_add_f32_dpp v26, v26, v26 row_shr:4 row_mask:0xf bank_mask:0xf
v_add_f32_dpp v27, v27, v27 row_shr:4 row_mask:0xf bank_mask:0xf
v_add_f32_dpp v20, v20, v20 row_shr:8 row_mask:0xf bank_mask:0xf
v_add_f32_dpp v21, v21, v21 row_shr:8 row_mask:0xf bank_mask:0xf
v_add_f32_dpp v22, v22, v22 row_shr:8 row_mask:0xf bank_mask:0xf
v_add_f32_dpp v23, v23, v23 row_shr:8 row_mask:0xf bank_mask:0xf
v_add_f32_dpp v24, v24, v24 row_shr:8 row_mask:0xf bank_mask:0xf
v_add_f32_dpp v25, v25, v25 row_shr:8 row_mask:0xf bank_mask:0xf
v_add_f32_dpp v26, v26, v26 row_shr:8 row_mask:0xf bank_mask:0xf
v_add_f32_dpp v27, v27, v27 row_shr:8 row_mask:0xf bank_mask:0xf
v_add_f32_dpp v20, v20, v20 row_bcast:15 row_mask:0xa bank_mask:0xf
v_add_f32_dpp v21, v21, v21 row_bcast:15 row_mask:0xa bank_mask:0xf
v_add_f32_dpp v22, v22, v22 row_bcast:15 row_mask:0xa bank_mask:0xf
v_add_f32_dpp v23, v23, v23 row_bcast:15 row_mask:0xa bank_mask:0xf
v_add_f32_dpp v24, v24, v24 row_bcast:15 row_mask:0xa bank_mask:0xf
v_add_f32_dpp v25, v25, v25 row_bcast:15 row_mask:0xa bank_mask:0xf
v_add_f32_dpp v26, v26, v26 row_bcast:15 row_mask:0xa bank_mask:0xf
v_add_f32_dpp v27, v27, v27 row_bcast:15 row_mask:0xa bank_mask:0xf
v_add_f32_dpp v20, v20, v20 row_bcast:31 row_mask:0xc bank_mask:0xf
v_add_f32_dpp v21, v21, v21 row_bcast:31 row_mask:0xc bank_mask:0xf
v_add_f32_dpp v22, v22, v22 row_bcast:31 row_mask:0xc bank_mask:0xf
v_add_f32_dpp v23, v23, v23 row_bcast:31 row_mask:0xc bank_mask:0xf
v_add_f32_dpp v24, v24, v24 row_bcast:31 row_mask:0xc bank_mask:0xf
v_add_f32_dpp v25, v25, v25 row_bcast:31 row_mask:0xc bank_mask:0xf
v_add_f32_dpp v26, v26, v26 row_bcast:31 row_mask:0xc bank_mask:0xf
v_add_f32_dpp v27, v27, v27 row_bcast:31 row_mask:0xc bank_mask:0xf
s_lshl_b32 s4, s43, 5
s_add_u32 s4, s4, 157184
v_mov_b32 v14, s4
s_mov_b32 exec_lo, 0
s_brev_b32 exec_hi, 1
ds_write_b128 v14, v[20:23]
ds_write_b128 v14, v[24:27] offset:16
s_mov_b64 exec, -1
s_waitcnt lgkmcnt(0)
s_barrier
s_cmp_lg_u32 s43, 0
s_cbranch_scc1 nw_2
v_and_b32 v15, 1, v0
v_lshlrev_b32 v15, 4, v15
v_add_u32 v14, 157184, v15
ds_read_b128 v[32:35], v14 offset:0
ds_read_b128 v[36:39], v14 offset:32
ds_read_b128 v[40:43], v14 offset:64
ds_read_b128 v[44:47], v14 offset:96
s_waitcnt lgkmcnt(0)
v_add_f32 v32, v32, v36
v_add_f32 v40, v40, v44
v_add_f32 v33, v33, v37
v_add_f32 v41, v41, v45
v_add_f32 v34, v34, v38
v_add_f32 v42, v42, v46
v_add_f32 v35, v35, v39
v_add_f32 v43, v43, v47
v_mov_b32 v14, 0xff
v_add_f32 v32, v32, v40
s_lshr_b32 s4, s40, 0
v_bfi_b32 v32, v14, s4, v32
v_add_f32 v33, v33, v41
s_lshr_b32 s4, s40, 8
v_bfi_b32 v33, v14, s4, v33
v_add_f32 v34, v34, v42
s_lshr_b32 s4, s40, 16
v_bfi_b32 v34, v14, s4, v34
v_add_f32 v35, v35, v43
s_lshr_b32 s4, s40, 24
v_bfi_b32 v35, v14, s4, v35
s_add_u32 s4, s94, 4096
s_mov_b64 exec, 3
buffer_store_dwordx4 v[32:35], v15, s[84:87], s4 offen sc1
s_mov_b64 exec, -1
nw_2:
s_add_u32 m0, s14, 0
s_add_u32 s6, s13, 0
buffer_load_dwordx4 v108, s[48:51], s6 offen lds
s_add_u32 m0, s14, 1024
s_add_u32 s6, s13, 4096
buffer_load_dwordx4 v109, s[48:51], s6 offen lds
s_add_u32 m0, s14, 2048
s_add_u32 s6, s13, 8192
buffer_load_dwordx4 v110, s[48:51], s6 offen lds
s_add_u32 m0, s14, 3072
s_add_u32 s6, s13, 12288
buffer_load_dwordx4 v111, s[48:51], s6 offen lds
s_add_u32 m0, s14, 4096
s_add_u32 s6, s13, 16384
buffer_load_dwordx4 v108, s[48:51], s6 offen lds
s_add_u32 m0, s14, 5120
s_add_u32 s6, s13, 20480
buffer_load_dwordx4 v109, s[48:51], s6 offen lds
s_add_u32 m0, s14, 6144
s_add_u32 s6, s13, 24576
buffer_load_dwordx4 v110, s[48:51], s6 offen lds
s_add_u32 m0, s14, 7168
s_add_u32 s6, s13, 28672
buffer_load_dwordx4 v111, s[48:51], s6 offen lds
s_add_u32 m0, s14, 8192
s_add_u32 s6, s13, 256
buffer_load_dwordx4 v108, s[48:51], s6 offen lds
s_add_u32 m0, s14, 9216
s_add_u32 s6, s13, 4352
buffer_load_dwordx4 v109, s[48:51], s6 offen lds
s_add_u32 m0, s14, 10240
s_add_u32 s6, s13, 8448
buffer_load_dwordx4 v110, s[48:51], s6 offen lds
s_add_u32 m0, s14, 11264
s_add_u32 s6, s13, 12544
buffer_load_dwordx4 v111, s[48:51], s6 offen lds
s_add_u32 m0, s14, 12288
s_add_u32 s6, s13, 16640
buffer_load_dwordx4 v108, s[48:51], s6 offen lds
s_add_u32 m0, s14, 13312
s_add_u32 s6, s13, 20736
buffer_load_dwordx4 v109, s[48:51], s6 offen lds
s_add_u32 m0, s14, 14336
s_add_u32 s6, s13, 24832
buffer_load_dwordx4 v110, s[48:51], s6 offen lds
s_add_u32 m0, s14, 15360
s_add_u32 s6, s13, 28928
buffer_load_dwordx4 v111, s[48:51], s6 offen lds
v_and_b32 v14, 31, v0
v_lshlrev_b32 v9, 8, v14
v_add_u32 v9, s14, v9
v_and_b32 v14, 15, v0
v_add_u32 v15, 0, v5
v_xor_b32 v15, v15, v14
v_lshl_add_u32 v96, v15, 4, v9
v_add_u32 v15, 2, v5
v_xor_b32 v15, v15, v14
v_lshl_add_u32 v97, v15, 4, v9
v_add_u32 v15, 4, v5
v_xor_b32 v15, v15, v14
v_lshl_add_u32 v98, v15, 4, v9
v_add_u32 v15, 6, v5
v_xor_b32 v15, v15, v14
v_lshl_add_u32 v99, v15, 4, v9
v_add_u32 v15, 8, v5
v_xor_b32 v15, v15, v14
v_lshl_add_u32 v100, v15, 4, v9
v_add_u32 v15, 10, v5
v_xor_b32 v15, v15, v14
v_lshl_add_u32 v101, v15, 4, v9
v_add_u32 v15, 12, v5
v_xor_b32 v15, v15, v14
v_lshl_add_u32 v102, v15, 4, v9
v_add_u32 v15, 14, v5
v_xor_b32 v15, v15, v14
v_lshl_add_u32 v103, v15, 4, v9
v_mov_b32 v112, 0
v_mov_b32 v113, 0
v_mov_b32 v114, 0
v_mov_b32 v115, 0
s_mov_b32 s15, 0x3f803f80
v_lshrrev_b32 v12, 2, v0
v_mul_u32_u24 v12, 3072, v12
v_and_b32 v15, 3, v0
v_lshl_add_u32 v12, v15, 4, v12
s_mul_i32 s9, s43, 49152
s_lshl_b32 s5, s42, 6
s_add_u32 s9, s9, s5
s_waitcnt vmcnt(8)
ds_read_b128 v[128:131], v96 offset:0
ds_read_b128 v[132:135], v97 offset:0
ds_read_b128 v[136:139], v98 offset:0
ds_read_b128 v[140:143], v99 offset:0
ds_read_b128 v[144:147], v100 offset:0
ds_read_b128 v[148:151], v101 offset:0
ds_read_b128 v[152:155], v102 offset:0
ds_read_b128 v[156:159], v103 offset:0
s_waitcnt lgkmcnt(0)
s_add_u32 m0, s14, 16384
s_add_u32 s6, s13, 512
buffer_load_dwordx4 v108, s[48:51], s6 offen lds
s_add_u32 m0, s14, 17408
s_add_u32 s6, s13, 4608
buffer_load_dwordx4 v109, s[48:51], s6 offen lds
s_add_u32 m0, s14, 18432
s_add_u32 s6, s13, 8704
buffer_load_dwordx4 v110, s[48:51], s6 offen lds
s_add_u32 m0, s14, 19456
s_add_u32 s6, s13, 12800
buffer_load_dwordx4 v111, s[48:51], s6 offen lds
s_add_u32 m0, s14, 20480
s_add_u32 s6, s13, 16896
buffer_load_dwordx4 v108, s[48:51], s6 offen lds
s_add_u32 m0, s14, 21504
s_add_u32 s6, s13, 20992
buffer_load_dwordx4 v109, s[48:51], s6 offen lds
s_add_u32 m0, s14, 22528
s_add_u32 s6, s13, 25088
buffer_load_dwordx4 v110, s[48:51], s6 offen lds
s_add_u32 m0, s14, 23552
s_add_u32 s6, s13, 29184
buffer_load_dwordx4 v111, s[48:51], s6 offen lds
s_waitcnt lgkmcnt(0)
s_waitcnt vmcnt(8)
ds_read_b128 v[160:163], v96 offset:8192
ds_read_b128 v[164:167], v97 offset:8192
ds_read_b128 v[168:171], v98 offset:8192
ds_read_b128 v[172:175], v99 offset:8192
ds_read_b128 v[176:179], v100 offset:8192
ds_read_b128 v[180:183], v101 offset:8192
ds_read_b128 v[184:187], v102 offset:8192
ds_read_b128 v[188:191], v103 offset:8192
s_waitcnt lgkmcnt(0)
s_add_u32 m0, s14, 24576
s_add_u32 s6, s13, 768
buffer_load_dwordx4 v108, s[48:51], s6 offen lds
v_dot2_f32_bf16 v112, v128, s15, v112
v_dot2_f32_bf16 v114, v128, v128, v114
v_dot2_f32_bf16 v113, v129, s15, v113
v_dot2_f32_bf16 v115, v129, v129, v115
v_dot2_f32_bf16 v112, v130, s15, v112
v_dot2_f32_bf16 v114, v130, v130, v114
v_dot2_f32_bf16 v113, v131, s15, v113
v_dot2_f32_bf16 v115, v131, v131, v115
s_add_u32 m0, s14, 25600
s_add_u32 s6, s13, 4864
buffer_load_dwordx4 v109, s[48:51], s6 offen lds
v_dot2_f32_bf16 v112, v132, s15, v112
v_dot2_f32_bf16 v114, v132, v132, v114
v_dot2_f32_bf16 v113, v133, s15, v113
v_dot2_f32_bf16 v115, v133, v133, v115
v_dot2_f32_bf16 v112, v134, s15, v112
v_dot2_f32_bf16 v114, v134, v134, v114
v_dot2_f32_bf16 v113, v135, s15, v113
v_dot2_f32_bf16 v115, v135, v135, v115
s_add_u32 m0, s14, 26624
s_add_u32 s6, s13, 8960
buffer_load_dwordx4 v110, s[48:51], s6 offen lds
v_dot2_f32_bf16 v112, v136, s15, v112
v_dot2_f32_bf16 v114, v136, v136, v114
v_dot2_f32_bf16 v113, v137, s15, v113
v_dot2_f32_bf16 v115, v137, v137, v115
v_dot2_f32_bf16 v112, v138, s15, v112
v_dot2_f32_bf16 v114, v138, v138, v114
v_dot2_f32_bf16 v113, v139, s15, v113
v_dot2_f32_bf16 v115, v139, v139, v115
s_add_u32 m0, s14, 27648
s_add_u32 s6, s13, 13056
buffer_load_dwordx4 v111, s[48:51], s6 offen lds
v_dot2_f32_bf16 v112, v140, s15, v112
v_dot2_f32_bf16 v114, v140, v140, v114
v_dot2_f32_bf16 v113, v141, s15, v113
v_dot2_f32_bf16 v115, v141, v141, v115
v_dot2_f32_bf16 v112, v142, s15, v112
v_dot2_f32_bf16 v114, v142, v142, v114
v_dot2_f32_bf16 v113, v143, s15, v113
v_dot2_f32_bf16 v115, v143, v143, v115
s_add_u32 m0, s14, 28672
s_add_u32 s6, s13, 17152
buffer_load_dwordx4 v108, s[48:51], s6 offen lds
v_dot2_f32_bf16 v112, v144, s15, v112
v_dot2_f32_bf16 v114, v144, v144, v114
v_dot2_f32_bf16 v113, v145, s15, v113
v_dot2_f32_bf16 v115, v145, v145, v115
v_dot2_f32_bf16 v112, v146, s15, v112
v_dot2_f32_bf16 v114, v146, v146, v114
v_dot2_f32_bf16 v113, v147, s15, v113
v_dot2_f32_bf16 v115, v147, v147, v115
s_add_u32 m0, s14, 29696
s_add_u32 s6, s13, 21248
buffer_load_dwordx4 v109, s[48:51], s6 offen lds
v_dot2_f32_bf16 v112, v148, s15, v112
v_dot2_f32_bf16 v114, v148, v148, v114
v_dot2_f32_bf16 v113, v149, s15, v113
v_dot2_f32_bf16 v115, v149, v149, v115
v_dot2_f32_bf16 v112, v150, s15, v112
v_dot2_f32_bf16 v114, v150, v150, v114
v_dot2_f32_bf16 v113, v151, s15, v113
v_dot2_f32_bf16 v115, v151, v151, v115
s_add_u32 m0, s14, 30720
s_add_u32 s6, s13, 25344
buffer_load_dwordx4 v110, s[48:51], s6 offen lds
v_dot2_f32_bf16 v112, v152, s15, v112
v_dot2_f32_bf16 v114, v152, v152, v114
v_dot2_f32_bf16 v113, v153, s15, v113
v_dot2_f32_bf16 v115, v153, v153, v115
v_dot2_f32_bf16 v112, v154, s15, v112
v_dot2_f32_bf16 v114, v154, v154, v114
v_dot2_f32_bf16 v113, v155, s15, v113
v_dot2_f32_bf16 v115, v155, v155, v115
s_add_u32 m0, s14, 31744
s_add_u32 s6, s13, 29440
buffer_load_dwordx4 v111, s[48:51], s6 offen lds
v_dot2_f32_bf16 v112, v156, s15, v112
v_dot2_f32_bf16 v114, v156, v156, v114
v_dot2_f32_bf16 v113, v157, s15, v113
v_dot2_f32_bf16 v115, v157, v157, v115
v_dot2_f32_bf16 v112, v158, s15, v112
v_dot2_f32_bf16 v114, v158, v158, v114
v_dot2_f32_bf16 v113, v159, s15, v113
v_dot2_f32_bf16 v115, v159, v159, v115
s_waitcnt lgkmcnt(0)
s_waitcnt vmcnt(8)
ds_read_b128 v[192:195], v96 offset:16384
ds_read_b128 v[196:199], v97 offset:16384
ds_read_b128 v[200:203], v98 offset:16384
ds_read_b128 v[204:207], v99 offset:16384
ds_read_b128 v[208:211], v100 offset:16384
ds_read_b128 v[212:215], v101 offset:16384
ds_read_b128 v[216:219], v102 offset:16384
ds_read_b128 v[220:223], v103 offset:16384
v_dot2_f32_bf16 v112, v160, s15, v112
v_dot2_f32_bf16 v114, v160, v160, v114
v_dot2_f32_bf16 v113, v161, s15, v113
v_dot2_f32_bf16 v115, v161, v161, v115
v_dot2_f32_bf16 v112, v162, s15, v112
v_dot2_f32_bf16 v114, v162, v162, v114
v_dot2_f32_bf16 v113, v163, s15, v113
v_dot2_f32_bf16 v115, v163, v163, v115
v_dot2_f32_bf16 v112, v164, s15, v112
v_dot2_f32_bf16 v114, v164, v164, v114
v_dot2_f32_bf16 v113, v165, s15, v113
v_dot2_f32_bf16 v115, v165, v165, v115
v_dot2_f32_bf16 v112, v166, s15, v112
v_dot2_f32_bf16 v114, v166, v166, v114
v_dot2_f32_bf16 v113, v167, s15, v113
v_dot2_f32_bf16 v115, v167, v167, v115
v_dot2_f32_bf16 v112, v168, s15, v112
v_dot2_f32_bf16 v114, v168, v168, v114
v_dot2_f32_bf16 v113, v169, s15, v113
v_dot2_f32_bf16 v115, v169, v169, v115
v_dot2_f32_bf16 v112, v170, s15, v112
v_dot2_f32_bf16 v114, v170, v170, v114
v_dot2_f32_bf16 v113, v171, s15, v113
v_dot2_f32_bf16 v115, v171, v171, v115
v_dot2_f32_bf16 v112, v172, s15, v112
v_dot2_f32_bf16 v114, v172, v172, v114
v_dot2_f32_bf16 v113, v173, s15, v113
v_dot2_f32_bf16 v115, v173, v173, v115
v_dot2_f32_bf16 v112, v174, s15, v112
v_dot2_f32_bf16 v114, v174, v174, v114
v_dot2_f32_bf16 v113, v175, s15, v113
v_dot2_f32_bf16 v115, v175, v175, v115
v_dot2_f32_bf16 v112, v176, s15, v112
v_dot2_f32_bf16 v114, v176, v176, v114
v_dot2_f32_bf16 v113, v177, s15, v113
v_dot2_f32_bf16 v115, v177, v177, v115
v_dot2_f32_bf16 v112, v178, s15, v112
v_dot2_f32_bf16 v114, v178, v178, v114
v_dot2_f32_bf16 v113, v179, s15, v113
v_dot2_f32_bf16 v115, v179, v179, v115
v_dot2_f32_bf16 v112, v180, s15, v112
v_dot2_f32_bf16 v114, v180, v180, v114
v_dot2_f32_bf16 v113, v181, s15, v113
v_dot2_f32_bf16 v115, v181, v181, v115
v_dot2_f32_bf16 v112, v182, s15, v112
v_dot2_f32_bf16 v114, v182, v182, v114
v_dot2_f32_bf16 v113, v183, s15, v113
v_dot2_f32_bf16 v115, v183, v183, v115
v_dot2_f32_bf16 v112, v184, s15, v112
v_dot2_f32_bf16 v114, v184, v184, v114
v_dot2_f32_bf16 v113, v185, s15, v113
v_dot2_f32_bf16 v115, v185, v185, v115
v_dot2_f32_bf16 v112, v186, s15, v112
v_dot2_f32_bf16 v114, v186, v186, v114
v_dot2_f32_bf16 v113, v187, s15, v113
v_dot2_f32_bf16 v115, v187, v187, v115
v_dot2_f32_bf16 v112, v188, s15, v112
v_dot2_f32_bf16 v114, v188, v188, v114
v_dot2_f32_bf16 v113, v189, s15, v113
v_dot2_f32_bf16 v115, v189, v189, v115
v_dot2_f32_bf16 v112, v190, s15, v112
v_dot2_f32_bf16 v114, v190, v190, v114
v_dot2_f32_bf16 v113, v191, s15, v113
v_dot2_f32_bf16 v115, v191, v191, v115
s_waitcnt lgkmcnt(0)
s_waitcnt vmcnt(0)
ds_read_b128 v[224:227], v96 offset:24576
ds_read_b128 v[228:231], v97 offset:24576
ds_read_b128 v[232:235], v98 offset:24576
ds_read_b128 v[236:239], v99 offset:24576
ds_read_b128 v[240:243], v100 offset:24576
ds_read_b128 v[244:247], v101 offset:24576
ds_read_b128 v[248:251], v102 offset:24576
ds_read_b128 v[252:255], v103 offset:24576
v_dot2_f32_bf16 v112, v192, s15, v112
v_dot2_f32_bf16 v114, v192, v192, v114
v_dot2_f32_bf16 v113, v193, s15, v113
v_dot2_f32_bf16 v115, v193, v193, v115
v_dot2_f32_bf16 v112, v194, s15, v112
v_dot2_f32_bf16 v114, v194, v194, v114
v_dot2_f32_bf16 v113, v195, s15, v113
v_dot2_f32_bf16 v115, v195, v195, v115
v_dot2_f32_bf16 v112, v196, s15, v112
v_dot2_f32_bf16 v114, v196, v196, v114
v_dot2_f32_bf16 v113, v197, s15, v113
v_dot2_f32_bf16 v115, v197, v197, v115
v_dot2_f32_bf16 v112, v198, s15, v112
v_dot2_f32_bf16 v114, v198, v198, v114
v_dot2_f32_bf16 v113, v199, s15, v113
v_dot2_f32_bf16 v115, v199, v199, v115
v_dot2_f32_bf16 v112, v200, s15, v112
v_dot2_f32_bf16 v114, v200, v200, v114
v_dot2_f32_bf16 v113, v201, s15, v113
v_dot2_f32_bf16 v115, v201, v201, v115
v_dot2_f32_bf16 v112, v202, s15, v112
v_dot2_f32_bf16 v114, v202, v202, v114
v_dot2_f32_bf16 v113, v203, s15, v113
v_dot2_f32_bf16 v115, v203, v203, v115
v_dot2_f32_bf16 v112, v204, s15, v112
v_dot2_f32_bf16 v114, v204, v204, v114
v_dot2_f32_bf16 v113, v205, s15, v113
v_dot2_f32_bf16 v115, v205, v205, v115
v_dot2_f32_bf16 v112, v206, s15, v112
v_dot2_f32_bf16 v114, v206, v206, v114
v_dot2_f32_bf16 v113, v207, s15, v113
v_dot2_f32_bf16 v115, v207, v207, v115
v_dot2_f32_bf16 v112, v208, s15, v112
v_dot2_f32_bf16 v114, v208, v208, v114
v_dot2_f32_bf16 v113, v209, s15, v113
v_dot2_f32_bf16 v115, v209, v209, v115
v_dot2_f32_bf16 v112, v210, s15, v112
v_dot2_f32_bf16 v114, v210, v210, v114
v_dot2_f32_bf16 v113, v211, s15, v113
v_dot2_f32_bf16 v115, v211, v211, v115
v_dot2_f32_bf16 v112, v212, s15, v112
v_dot2_f32_bf16 v114, v212, v212, v114
v_dot2_f32_bf16 v113, v213, s15, v113
v_dot2_f32_bf16 v115, v213, v213, v115
v_dot2_f32_bf16 v112, v214, s15, v112
v_dot2_f32_bf16 v114, v214, v214, v114
v_dot2_f32_bf16 v113, v215, s15, v113
v_dot2_f32_bf16 v115, v215, v215, v115
v_dot2_f32_bf16 v112, v216, s15, v112
v_dot2_f32_bf16 v114, v216, v216, v114
v_dot2_f32_bf16 v113, v217, s15, v113
v_dot2_f32_bf16 v115, v217, v217, v115
v_dot2_f32_bf16 v112, v218, s15, v112
v_dot2_f32_bf16 v114, v218, v218, v114
v_dot2_f32_bf16 v113, v219, s15, v113
v_dot2_f32_bf16 v115, v219, v219, v115
v_dot2_f32_bf16 v112, v220, s15, v112
v_dot2_f32_bf16 v114, v220, v220, v114
v_dot2_f32_bf16 v113, v221, s15, v113
v_dot2_f32_bf16 v115, v221, v221, v115
v_dot2_f32_bf16 v112, v222, s15, v112
v_dot2_f32_bf16 v114, v222, v222, v114
v_dot2_f32_bf16 v113, v223, s15, v113
v_dot2_f32_bf16 v115, v223, v223, v115
s_waitcnt lgkmcnt(0)
v_dot2_f32_bf16 v112, v224, s15, v112
v_dot2_f32_bf16 v114, v224, v224, v114
v_dot2_f32_bf16 v113, v225, s15, v113
v_dot2_f32_bf16 v115, v225, v225, v115
v_dot2_f32_bf16 v112, v226, s15, v112
v_dot2_f32_bf16 v114, v226, v226, v114
v_dot2_f32_bf16 v113, v227, s15, v113
v_dot2_f32_bf16 v115, v227, v227, v115
v_dot2_f32_bf16 v112, v228, s15, v112
v_dot2_f32_bf16 v114, v228, v228, v114
v_dot2_f32_bf16 v113, v229, s15, v113
v_dot2_f32_bf16 v115, v229, v229, v115
v_dot2_f32_bf16 v112, v230, s15, v112
v_dot2_f32_bf16 v114, v230, v230, v114
v_dot2_f32_bf16 v113, v231, s15, v113
v_dot2_f32_bf16 v115, v231, v231, v115
v_dot2_f32_bf16 v112, v232, s15, v112
v_dot2_f32_bf16 v114, v232, v232, v114
v_dot2_f32_bf16 v113, v233, s15, v113
v_dot2_f32_bf16 v115, v233, v233, v115
v_dot2_f32_bf16 v112, v234, s15, v112
v_dot2_f32_bf16 v114, v234, v234, v114
v_dot2_f32_bf16 v113, v235, s15, v113
v_dot2_f32_bf16 v115, v235, v235, v115
v_dot2_f32_bf16 v112, v236, s15, v112
v_dot2_f32_bf16 v114, v236, v236, v114
v_dot2_f32_bf16 v113, v237, s15, v113
v_dot2_f32_bf16 v115, v237, v237, v115
v_dot2_f32_bf16 v112, v238, s15, v112
v_dot2_f32_bf16 v114, v238, v238, v114
v_dot2_f32_bf16 v113, v239, s15, v113
v_dot2_f32_bf16 v115, v239, v239, v115
v_dot2_f32_bf16 v112, v240, s15, v112
v_dot2_f32_bf16 v114, v240, v240, v114
v_dot2_f32_bf16 v113, v241, s15, v113
v_dot2_f32_bf16 v115, v241, v241, v115
v_dot2_f32_bf16 v112, v242, s15, v112
v_dot2_f32_bf16 v114, v242, v242, v114
v_dot2_f32_bf16 v113, v243, s15, v113
v_dot2_f32_bf16 v115, v243, v243, v115
v_dot2_f32_bf16 v112, v244, s15, v112
v_dot2_f32_bf16 v114, v244, v244, v114
v_dot2_f32_bf16 v113, v245, s15, v113
v_dot2_f32_bf16 v115, v245, v245, v115
v_dot2_f32_bf16 v112, v246, s15, v112
v_dot2_f32_bf16 v114, v246, v246, v114
v_dot2_f32_bf16 v113, v247, s15, v113
v_dot2_f32_bf16 v115, v247, v247, v115
v_dot2_f32_bf16 v112, v248, s15, v112
v_dot2_f32_bf16 v114, v248, v248, v114
v_dot2_f32_bf16 v113, v249, s15, v113
v_dot2_f32_bf16 v115, v249, v249, v115
v_dot2_f32_bf16 v112, v250, s15, v112
v_dot2_f32_bf16 v114, v250, v250, v114
v_dot2_f32_bf16 v113, v251, s15, v113
v_dot2_f32_bf16 v115, v251, v251, v115
v_dot2_f32_bf16 v112, v252, s15, v112
v_dot2_f32_bf16 v114, v252, v252, v114
v_dot2_f32_bf16 v113, v253, s15, v113
v_dot2_f32_bf16 v115, v253, v253, v115
v_dot2_f32_bf16 v112, v254, s15, v112
v_dot2_f32_bf16 v114, v254, v254, v114
v_dot2_f32_bf16 v113, v255, s15, v113
v_dot2_f32_bf16 v115, v255, v255, v115
s_nop 1
v_add_f32 v112, v112, v113
v_add_f32 v114, v114, v115
v_mov_b32 v113, v112
v_mov_b32 v115, v114
s_nop 0
v_permlane32_swap_b32 v112, v113
v_permlane32_swap_b32 v114, v115
v_add_f32 v112, v112, v113
v_add_f32 v114, v114, v115
v_mul_f32 v112, 0x3b000000, v112
v_mul_f32 v114, 0x3b000000, v114
v_fma_f32 v114, -v112, v112, v114
v_max_f32 v114, 0, v114
v_add_f32 v114, 0x3727c5ac, v114
v_rsq_f32 v116, v114
s_nop 0
v_mul_f32 v118, v112, v116
v_sub_f32 v118, 0, v118
v_mov_b32 v117, v116
v_mov_b32 v119, v118
v_lshlrev_b32 v8, 4, v4
v_add_u32 v9, 4096, v8
s_mov_b32 s47, 0x8000
mp_3:
s_mov_b32 s5, 0
buffer_load_dwordx4 v[40:43], v9, s[84:87], s5 offen sc1
s_mov_b32 s5, 4096
buffer_load_dwordx4 v[44:47], v9, s[84:87], s5 offen sc1
s_waitcnt vmcnt(0)
s_lshr_b32 s4, s40, 0
v_xor_b32 v49, s4, v40
v_mov_b32 v48, v49
s_lshr_b32 s4, s40, 8
v_xor_b32 v49, s4, v41
v_or_b32 v48, v48, v49
s_lshr_b32 s4, s40, 16
v_xor_b32 v49, s4, v42
v_or_b32 v48, v48, v49
s_lshr_b32 s4, s40, 24
v_xor_b32 v49, s4, v43
v_or_b32 v48, v48, v49
s_lshr_b32 s4, s40, 0
v_xor_b32 v49, s4, v44
v_or_b32 v48, v48, v49
s_lshr_b32 s4, s40, 8
v_xor_b32 v49, s4, v45
v_or_b32 v48, v48, v49
s_lshr_b32 s4, s40, 16
v_xor_b32 v49, s4, v46
v_or_b32 v48, v48, v49
s_lshr_b32 s4, s40, 24
v_xor_b32 v49, s4, v47
v_or_b32 v48, v48, v49
v_and_b32 v48, 0xff, v48
v_add_u32 v48, s40, v48
v_cmp_ne_u32 vcc, s40, v48
s_cbranch_vccz md_4
s_sub_u32 s47, s47, 1
s_cbranch_scc0 mp_3
md_4:
s_add_u32 m0, s14, 0
s_add_u32 s6, s9, 0
buffer_load_dwordx4 v12, s[52:55], s6 offen lds
s_add_u32 m0, s14, 1024
s_add_u32 s6, s9, 1024
buffer_load_dwordx4 v12, s[52:55], s6 offen lds
s_add_u32 m0, s14, 2048
s_add_u32 s6, s9, 2048
buffer_load_dwordx4 v12, s[52:55], s6 offen lds
v_add_f32 v40, v40, v44
v_add_f32 v41, v41, v45
v_add_f32 v42, v42, v46
v_add_f32 v43, v43, v47
v_cvt_pk_bf16_f32 v32, v40, v41
v_cvt_pk_bf16_f32 v33, v42, v43
v_lshlrev_b32 v36, 16, v32
v_and_b32 v37, 0xffff0000, v32
v_lshlrev_b32 v38, 16, v33
v_and_b32 v39, 0xffff0000, v33
s_cmp_lt_u32 s43, 2
s_cbranch_scc1 L_ta
v_add_f32 v36, 1.0, v36
v_cvt_pk_bf16_f32 v36, 0, v36
v_add_f32 v37, 1.0, v37
v_cvt_pk_bf16_f32 v37, 0, v37
v_add_f32 v38, 1.0, v38
v_cvt_pk_bf16_f32 v38, 0, v38
v_add_f32 v39, 1.0, v39
v_cvt_pk_bf16_f32 v39, 0, v39
v_subrev_u32 v8, 4096, v8
L_ta:
v_add_u32 v8, 141312, v8
ds_write_b128 v8, v[36:39]
s_add_u32 m0, s14, 3072
s_add_u32 s6, s9, 196608
buffer_load_dwordx4 v12, s[52:55], s6 offen lds
s_add_u32 m0, s14, 4096
s_add_u32 s6, s9, 197632
buffer_load_dwordx4 v12, s[52:55], s6 offen lds
s_add_u32 m0, s14, 5120
s_add_u32 s6, s9, 198656
buffer_load_dwordx4 v12, s[52:55], s6 offen lds
s_waitcnt lgkmcnt(0)
s_barrier
v_lshlrev_b32 v9, 5, v5
v_add_u32 v9, 139264, v9
v_add_u32 v10, 0x10000, v2
ds_read_b128 v[64:67], v9 offset:0
ds_read_b128 v[68:71], v9 offset:16
ds_read_b128 v[72:75], v9 offset:2048
ds_read_b128 v[76:79], v9 offset:2064
ds_read_b128 v[80:83], v9 offset:64
ds_read_b128 v[84:87], v9 offset:80
ds_read_b128 v[88:91], v9 offset:2112
ds_read_b128 v[92:95], v9 offset:2128
v_mov_b32 v96, 0xffff0000
v_lshlrev_b32 v120, 16, v128
v_and_b32 v121, v96, v128
v_mov_b32 v96, 0xffff0000
v_lshlrev_b32 v122, 16, v129
v_and_b32 v123, v96, v129
v_mov_b32 v96, 0xffff0000
v_lshlrev_b32 v124, 16, v130
v_and_b32 v125, v96, v130
v_mov_b32 v96, 0xffff0000
v_lshlrev_b32 v126, 16, v131
v_and_b32 v127, v96, v131
v_pk_fma_f32 v[120:121], v[120:121], v[116:117], v[118:119]
v_pk_fma_f32 v[122:123], v[122:123], v[116:117], v[118:119]
v_pk_fma_f32 v[124:125], v[124:125], v[116:117], v[118:119]
v_pk_fma_f32 v[126:127], v[126:127], v[116:117], v[118:119]
s_waitcnt lgkmcnt(4)
v_pk_fma_f32 v[120:121], v[120:121], v[64:65], v[72:73]
v_pk_fma_f32 v[122:123], v[122:123], v[66:67], v[74:75]
v_pk_fma_f32 v[124:125], v[124:125], v[68:69], v[76:77]
v_pk_fma_f32 v[126:127], v[126:127], v[70:71], v[78:79]
s_add_u32 m0, s14, 6144
s_add_u32 s6, s9, 393216
buffer_load_dwordx4 v12, s[52:55], s6 offen lds
v_cvt_pk_bf16_f32 v128, v120, v121
v_cvt_pk_bf16_f32 v129, v122, v123
v_cvt_pk_bf16_f32 v130, v124, v125
v_cvt_pk_bf16_f32 v131, v126, v127
ds_read_b128 v[64:67], v9 offset:128
ds_read_b128 v[68:71], v9 offset:144
ds_read_b128 v[72:75], v9 offset:2176
ds_read_b128 v[76:79], v9 offset:2192
v_lshlrev_b32 v120, 16, v132
v_and_b32 v121, v96, v132
v_lshlrev_b32 v122, 16, v133
v_and_b32 v123, v96, v133
v_lshlrev_b32 v124, 16, v134
v_and_b32 v125, v96, v134
v_lshlrev_b32 v126, 16, v135
v_and_b32 v127, v96, v135
v_pk_fma_f32 v[120:121], v[120:121], v[116:117], v[118:119]
v_pk_fma_f32 v[122:123], v[122:123], v[116:117], v[118:119]
v_pk_fma_f32 v[124:125], v[124:125], v[116:117], v[118:119]
v_pk_fma_f32 v[126:127], v[126:127], v[116:117], v[118:119]
s_waitcnt lgkmcnt(4)
v_pk_fma_f32 v[120:121], v[120:121], v[80:81], v[88:89]
v_pk_fma_f32 v[122:123], v[122:123], v[82:83], v[90:91]
v_pk_fma_f32 v[124:125], v[124:125], v[84:85], v[92:93]
v_pk_fma_f32 v[126:127], v[126:127], v[86:87], v[94:95]
s_add_u32 m0, s14, 7168
s_add_u32 s6, s9, 394240
buffer_load_dwordx4 v12, s[52:55], s6 offen lds
v_cvt_pk_bf16_f32 v132, v120, v121
v_cvt_pk_bf16_f32 v133, v122, v123
v_cvt_pk_bf16_f32 v134, v124, v125
v_cvt_pk_bf16_f32 v135, v126, v127
ds_read_b128 v[80:83], v9 offset:192
ds_read_b128 v[84:87], v9 offset:208
ds_read_b128 v[88:91], v9 offset:2240
ds_read_b128 v[92:95], v9 offset:2256
v_lshlrev_b32 v120, 16, v136
v_and_b32 v121, v96, v136
v_lshlrev_b32 v122, 16, v137
v_and_b32 v123, v96, v137
v_lshlrev_b32 v124, 16, v138
v_and_b32 v125, v96, v138
v_lshlrev_b32 v126, 16, v139
v_and_b32 v127, v96, v139
v_pk_fma_f32 v[120:121], v[120:121], v[116:117], v[118:119]
v_pk_fma_f32 v[122:123], v[122:123], v[116:117], v[118:119]
v_pk_fma_f32 v[124:125], v[124:125], v[116:117], v[118:119]
v_pk_fma_f32 v[126:127], v[126:127], v[116:117], v[118:119]
s_waitcnt lgkmcnt(4)
v_pk_fma_f32 v[120:121], v[120:121], v[64:65], v[72:73]
v_pk_fma_f32 v[122:123], v[122:123], v[66:67], v[74:75]
v_pk_fma_f32 v[124:125], v[124:125], v[68:69], v[76:77]
v_pk_fma_f32 v[126:127], v[126:127], v[70:71], v[78:79]
v_cvt_pk_bf16_f32 v136, v120, v121
v_cvt_pk_bf16_f32 v137, v122, v123
v_cvt_pk_bf16_f32 v138, v124, v125
v_cvt_pk_bf16_f32 v139, v126, v127
ds_read_b128 v[64:67], v9 offset:256
ds_read_b128 v[68:71], v9 offset:272
ds_read_b128 v[72:75], v9 offset:2304
ds_read_b128 v[76:79], v9 offset:2320
v_lshlrev_b32 v120, 16, v140
v_and_b32 v121, v96, v140
v_lshlrev_b32 v122, 16, v141
v_and_b32 v123, v96, v141
v_lshlrev_b32 v124, 16, v142
v_and_b32 v125, v96, v142
v_lshlrev_b32 v126, 16, v143
v_and_b32 v127, v96, v143
v_pk_fma_f32 v[120:121], v[120:121], v[116:117], v[118:119]
v_pk_fma_f32 v[122:123], v[122:123], v[116:117], v[118:119]
v_pk_fma_f32 v[124:125], v[124:125], v[116:117], v[118:119]
v_pk_fma_f32 v[126:127], v[126:127], v[116:117], v[118:119]
s_waitcnt lgkmcnt(4)
v_pk_fma_f32 v[120:121], v[120:121], v[80:81], v[88:89]
v_pk_fma_f32 v[122:123], v[122:123], v[82:83], v[90:91]
v_pk_fma_f32 v[124:125], v[124:125], v[84:85], v[92:93]
v_pk_fma_f32 v[126:127], v[126:127], v[86:87], v[94:95]
s_add_u32 m0, s14, 8192
s_add_u32 s6, s9, 395264
buffer_load_dwordx4 v12, s[52:55], s6 offen lds
v_cvt_pk_bf16_f32 v140, v120, v121
v_cvt_pk_bf16_f32 v141, v122, v123
v_cvt_pk_bf16_f32 v142, v124, v125
v_cvt_pk_bf16_f32 v143, v126, v127
ds_read_b128 v[80:83], v9 offset:320
ds_read_b128 v[84:87], v9 offset:336
ds_read_b128 v[88:91], v9 offset:2368
ds_read_b128 v[92:95], v9 offset:2384
v_lshlrev_b32 v120, 16, v144
v_and_b32 v121, v96, v144
v_lshlrev_b32 v122, 16, v145
v_and_b32 v123, v96, v145
v_lshlrev_b32 v124, 16, v146
v_and_b32 v125, v96, v146
v_lshlrev_b32 v126, 16, v147
v_and_b32 v127, v96, v147
v_pk_fma_f32 v[120:121], v[120:121], v[116:117], v[118:119]
v_pk_fma_f32 v[122:123], v[122:123], v[116:117], v[118:119]
v_pk_fma_f32 v[124:125], v[124:125], v[116:117], v[118:119]
v_pk_fma_f32 v[126:127], v[126:127], v[116:117], v[118:119]
s_waitcnt lgkmcnt(4)
v_pk_fma_f32 v[120:121], v[120:121], v[64:65], v[72:73]
v_pk_fma_f32 v[122:123], v[122:123], v[66:67], v[74:75]
v_pk_fma_f32 v[124:125], v[124:125], v[68:69], v[76:77]
v_pk_fma_f32 v[126:127], v[126:127], v[70:71], v[78:79]
s_add_u32 m0, s14, 9216
s_add_u32 s6, s9, 589824
buffer_load_dwordx4 v12, s[52:55], s6 offen lds
v_cvt_pk_bf16_f32 v144, v120, v121
v_cvt_pk_bf16_f32 v145, v122, v123
v_cvt_pk_bf16_f32 v146, v124, v125
v_cvt_pk_bf16_f32 v147, v126, v127
ds_read_b128 v[64:67], v9 offset:384
ds_read_b128 v[68:71], v9 offset:400
ds_read_b128 v[72:75], v9 offset:2432
ds_read_b128 v[76:79], v9 offset:2448
v_lshlrev_b32 v120, 16, v148
v_and_b32 v121, v96, v148
v_lshlrev_b32 v122, 16, v149
v_and_b32 v123, v96, v149
v_lshlrev_b32 v124, 16, v150
v_and_b32 v125, v96, v150
v_lshlrev_b32 v126, 16, v151
v_and_b32 v127, v96, v151
v_pk_fma_f32 v[120:121], v[120:121], v[116:117], v[118:119]
v_pk_fma_f32 v[122:123], v[122:123], v[116:117], v[118:119]
v_pk_fma_f32 v[124:125], v[124:125], v[116:117], v[118:119]
v_pk_fma_f32 v[126:127], v[126:127], v[116:117], v[118:119]
s_waitcnt lgkmcnt(4)
v_pk_fma_f32 v[120:121], v[120:121], v[80:81], v[88:89]
v_pk_fma_f32 v[122:123], v[122:123], v[82:83], v[90:91]
v_pk_fma_f32 v[124:125], v[124:125], v[84:85], v[92:93]
v_pk_fma_f32 v[126:127], v[126:127], v[86:87], v[94:95]
v_cvt_pk_bf16_f32 v148, v120, v121
v_cvt_pk_bf16_f32 v149, v122, v123
v_cvt_pk_bf16_f32 v150, v124, v125
v_cvt_pk_bf16_f32 v151, v126, v127
ds_read_b128 v[80:83], v9 offset:448
ds_read_b128 v[84:87], v9 offset:464
ds_read_b128 v[88:91], v9 offset:2496
ds_read_b128 v[92:95], v9 offset:2512
v_lshlrev_b32 v120, 16, v152
v_and_b32 v121, v96, v152
v_lshlrev_b32 v122, 16, v153
v_and_b32 v123, v96, v153
v_lshlrev_b32 v124, 16, v154
v_and_b32 v125, v96, v154
v_lshlrev_b32 v126, 16, v155
v_and_b32 v127, v96, v155
v_pk_fma_f32 v[120:121], v[120:121], v[116:117], v[118:119]
v_pk_fma_f32 v[122:123], v[122:123], v[116:117], v[118:119]
v_pk_fma_f32 v[124:125], v[124:125], v[116:117], v[118:119]
v_pk_fma_f32 v[126:127], v[126:127], v[116:117], v[118:119]
s_waitcnt lgkmcnt(4)
v_pk_fma_f32 v[120:121], v[120:121], v[64:65], v[72:73]
v_pk_fma_f32 v[122:123], v[122:123], v[66:67], v[74:75]
v_pk_fma_f32 v[124:125], v[124:125], v[68:69], v[76:77]
v_pk_fma_f32 v[126:127], v[126:127], v[70:71], v[78:79]
s_add_u32 m0, s14, 10240
s_add_u32 s6, s9, 590848
buffer_load_dwordx4 v12, s[52:55], s6 offen lds
v_cvt_pk_bf16_f32 v152, v120, v121
v_cvt_pk_bf16_f32 v153, v122, v123
v_cvt_pk_bf16_f32 v154, v124, v125
v_cvt_pk_bf16_f32 v155, v126, v127
ds_read_b128 v[64:67], v9 offset:512
ds_read_b128 v[68:71], v9 offset:528
ds_read_b128 v[72:75], v9 offset:2560
ds_read_b128 v[76:79], v9 offset:2576
v_lshlrev_b32 v120, 16, v156
v_and_b32 v121, v96, v156
v_lshlrev_b32 v122, 16, v157
v_and_b32 v123, v96, v157
v_lshlrev_b32 v124, 16, v158
v_and_b32 v125, v96, v158
v_lshlrev_b32 v126, 16, v159
v_and_b32 v127, v96, v159
v_pk_fma_f32 v[120:121], v[120:121], v[116:117], v[118:119]
v_pk_fma_f32 v[122:123], v[122:123], v[116:117], v[118:119]
v_pk_fma_f32 v[124:125], v[124:125], v[116:117], v[118:119]
v_pk_fma_f32 v[126:127], v[126:127], v[116:117], v[118:119]
s_waitcnt lgkmcnt(4)
v_pk_fma_f32 v[120:121], v[120:121], v[80:81], v[88:89]
v_pk_fma_f32 v[122:123], v[122:123], v[82:83], v[90:91]
v_pk_fma_f32 v[124:125], v[124:125], v[84:85], v[92:93]
v_pk_fma_f32 v[126:127], v[126:127], v[86:87], v[94:95]
s_add_u32 m0, s14, 11264
s_add_u32 s6, s9, 591872
buffer_load_dwordx4 v12, s[52:55], s6 offen lds
v_cvt_pk_bf16_f32 v156, v120, v121
v_cvt_pk_bf16_f32 v157, v122, v123
v_cvt_pk_bf16_f32 v158, v124, v125
v_cvt_pk_bf16_f32 v159, v126, v127
ds_read_b128 v[80:83], v9 offset:576
ds_read_b128 v[84:87], v9 offset:592
ds_read_b128 v[88:91], v9 offset:2624
ds_read_b128 v[92:95], v9 offset:2640
v_lshlrev_b32 v120, 16, v160
v_and_b32 v121, v96, v160
v_lshlrev_b32 v122, 16, v161
v_and_b32 v123, v96, v161
v_lshlrev_b32 v124, 16, v162
v_and_b32 v125, v96, v162
v_lshlrev_b32 v126, 16, v163
v_and_b32 v127, v96, v163
v_pk_fma_f32 v[120:121], v[120:121], v[116:117], v[118:119]
v_pk_fma_f32 v[122:123], v[122:123], v[116:117], v[118:119]
v_pk_fma_f32 v[124:125], v[124:125], v[116:117], v[118:119]
v_pk_fma_f32 v[126:127], v[126:127], v[116:117], v[118:119]
s_waitcnt lgkmcnt(4)
v_pk_fma_f32 v[120:121], v[120:121], v[64:65], v[72:73]
v_pk_fma_f32 v[122:123], v[122:123], v[66:67], v[74:75]
v_pk_fma_f32 v[124:125], v[124:125], v[68:69], v[76:77]
v_pk_fma_f32 v[126:127], v[126:127], v[70:71], v[78:79]
v_cvt_pk_bf16_f32 v160, v120, v121
v_cvt_pk_bf16_f32 v161, v122, v123
v_cvt_pk_bf16_f32 v162, v124, v125
v_cvt_pk_bf16_f32 v163, v126, v127
ds_read_b128 v[64:67], v9 offset:640
ds_read_b128 v[68:71], v9 offset:656
ds_read_b128 v[72:75], v9 offset:2688
ds_read_b128 v[76:79], v9 offset:2704
v_lshlrev_b32 v120, 16, v164
v_and_b32 v121, v96, v164
v_lshlrev_b32 v122, 16, v165
v_and_b32 v123, v96, v165
v_lshlrev_b32 v124, 16, v166
v_and_b32 v125, v96, v166
v_lshlrev_b32 v126, 16, v167
v_and_b32 v127, v96, v167
v_pk_fma_f32 v[120:121], v[120:121], v[116:117], v[118:119]
v_pk_fma_f32 v[122:123], v[122:123], v[116:117], v[118:119]
v_pk_fma_f32 v[124:125], v[124:125], v[116:117], v[118:119]
v_pk_fma_f32 v[126:127], v[126:127], v[116:117], v[118:119]
s_waitcnt lgkmcnt(4)
v_pk_fma_f32 v[120:121], v[120:121], v[80:81], v[88:89]
v_pk_fma_f32 v[122:123], v[122:123], v[82:83], v[90:91]
v_pk_fma_f32 v[124:125], v[124:125], v[84:85], v[92:93]
v_pk_fma_f32 v[126:127], v[126:127], v[86:87], v[94:95]
s_add_u32 m0, s14, 12288
s_add_u32 s6, s9, 786432
buffer_load_dwordx4 v12, s[52:55], s6 offen lds
v_cvt_pk_bf16_f32 v164, v120, v121
v_cvt_pk_bf16_f32 v165, v122, v123
v_cvt_pk_bf16_f32 v166, v124, v125
v_cvt_pk_bf16_f32 v167, v126, v127
ds_read_b128 v[80:83], v9 offset:704
ds_read_b128 v[84:87], v9 offset:720
ds_read_b128 v[88:91], v9 offset:2752
ds_read_b128 v[92:95], v9 offset:2768
v_lshlrev_b32 v120, 16, v168
v_and_b32 v121, v96, v168
v_lshlrev_b32 v122, 16, v169
v_and_b32 v123, v96, v169
v_lshlrev_b32 v124, 16, v170
v_and_b32 v125, v96, v170
v_lshlrev_b32 v126, 16, v171
v_and_b32 v127, v96, v171
v_pk_fma_f32 v[120:121], v[120:121], v[116:117], v[118:119]
v_pk_fma_f32 v[122:123], v[122:123], v[116:117], v[118:119]
v_pk_fma_f32 v[124:125], v[124:125], v[116:117], v[118:119]
v_pk_fma_f32 v[126:127], v[126:127], v[116:117], v[118:119]
s_waitcnt lgkmcnt(4)
v_pk_fma_f32 v[120:121], v[120:121], v[64:65], v[72:73]
v_pk_fma_f32 v[122:123], v[122:123], v[66:67], v[74:75]
v_pk_fma_f32 v[124:125], v[124:125], v[68:69], v[76:77]
v_pk_fma_f32 v[126:127], v[126:127], v[70:71], v[78:79]
s_add_u32 m0, s14, 13312
s_add_u32 s6, s9, 787456
buffer_load_dwordx4 v12, s[52:55], s6 offen lds
v_cvt_pk_bf16_f32 v168, v120, v121
v_cvt_pk_bf16_f32 v169, v122, v123
v_cvt_pk_bf16_f32 v170, v124, v125
v_cvt_pk_bf16_f32 v171, v126, v127
ds_read_b128 v[64:67], v9 offset:768
ds_read_b128 v[68:71], v9 offset:784
ds_read_b128 v[72:75], v9 offset:2816
ds_read_b128 v[76:79], v9 offset:2832
v_lshlrev_b32 v120, 16, v172
v_and_b32 v121, v96, v172
v_lshlrev_b32 v122, 16, v173
v_and_b32 v123, v96, v173
v_lshlrev_b32 v124, 16, v174
v_and_b32 v125, v96, v174
v_lshlrev_b32 v126, 16, v175
v_and_b32 v127, v96, v175
v_pk_fma_f32 v[120:121], v[120:121], v[116:117], v[118:119]
v_pk_fma_f32 v[122:123], v[122:123], v[116:117], v[118:119]
v_pk_fma_f32 v[124:125], v[124:125], v[116:117], v[118:119]
v_pk_fma_f32 v[126:127], v[126:127], v[116:117], v[118:119]
s_waitcnt lgkmcnt(4)
v_pk_fma_f32 v[120:121], v[120:121], v[80:81], v[88:89]
v_pk_fma_f32 v[122:123], v[122:123], v[82:83], v[90:91]
v_pk_fma_f32 v[124:125], v[124:125], v[84:85], v[92:93]
v_pk_fma_f32 v[126:127], v[126:127], v[86:87], v[94:95]
v_cvt_pk_bf16_f32 v172, v120, v121
v_cvt_pk_bf16_f32 v173, v122, v123
v_cvt_pk_bf16_f32 v174, v124, v125
v_cvt_pk_bf16_f32 v175, v126, v127
ds_read_b128 v[80:83], v9 offset:832
ds_read_b128 v[84:87], v9 offset:848
ds_read_b128 v[88:91], v9 offset:2880
ds_read_b128 v[92:95], v9 offset:2896
v_lshlrev_b32 v120, 16, v176
v_and_b32 v121, v96, v176
v_lshlrev_b32 v122, 16, v177
v_and_b32 v123, v96, v177
v_lshlrev_b32 v124, 16, v178
v_and_b32 v125, v96, v178
v_lshlrev_b32 v126, 16, v179
v_and_b32 v127, v96, v179
v_pk_fma_f32 v[120:121], v[120:121], v[116:117], v[118:119]
v_pk_fma_f32 v[122:123], v[122:123], v[116:117], v[118:119]
v_pk_fma_f32 v[124:125], v[124:125], v[116:117], v[118:119]
v_pk_fma_f32 v[126:127], v[126:127], v[116:117], v[118:119]
s_waitcnt lgkmcnt(4)
v_pk_fma_f32 v[120:121], v[120:121], v[64:65], v[72:73]
v_pk_fma_f32 v[122:123], v[122:123], v[66:67], v[74:75]
v_pk_fma_f32 v[124:125], v[124:125], v[68:69], v[76:77]
v_pk_fma_f32 v[126:127], v[126:127], v[70:71], v[78:79]
s_add_u32 m0, s14, 14336
s_add_u32 s6, s9, 788480
buffer_load_dwordx4 v12, s[52:55], s6 offen lds
v_cvt_pk_bf16_f32 v176, v120, v121
v_cvt_pk_bf16_f32 v177, v122, v123
v_cvt_pk_bf16_f32 v178, v124, v125
v_cvt_pk_bf16_f32 v179, v126, v127
ds_read_b128 v[64:67], v9 offset:896
ds_read_b128 v[68:71], v9 offset:912
ds_read_b128 v[72:75], v9 offset:2944
ds_read_b128 v[76:79], v9 offset:2960
v_lshlrev_b32 v120, 16, v180
v_and_b32 v121, v96, v180
v_lshlrev_b32 v122, 16, v181
v_and_b32 v123, v96, v181
v_lshlrev_b32 v124, 16, v182
v_and_b32 v125, v96, v182
v_lshlrev_b32 v126, 16, v183
v_and_b32 v127, v96, v183
v_pk_fma_f32 v[120:121], v[120:121], v[116:117], v[118:119]
v_pk_fma_f32 v[122:123], v[122:123], v[116:117], v[118:119]
v_pk_fma_f32 v[124:125], v[124:125], v[116:117], v[118:119]
v_pk_fma_f32 v[126:127], v[126:127], v[116:117], v[118:119]
s_waitcnt lgkmcnt(4)
v_pk_fma_f32 v[120:121], v[120:121], v[80:81], v[88:89]
v_pk_fma_f32 v[122:123], v[122:123], v[82:83], v[90:91]
v_pk_fma_f32 v[124:125], v[124:125], v[84:85], v[92:93]
v_pk_fma_f32 v[126:127], v[126:127], v[86:87], v[94:95]
s_add_u32 m0, s14, 15360
s_add_u32 s6, s9, 983040
buffer_load_dwordx4 v12, s[52:55], s6 offen lds
v_cvt_pk_bf16_f32 v180, v120, v121
v_cvt_pk_bf16_f32 v181, v122, v123
v_cvt_pk_bf16_f32 v182, v124, v125
v_cvt_pk_bf16_f32 v183, v126, v127
ds_read_b128 v[80:83], v9 offset:960
ds_read_b128 v[84:87], v9 offset:976
ds_read_b128 v[88:91], v9 offset:3008
ds_read_b128 v[92:95], v9 offset:3024
v_lshlrev_b32 v120, 16, v184
v_and_b32 v121, v96, v184
v_lshlrev_b32 v122, 16, v185
v_and_b32 v123, v96, v185
v_lshlrev_b32 v124, 16, v186
v_and_b32 v125, v96, v186
v_lshlrev_b32 v126, 16, v187
v_and_b32 v127, v96, v187
v_pk_fma_f32 v[120:121], v[120:121], v[116:117], v[118:119]
v_pk_fma_f32 v[122:123], v[122:123], v[116:117], v[118:119]
v_pk_fma_f32 v[124:125], v[124:125], v[116:117], v[118:119]
v_pk_fma_f32 v[126:127], v[126:127], v[116:117], v[118:119]
s_waitcnt lgkmcnt(4)
v_pk_fma_f32 v[120:121], v[120:121], v[64:65], v[72:73]
v_pk_fma_f32 v[122:123], v[122:123], v[66:67], v[74:75]
v_pk_fma_f32 v[124:125], v[124:125], v[68:69], v[76:77]
v_pk_fma_f32 v[126:127], v[126:127], v[70:71], v[78:79]
v_cvt_pk_bf16_f32 v184, v120, v121
v_cvt_pk_bf16_f32 v185, v122, v123
v_cvt_pk_bf16_f32 v186, v124, v125
v_cvt_pk_bf16_f32 v187, v126, v127
ds_read_b128 v[64:67], v9 offset:1024
ds_read_b128 v[68:71], v9 offset:1040
ds_read_b128 v[72:75], v9 offset:3072
ds_read_b128 v[76:79], v9 offset:3088
v_lshlrev_b32 v120, 16, v188
v_and_b32 v121, v96, v188
v_lshlrev_b32 v122, 16, v189
v_and_b32 v123, v96, v189
v_lshlrev_b32 v124, 16, v190
v_and_b32 v125, v96, v190
v_lshlrev_b32 v126, 16, v191
v_and_b32 v127, v96, v191
v_pk_fma_f32 v[120:121], v[120:121], v[116:117], v[118:119]
v_pk_fma_f32 v[122:123], v[122:123], v[116:117], v[118:119]
v_pk_fma_f32 v[124:125], v[124:125], v[116:117], v[118:119]
v_pk_fma_f32 v[126:127], v[126:127], v[116:117], v[118:119]
s_waitcnt lgkmcnt(4)
v_pk_fma_f32 v[120:121], v[120:121], v[80:81], v[88:89]
v_pk_fma_f32 v[122:123], v[122:123], v[82:83], v[90:91]
v_pk_fma_f32 v[124:125], v[124:125], v[84:85], v[92:93]
v_pk_fma_f32 v[126:127], v[126:127], v[86:87], v[94:95]
s_add_u32 m0, s14, 16384
s_add_u32 s6, s9, 984064
buffer_load_dwordx4 v12, s[52:55], s6 offen lds
v_cvt_pk_bf16_f32 v188, v120, v121
v_cvt_pk_bf16_f32 v189, v122, v123
v_cvt_pk_bf16_f32 v190, v124, v125
v_cvt_pk_bf16_f32 v191, v126, v127
ds_read_b128 v[80:83], v9 offset:1088
ds_read_b128 v[84:87], v9 offset:1104
ds_read_b128 v[88:91], v9 offset:3136
ds_read_b128 v[92:95], v9 offset:3152
v_lshlrev_b32 v120, 16, v192
v_and_b32 v121, v96, v192
v_lshlrev_b32 v122, 16, v193
v_and_b32 v123, v96, v193
v_lshlrev_b32 v124, 16, v194
v_and_b32 v125, v96, v194
v_lshlrev_b32 v126, 16, v195
v_and_b32 v127, v96, v195
v_pk_fma_f32 v[120:121], v[120:121], v[116:117], v[118:119]
v_pk_fma_f32 v[122:123], v[122:123], v[116:117], v[118:119]
v_pk_fma_f32 v[124:125], v[124:125], v[116:117], v[118:119]
v_pk_fma_f32 v[126:127], v[126:127], v[116:117], v[118:119]
s_waitcnt lgkmcnt(4)
v_pk_fma_f32 v[120:121], v[120:121], v[64:65], v[72:73]
v_pk_fma_f32 v[122:123], v[122:123], v[66:67], v[74:75]
v_pk_fma_f32 v[124:125], v[124:125], v[68:69], v[76:77]
v_pk_fma_f32 v[126:127], v[126:127], v[70:71], v[78:79]
s_add_u32 m0, s14, 17408
s_add_u32 s6, s9, 985088
buffer_load_dwordx4 v12, s[52:55], s6 offen lds
v_cvt_pk_bf16_f32 v192, v120, v121
v_cvt_pk_bf16_f32 v193, v122, v123
v_cvt_pk_bf16_f32 v194, v124, v125
v_cvt_pk_bf16_f32 v195, v126, v127
ds_read_b128 v[64:67], v9 offset:1152
ds_read_b128 v[68:71], v9 offset:1168
ds_read_b128 v[72:75], v9 offset:3200
ds_read_b128 v[76:79], v9 offset:3216
v_lshlrev_b32 v120, 16, v196
v_and_b32 v121, v96, v196
v_lshlrev_b32 v122, 16, v197
v_and_b32 v123, v96, v197
v_lshlrev_b32 v124, 16, v198
v_and_b32 v125, v96, v198
v_lshlrev_b32 v126, 16, v199
v_and_b32 v127, v96, v199
v_pk_fma_f32 v[120:121], v[120:121], v[116:117], v[118:119]
v_pk_fma_f32 v[122:123], v[122:123], v[116:117], v[118:119]
v_pk_fma_f32 v[124:125], v[124:125], v[116:117], v[118:119]
v_pk_fma_f32 v[126:127], v[126:127], v[116:117], v[118:119]
s_waitcnt lgkmcnt(4)
v_pk_fma_f32 v[120:121], v[120:121], v[80:81], v[88:89]
v_pk_fma_f32 v[122:123], v[122:123], v[82:83], v[90:91]
v_pk_fma_f32 v[124:125], v[124:125], v[84:85], v[92:93]
v_pk_fma_f32 v[126:127], v[126:127], v[86:87], v[94:95]
v_cvt_pk_bf16_f32 v196, v120, v121
v_cvt_pk_bf16_f32 v197, v122, v123
v_cvt_pk_bf16_f32 v198, v124, v125
v_cvt_pk_bf16_f32 v199, v126, v127
ds_read_b128 v[80:83], v9 offset:1216
ds_read_b128 v[84:87], v9 offset:1232
ds_read_b128 v[88:91], v9 offset:3264
ds_read_b128 v[92:95], v9 offset:3280
v_lshlrev_b32 v120, 16, v200
v_and_b32 v121, v96, v200
v_lshlrev_b32 v122, 16, v201
v_and_b32 v123, v96, v201
v_lshlrev_b32 v124, 16, v202
v_and_b32 v125, v96, v202
v_lshlrev_b32 v126, 16, v203
v_and_b32 v127, v96, v203
v_pk_fma_f32 v[120:121], v[120:121], v[116:117], v[118:119]
v_pk_fma_f32 v[122:123], v[122:123], v[116:117], v[118:119]
v_pk_fma_f32 v[124:125], v[124:125], v[116:117], v[118:119]
v_pk_fma_f32 v[126:127], v[126:127], v[116:117], v[118:119]
s_waitcnt lgkmcnt(4)
v_pk_fma_f32 v[120:121], v[120:121], v[64:65], v[72:73]
v_pk_fma_f32 v[122:123], v[122:123], v[66:67], v[74:75]
v_pk_fma_f32 v[124:125], v[124:125], v[68:69], v[76:77]
v_pk_fma_f32 v[126:127], v[126:127], v[70:71], v[78:79]
s_add_u32 m0, s14, 18432
s_add_u32 s6, s9, 1179648
buffer_load_dwordx4 v12, s[52:55], s6 offen lds
v_cvt_pk_bf16_f32 v200, v120, v121
v_cvt_pk_bf16_f32 v201, v122, v123
v_cvt_pk_bf16_f32 v202, v124, v125
v_cvt_pk_bf16_f32 v203, v126, v127
ds_read_b128 v[64:67], v9 offset:1280
ds_read_b128 v[68:71], v9 offset:1296
ds_read_b128 v[72:75], v9 offset:3328
ds_read_b128 v[76:79], v9 offset:3344
v_lshlrev_b32 v120, 16, v204
v_and_b32 v121, v96, v204
v_lshlrev_b32 v122, 16, v205
v_and_b32 v123, v96, v205
v_lshlrev_b32 v124, 16, v206
v_and_b32 v125, v96, v206
v_lshlrev_b32 v126, 16, v207
v_and_b32 v127, v96, v207
v_pk_fma_f32 v[120:121], v[120:121], v[116:117], v[118:119]
v_pk_fma_f32 v[122:123], v[122:123], v[116:117], v[118:119]
v_pk_fma_f32 v[124:125], v[124:125], v[116:117], v[118:119]
v_pk_fma_f32 v[126:127], v[126:127], v[116:117], v[118:119]
s_waitcnt lgkmcnt(4)
v_pk_fma_f32 v[120:121], v[120:121], v[80:81], v[88:89]
v_pk_fma_f32 v[122:123], v[122:123], v[82:83], v[90:91]
v_pk_fma_f32 v[124:125], v[124:125], v[84:85], v[92:93]
v_pk_fma_f32 v[126:127], v[126:127], v[86:87], v[94:95]
s_add_u32 m0, s14, 19456
s_add_u32 s6, s9, 1180672
buffer_load_dwordx4 v12, s[52:55], s6 offen lds
v_cvt_pk_bf16_f32 v204, v120, v121
v_cvt_pk_bf16_f32 v205, v122, v123
v_cvt_pk_bf16_f32 v206, v124, v125
v_cvt_pk_bf16_f32 v207, v126, v127
ds_read_b128 v[80:83], v9 offset:1344
ds_read_b128 v[84:87], v9 offset:1360
ds_read_b128 v[88:91], v9 offset:3392
ds_read_b128 v[92:95], v9 offset:3408
v_lshlrev_b32 v120, 16, v208
v_and_b32 v121, v96, v208
v_lshlrev_b32 v122, 16, v209
v_and_b32 v123, v96, v209
v_lshlrev_b32 v124, 16, v210
v_and_b32 v125, v96, v210
v_lshlrev_b32 v126, 16, v211
v_and_b32 v127, v96, v211
v_pk_fma_f32 v[120:121], v[120:121], v[116:117], v[118:119]
v_pk_fma_f32 v[122:123], v[122:123], v[116:117], v[118:119]
v_pk_fma_f32 v[124:125], v[124:125], v[116:117], v[118:119]
v_pk_fma_f32 v[126:127], v[126:127], v[116:117], v[118:119]
s_waitcnt lgkmcnt(4)
v_pk_fma_f32 v[120:121], v[120:121], v[64:65], v[72:73]
v_pk_fma_f32 v[122:123], v[122:123], v[66:67], v[74:75]
v_pk_fma_f32 v[124:125], v[124:125], v[68:69], v[76:77]
v_pk_fma_f32 v[126:127], v[126:127], v[70:71], v[78:79]
v_cvt_pk_bf16_f32 v208, v120, v121
v_cvt_pk_bf16_f32 v209, v122, v123
v_cvt_pk_bf16_f32 v210, v124, v125
v_cvt_pk_bf16_f32 v211, v126, v127
ds_read_b128 v[64:67], v9 offset:1408
ds_read_b128 v[68:71], v9 offset:1424
ds_read_b128 v[72:75], v9 offset:3456
ds_read_b128 v[76:79], v9 offset:3472
v_lshlrev_b32 v120, 16, v212
v_and_b32 v121, v96, v212
v_lshlrev_b32 v122, 16, v213
v_and_b32 v123, v96, v213
v_lshlrev_b32 v124, 16, v214
v_and_b32 v125, v96, v214
v_lshlrev_b32 v126, 16, v215
v_and_b32 v127, v96, v215
v_pk_fma_f32 v[120:121], v[120:121], v[116:117], v[118:119]
v_pk_fma_f32 v[122:123], v[122:123], v[116:117], v[118:119]
v_pk_fma_f32 v[124:125], v[124:125], v[116:117], v[118:119]
v_pk_fma_f32 v[126:127], v[126:127], v[116:117], v[118:119]
s_waitcnt lgkmcnt(4)
v_pk_fma_f32 v[120:121], v[120:121], v[80:81], v[88:89]
v_pk_fma_f32 v[122:123], v[122:123], v[82:83], v[90:91]
v_pk_fma_f32 v[124:125], v[124:125], v[84:85], v[92:93]
v_pk_fma_f32 v[126:127], v[126:127], v[86:87], v[94:95]
s_add_u32 m0, s14, 20480
s_add_u32 s6, s9, 1181696
buffer_load_dwordx4 v12, s[52:55], s6 offen lds
v_cvt_pk_bf16_f32 v212, v120, v121
v_cvt_pk_bf16_f32 v213, v122, v123
v_cvt_pk_bf16_f32 v214, v124, v125
v_cvt_pk_bf16_f32 v215, v126, v127
ds_read_b128 v[80:83], v9 offset:1472
ds_read_b128 v[84:87], v9 offset:1488
ds_read_b128 v[88:91], v9 offset:3520
ds_read_b128 v[92:95], v9 offset:3536
v_lshlrev_b32 v120, 16, v216
v_and_b32 v121, v96, v216
v_lshlrev_b32 v122, 16, v217
v_and_b32 v123, v96, v217
v_lshlrev_b32 v124, 16, v218
v_and_b32 v125, v96, v218
v_lshlrev_b32 v126, 16, v219
v_and_b32 v127, v96, v219
v_pk_fma_f32 v[120:121], v[120:121], v[116:117], v[118:119]
v_pk_fma_f32 v[122:123], v[122:123], v[116:117], v[118:119]
v_pk_fma_f32 v[124:125], v[124:125], v[116:117], v[118:119]
v_pk_fma_f32 v[126:127], v[126:127], v[116:117], v[118:119]
s_waitcnt lgkmcnt(4)
v_pk_fma_f32 v[120:121], v[120:121], v[64:65], v[72:73]
v_pk_fma_f32 v[122:123], v[122:123], v[66:67], v[74:75]
v_pk_fma_f32 v[124:125], v[124:125], v[68:69], v[76:77]
v_pk_fma_f32 v[126:127], v[126:127], v[70:71], v[78:79]
s_add_u32 m0, s14, 21504
s_add_u32 s6, s9, 1376256
buffer_load_dwordx4 v12, s[52:55], s6 offen lds
v_cvt_pk_bf16_f32 v216, v120, v121
v_cvt_pk_bf16_f32 v217, v122, v123
v_cvt_pk_bf16_f32 v218, v124, v125
v_cvt_pk_bf16_f32 v219, v126, v127
ds_read_b128 v[64:67], v9 offset:1536
ds_read_b128 v[68:71], v9 offset:1552
ds_read_b128 v[72:75], v9 offset:3584
ds_read_b128 v[76:79], v9 offset:3600
v_lshlrev_b32 v120, 16, v220
v_and_b32 v121, v96, v220
v_lshlrev_b32 v122, 16, v221
v_and_b32 v123, v96, v221
v_lshlrev_b32 v124, 16, v222
v_and_b32 v125, v96, v222
v_lshlrev_b32 v126, 16, v223
v_and_b32 v127, v96, v223
v_pk_fma_f32 v[120:121], v[120:121], v[116:117], v[118:119]
v_pk_fma_f32 v[122:123], v[122:123], v[116:117], v[118:119]
v_pk_fma_f32 v[124:125], v[124:125], v[116:117], v[118:119]
v_pk_fma_f32 v[126:127], v[126:127], v[116:117], v[118:119]
s_waitcnt lgkmcnt(4)
v_pk_fma_f32 v[120:121], v[120:121], v[80:81], v[88:89]
v_pk_fma_f32 v[122:123], v[122:123], v[82:83], v[90:91]
v_pk_fma_f32 v[124:125], v[124:125], v[84:85], v[92:93]
v_pk_fma_f32 v[126:127], v[126:127], v[86:87], v[94:95]
v_cvt_pk_bf16_f32 v220, v120, v121
v_cvt_pk_bf16_f32 v221, v122, v123
v_cvt_pk_bf16_f32 v222, v124, v125
v_cvt_pk_bf16_f32 v223, v126, v127
ds_read_b128 v[80:83], v9 offset:1600
ds_read_b128 v[84:87], v9 offset:1616
ds_read_b128 v[88:91], v9 offset:3648
ds_read_b128 v[92:95], v9 offset:3664
v_lshlrev_b32 v120, 16, v224
v_and_b32 v121, v96, v224
v_lshlrev_b32 v122, 16, v225
v_and_b32 v123, v96, v225
v_lshlrev_b32 v124, 16, v226
v_and_b32 v125, v96, v226
v_lshlrev_b32 v126, 16, v227
v_and_b32 v127, v96, v227
v_pk_fma_f32 v[120:121], v[120:121], v[116:117], v[118:119]
v_pk_fma_f32 v[122:123], v[122:123], v[116:117], v[118:119]
v_pk_fma_f32 v[124:125], v[124:125], v[116:117], v[118:119]
v_pk_fma_f32 v[126:127], v[126:127], v[116:117], v[118:119]
s_waitcnt lgkmcnt(4)
v_pk_fma_f32 v[120:121], v[120:121], v[64:65], v[72:73]
v_pk_fma_f32 v[122:123], v[122:123], v[66:67], v[74:75]
v_pk_fma_f32 v[124:125], v[124:125], v[68:69], v[76:77]
v_pk_fma_f32 v[126:127], v[126:127], v[70:71], v[78:79]
s_add_u32 m0, s14, 22528
s_add_u32 s6, s9, 1377280
buffer_load_dwordx4 v12, s[52:55], s6 offen lds
v_cvt_pk_bf16_f32 v224, v120, v121
v_cvt_pk_bf16_f32 v225, v122, v123
v_cvt_pk_bf16_f32 v226, v124, v125
v_cvt_pk_bf16_f32 v227, v126, v127
ds_read_b128 v[64:67], v9 offset:1664
ds_read_b128 v[68:71], v9 offset:1680
ds_read_b128 v[72:75], v9 offset:3712
ds_read_b128 v[76:79], v9 offset:3728
v_lshlrev_b32 v120, 16, v228
v_and_b32 v121, v96, v228
v_lshlrev_b32 v122, 16, v229
v_and_b32 v123, v96, v229
v_lshlrev_b32 v124, 16, v230
v_and_b32 v125, v96, v230
v_lshlrev_b32 v126, 16, v231
v_and_b32 v127, v96, v231
v_pk_fma_f32 v[120:121], v[120:121], v[116:117], v[118:119]
v_pk_fma_f32 v[122:123], v[122:123], v[116:117], v[118:119]
v_pk_fma_f32 v[124:125], v[124:125], v[116:117], v[118:119]
v_pk_fma_f32 v[126:127], v[126:127], v[116:117], v[118:119]
s_waitcnt lgkmcnt(4)
v_pk_fma_f32 v[120:121], v[120:121], v[80:81], v[88:89]
v_pk_fma_f32 v[122:123], v[122:123], v[82:83], v[90:91]
v_pk_fma_f32 v[124:125], v[124:125], v[84:85], v[92:93]
v_pk_fma_f32 v[126:127], v[126:127], v[86:87], v[94:95]
s_add_u32 m0, s14, 23552
s_add_u32 s6, s9, 1378304
buffer_load_dwordx4 v12, s[52:55], s6 offen lds
v_cvt_pk_bf16_f32 v228, v120, v121
v_cvt_pk_bf16_f32 v229, v122, v123
v_cvt_pk_bf16_f32 v230, v124, v125
v_cvt_pk_bf16_f32 v231, v126, v127
ds_read_b128 v[80:83], v9 offset:1728
ds_read_b128 v[84:87], v9 offset:1744
ds_read_b128 v[88:91], v9 offset:3776
ds_read_b128 v[92:95], v9 offset:3792
v_lshlrev_b32 v120, 16, v232
v_and_b32 v121, v96, v232
v_lshlrev_b32 v122, 16, v233
v_and_b32 v123, v96, v233
v_lshlrev_b32 v124, 16, v234
v_and_b32 v125, v96, v234
v_lshlrev_b32 v126, 16, v235
v_and_b32 v127, v96, v235
v_pk_fma_f32 v[120:121], v[120:121], v[116:117], v[118:119]
v_pk_fma_f32 v[122:123], v[122:123], v[116:117], v[118:119]
v_pk_fma_f32 v[124:125], v[124:125], v[116:117], v[118:119]
v_pk_fma_f32 v[126:127], v[126:127], v[116:117], v[118:119]
s_waitcnt lgkmcnt(4)
v_pk_fma_f32 v[120:121], v[120:121], v[64:65], v[72:73]
v_pk_fma_f32 v[122:123], v[122:123], v[66:67], v[74:75]
v_pk_fma_f32 v[124:125], v[124:125], v[68:69], v[76:77]
v_pk_fma_f32 v[126:127], v[126:127], v[70:71], v[78:79]
v_cvt_pk_bf16_f32 v232, v120, v121
v_cvt_pk_bf16_f32 v233, v122, v123
v_cvt_pk_bf16_f32 v234, v124, v125
v_cvt_pk_bf16_f32 v235, v126, v127
s_lshl_b32 s13, s2, 2
s_add_u32 s13, s13, s43
s_and_b32 s4, s13, 31
s_mul_i32 s12, s4, 44032
s_mul_i32 s15, s43, 3072
s_add_u32 s15, s15, 143360
v_lshrrev_b32 v97, 2, v0
v_mul_u32_u24 v97, 2752, v97
v_and_b32 v15, 3, v0
v_lshl_add_u32 v97, v15, 4, v97
s_lshr_b32 s4, s13, 5
s_add_u32 s4, s4, 0
s_cmp_lt_u32 s4, 43
s_cselect_b32 s88, s60, s64
s_cselect_b32 s89, s61, s65
s_cselect_b32 s5, 0, 43
s_mov_b32 s90, s62
s_mov_b32 s91, 0x20000
s_sub_u32 s4, s4, s5
s_min_u32 s4, s4, 42
s_lshl_b32 s4, s4, 6
s_add_u32 s6, s12, s4
s_add_u32 m0, s15, 0
s_nop 0
buffer_load_dwordx4 v97, s[88:91], s6 offen lds
ds_read_b128 v[64:67], v9 offset:1792
ds_read_b128 v[68:71], v9 offset:1808
ds_read_b128 v[72:75], v9 offset:3840
ds_read_b128 v[76:79], v9 offset:3856
v_lshlrev_b32 v120, 16, v236
v_and_b32 v121, v96, v236
v_lshlrev_b32 v122, 16, v237
v_and_b32 v123, v96, v237
v_lshlrev_b32 v124, 16, v238
v_and_b32 v125, v96, v238
v_lshlrev_b32 v126, 16, v239
v_and_b32 v127, v96, v239
v_pk_fma_f32 v[120:121], v[120:121], v[116:117], v[118:119]
v_pk_fma_f32 v[122:123], v[122:123], v[116:117], v[118:119]
v_pk_fma_f32 v[124:125], v[124:125], v[116:117], v[118:119]
v_pk_fma_f32 v[126:127], v[126:127], v[116:117], v[118:119]
s_waitcnt lgkmcnt(4)
v_pk_fma_f32 v[120:121], v[120:121], v[80:81], v[88:89]
v_pk_fma_f32 v[122:123], v[122:123], v[82:83], v[90:91]
v_pk_fma_f32 v[124:125], v[124:125], v[84:85], v[92:93]
v_pk_fma_f32 v[126:127], v[126:127], v[86:87], v[94:95]
v_cvt_pk_bf16_f32 v236, v120, v121
v_cvt_pk_bf16_f32 v237, v122, v123
v_cvt_pk_bf16_f32 v238, v124, v125
v_cvt_pk_bf16_f32 v239, v126, v127
s_lshr_b32 s4, s13, 5
s_add_u32 s4, s4, 32
s_cmp_lt_u32 s4, 43
s_cselect_b32 s88, s60, s64
s_cselect_b32 s89, s61, s65
s_cselect_b32 s5, 0, 43
s_mov_b32 s90, s62
s_mov_b32 s91, 0x20000
s_sub_u32 s4, s4, s5
s_min_u32 s4, s4, 42
s_lshl_b32 s4, s4, 6
s_add_u32 s6, s12, s4
s_add_u32 m0, s15, 1024
s_nop 0
buffer_load_dwordx4 v97, s[88:91], s6 offen lds
s_add_u32 s96, s96, 2048
v_accvgpr_read_b32 v8, a251
s_cmp_lg_u32 s43, 0
s_cbranch_scc1 nw_5
buffer_load_dwordx4 a[240:243], v8, s[76:79], s96 offen offset:0
buffer_load_dwordx4 a[244:247], v8, s[76:79], s96 offen offset:2048
nw_5:
ds_read_b128 v[80:83], v9 offset:1856
ds_read_b128 v[84:87], v9 offset:1872
ds_read_b128 v[88:91], v9 offset:3904
ds_read_b128 v[92:95], v9 offset:3920
v_lshlrev_b32 v120, 16, v240
v_and_b32 v121, v96, v240
v_lshlrev_b32 v122, 16, v241
v_and_b32 v123, v96, v241
v_lshlrev_b32 v124, 16, v242
v_and_b32 v125, v96, v242
v_lshlrev_b32 v126, 16, v243
v_and_b32 v127, v96, v243
v_pk_fma_f32 v[120:121], v[120:121], v[116:117], v[118:119]
v_pk_fma_f32 v[122:123], v[122:123], v[116:117], v[118:119]
v_pk_fma_f32 v[124:125], v[124:125], v[116:117], v[118:119]
v_pk_fma_f32 v[126:127], v[126:127], v[116:117], v[118:119]
s_waitcnt lgkmcnt(4)
v_pk_fma_f32 v[120:121], v[120:121], v[64:65], v[72:73]
v_pk_fma_f32 v[122:123], v[122:123], v[66:67], v[74:75]
v_pk_fma_f32 v[124:125], v[124:125], v[68:69], v[76:77]
v_pk_fma_f32 v[126:127], v[126:127], v[70:71], v[78:79]
v_cvt_pk_bf16_f32 v240, v120, v121
v_cvt_pk_bf16_f32 v241, v122, v123
v_cvt_pk_bf16_f32 v242, v124, v125
v_cvt_pk_bf16_f32 v243, v126, v127
s_lshr_b32 s4, s13, 5
s_add_u32 s4, s4, 64
s_cmp_lt_u32 s4, 43
s_cselect_b32 s88, s60, s64
s_cselect_b32 s89, s61, s65
s_cselect_b32 s5, 0, 43
s_mov_b32 s90, s62
s_mov_b32 s91, 0x20000
s_sub_u32 s4, s4, s5
s_min_u32 s4, s4, 42
s_lshl_b32 s4, s4, 6
s_add_u32 s6, s12, s4
s_add_u32 m0, s15, 2048
s_nop 0
buffer_load_dwordx4 v97, s[88:91], s6 offen lds
s_cmp_lg_u32 s43, 1
s_cbranch_scc1 nw_6
buffer_load_dwordx4 a[240:243], v8, s[76:79], s96 offen offset:0
buffer_load_dwordx4 a[244:247], v8, s[76:79], s96 offen offset:2048
nw_6:
ds_read_b128 v[64:67], v9 offset:1920
ds_read_b128 v[68:71], v9 offset:1936
ds_read_b128 v[72:75], v9 offset:3968
ds_read_b128 v[76:79], v9 offset:3984
v_lshlrev_b32 v120, 16, v244
v_and_b32 v121, v96, v244
v_lshlrev_b32 v122, 16, v245
v_and_b32 v123, v96, v245
v_lshlrev_b32 v124, 16, v246
v_and_b32 v125, v96, v246
v_lshlrev_b32 v126, 16, v247
v_and_b32 v127, v96, v247
v_pk_fma_f32 v[120:121], v[120:121], v[116:117], v[118:119]
v_pk_fma_f32 v[122:123], v[122:123], v[116:117], v[118:119]
v_pk_fma_f32 v[124:125], v[124:125], v[116:117], v[118:119]
v_pk_fma_f32 v[126:127], v[126:127], v[116:117], v[118:119]
s_waitcnt lgkmcnt(4)
v_pk_fma_f32 v[120:121], v[120:121], v[80:81], v[88:89]
v_pk_fma_f32 v[122:123], v[122:123], v[82:83], v[90:91]
v_pk_fma_f32 v[124:125], v[124:125], v[84:85], v[92:93]
v_pk_fma_f32 v[126:127], v[126:127], v[86:87], v[94:95]
v_cvt_pk_bf16_f32 v244, v120, v121
v_cvt_pk_bf16_f32 v245, v122, v123
v_cvt_pk_bf16_f32 v246, v124, v125
v_cvt_pk_bf16_f32 v247, v126, v127
s_cmp_lg_u32 s43, 2
s_cbranch_scc1 nw_7
buffer_load_dwordx4 a[240:243], v8, s[76:79], s96 offen offset:0
buffer_load_dwordx4 a[244:247], v8, s[76:79], s96 offen offset:2048
nw_7:
ds_read_b128 v[80:83], v9 offset:1984
ds_read_b128 v[84:87], v9 offset:2000
ds_read_b128 v[88:91], v9 offset:4032
ds_read_b128 v[92:95], v9 offset:4048
v_lshlrev_b32 v120, 16, v248
v_and_b32 v121, v96, v248
v_lshlrev_b32 v122, 16, v249
v_and_b32 v123, v96, v249
v_lshlrev_b32 v124, 16, v250
v_and_b32 v125, v96, v250
v_lshlrev_b32 v126, 16, v251
v_and_b32 v127, v96, v251
v_pk_fma_f32 v[120:121], v[120:121], v[116:117], v[118:119]
v_pk_fma_f32 v[122:123], v[122:123], v[116:117], v[118:119]
v_pk_fma_f32 v[124:125], v[124:125], v[116:117], v[118:119]
v_pk_fma_f32 v[126:127], v[126:127], v[116:117], v[118:119]
s_waitcnt lgkmcnt(4)
v_pk_fma_f32 v[120:121], v[120:121], v[64:65], v[72:73]
v_pk_fma_f32 v[122:123], v[122:123], v[66:67], v[74:75]
v_pk_fma_f32 v[124:125], v[124:125], v[68:69], v[76:77]
v_pk_fma_f32 v[126:127], v[126:127], v[70:71], v[78:79]
v_cvt_pk_bf16_f32 v248, v120, v121
v_cvt_pk_bf16_f32 v249, v122, v123
v_cvt_pk_bf16_f32 v250, v124, v125
v_cvt_pk_bf16_f32 v251, v126, v127
s_cmp_lg_u32 s43, 3
s_cbranch_scc1 nw_8
buffer_load_dwordx4 a[240:243], v8, s[76:79], s96 offen offset:0
buffer_load_dwordx4 a[244:247], v8, s[76:79], s96 offen offset:2048
nw_8:
v_lshlrev_b32 v120, 16, v252
v_and_b32 v121, v96, v252
v_lshlrev_b32 v122, 16, v253
v_and_b32 v123, v96, v253
v_lshlrev_b32 v124, 16, v254
v_and_b32 v125, v96, v254
v_lshlrev_b32 v126, 16, v255
v_and_b32 v127, v96, v255
v_pk_fma_f32 v[120:121], v[120:121], v[116:117], v[118:119]
v_pk_fma_f32 v[122:123], v[122:123], v[116:117], v[118:119]
v_pk_fma_f32 v[124:125], v[124:125], v[116:117], v[118:119]
v_pk_fma_f32 v[126:127], v[126:127], v[116:117], v[118:119]
s_waitcnt lgkmcnt(0)
v_pk_fma_f32 v[120:121], v[120:121], v[80:81], v[88:89]
v_pk_fma_f32 v[122:123], v[122:123], v[82:83], v[90:91]
v_pk_fma_f32 v[124:125], v[124:125], v[84:85], v[92:93]
v_pk_fma_f32 v[126:127], v[126:127], v[86:87], v[94:95]
v_cvt_pk_bf16_f32 v252, v120, v121
v_cvt_pk_bf16_f32 v253, v122, v123
v_cvt_pk_bf16_f32 v254, v124, v125
v_cvt_pk_bf16_f32 v255, v126, v127
s_waitcnt vmcnt(3)
s_waitcnt lgkmcnt(0)
s_barrier
ds_read_b64_tr_b16 v[64:65], v2 offset:0
ds_read_b64_tr_b16 v[66:67], v2 offset:256
ds_read_b64_tr_b16 v[68:69], v2 offset:1024
ds_read_b64_tr_b16 v[70:71], v2 offset:1280
ds_read_b64_tr_b16 v[72:73], v2 offset:2048
ds_read_b64_tr_b16 v[74:75], v2 offset:2304
ds_read_b64_tr_b16 v[76:77], v2 offset:32768
ds_read_b64_tr_b16 v[78:79], v2 offset:33024
ds_read_b64_tr_b16 v[80:81], v2 offset:33792
ds_read_b64_tr_b16 v[82:83], v2 offset:34048
ds_read_b64_tr_b16 v[84:85], v2 offset:34816
ds_read_b64_tr_b16 v[86:87], v2 offset:35072
s_waitcnt lgkmcnt(6)
v_mfma_f32_32x32x16_bf16 v[16:31], v[64:67], v[128:131], 0
ds_read_b64_tr_b16 v[88:89], v10 offset:0
ds_read_b64_tr_b16 v[90:91], v10 offset:256
ds_read_b64_tr_b16 v[92:93], v10 offset:1024
ds_read_b64_tr_b16 v[94:95], v10 offset:1280
ds_read_b64_tr_b16 v[96:97], v10 offset:2048
ds_read_b64_tr_b16 v[98:99], v10 offset:2304
v_mfma_f32_32x32x16_bf16 v[32:47], v[68:71], v[128:131], 0
v_mfma_f32_32x32x16_bf16 v[48:63], v[128:131], v[72:75], 0
s_waitcnt lgkmcnt(6)
v_mfma_f32_32x32x16_bf16 v[16:31], v[76:79], v[132:135], v[16:31]
ds_read_b64_tr_b16 v[64:65], v10 offset:32768
ds_read_b64_tr_b16 v[66:67], v10 offset:33024
ds_read_b64_tr_b16 v[68:69], v10 offset:33792
ds_read_b64_tr_b16 v[70:71], v10 offset:34048
ds_read_b64_tr_b16 v[72:73], v10 offset:34816
ds_read_b64_tr_b16 v[74:75], v10 offset:35072
v_mfma_f32_32x32x16_bf16 v[32:47], v[80:83], v[132:135], v[32:47]
v_mfma_f32_32x32x16_bf16 v[48:63], v[132:135], v[84:87], v[48:63]
v_lshlrev_b32 v14, 7, v0
s_cmp_lg_u32 s43, 0
s_cbranch_scc1 nw_9
s_mul_i32 s4, s2, 5504
v_min_u32 v14, 5376, v14
buffer_load_dword v11, v14, s[68:71], s4 offen
nw_9:
s_cmp_lg_u32 s43, 1
s_cbranch_scc1 nw_10
s_lshl_b32 s4, s2, 11
v_min_u32 v14, 1920, v14
buffer_load_dword v11, v14, s[56:59], s4 offen
nw_10:
s_waitcnt lgkmcnt(6)
v_mfma_f32_32x32x16_bf16 v[16:31], v[88:91], v[136:139], v[16:31]
ds_read_b64_tr_b16 v[76:77], v2 offset:3072
ds_read_b64_tr_b16 v[78:79], v2 offset:3328
ds_read_b64_tr_b16 v[80:81], v2 offset:4096
ds_read_b64_tr_b16 v[82:83], v2 offset:4352
ds_read_b64_tr_b16 v[84:85], v2 offset:5120
ds_read_b64_tr_b16 v[86:87], v2 offset:5376
v_mfma_f32_32x32x16_bf16 v[32:47], v[92:95], v[136:139], v[32:47]
v_mfma_f32_32x32x16_bf16 v[48:63], v[136:139], v[96:99], v[48:63]
s_waitcnt lgkmcnt(6)
v_mfma_f32_32x32x16_bf16 v[16:31], v[64:67], v[140:143], v[16:31]
ds_read_b64_tr_b16 v[88:89], v2 offset:35840
ds_read_b64_tr_b16 v[90:91], v2 offset:36096
ds_read_b64_tr_b16 v[92:93], v2 offset:36864
ds_read_b64_tr_b16 v[94:95], v2 offset:37120
ds_read_b64_tr_b16 v[96:97], v2 offset:37888
ds_read_b64_tr_b16 v[98:99], v2 offset:38144
v_mfma_f32_32x32x16_bf16 v[32:47], v[68:71], v[140:143], v[32:47]
v_mfma_f32_32x32x16_bf16 v[48:63], v[140:143], v[72:75], v[48:63]
s_waitcnt lgkmcnt(6)
v_mfma_f32_32x32x16_bf16 v[16:31], v[76:79], v[144:147], v[16:31]
ds_read_b64_tr_b16 v[64:65], v10 offset:3072
ds_read_b64_tr_b16 v[66:67], v10 offset:3328
ds_read_b64_tr_b16 v[68:69], v10 offset:4096
ds_read_b64_tr_b16 v[70:71], v10 offset:4352
ds_read_b64_tr_b16 v[72:73], v10 offset:5120
ds_read_b64_tr_b16 v[74:75], v10 offset:5376
v_mfma_f32_32x32x16_bf16 v[32:47], v[80:83], v[144:147], v[32:47]
v_mfma_f32_32x32x16_bf16 v[48:63], v[144:147], v[84:87], v[48:63]
s_waitcnt lgkmcnt(6)
v_mfma_f32_32x32x16_bf16 v[16:31], v[88:91], v[148:151], v[16:31]
ds_read_b64_tr_b16 v[76:77], v10 offset:35840
ds_read_b64_tr_b16 v[78:79], v10 offset:36096
ds_read_b64_tr_b16 v[80:81], v10 offset:36864
ds_read_b64_tr_b16 v[82:83], v10 offset:37120
ds_read_b64_tr_b16 v[84:85], v10 offset:37888
ds_read_b64_tr_b16 v[86:87], v10 offset:38144
v_mfma_f32_32x32x16_bf16 v[32:47], v[92:95], v[148:151], v[32:47]
v_mfma_f32_32x32x16_bf16 v[48:63], v[148:151], v[96:99], v[48:63]
s_waitcnt lgkmcnt(6)
v_mfma_f32_32x32x16_bf16 v[16:31], v[64:67], v[152:155], v[16:31]
ds_read_b64_tr_b16 v[88:89], v2 offset:6144
ds_read_b64_tr_b16 v[90:91], v2 offset:6400
ds_read_b64_tr_b16 v[92:93], v2 offset:7168
ds_read_b64_tr_b16 v[94:95], v2 offset:7424
ds_read_b64_tr_b16 v[96:97], v2 offset:8192
ds_read_b64_tr_b16 v[98:99], v2 offset:8448
v_mfma_f32_32x32x16_bf16 v[32:47], v[68:71], v[152:155], v[32:47]
v_mfma_f32_32x32x16_bf16 v[48:63], v[152:155], v[72:75], v[48:63]
s_waitcnt lgkmcnt(6)
v_mfma_f32_32x32x16_bf16 v[16:31], v[76:79], v[156:159], v[16:31]
ds_read_b64_tr_b16 v[64:65], v2 offset:38912
ds_read_b64_tr_b16 v[66:67], v2 offset:39168
ds_read_b64_tr_b16 v[68:69], v2 offset:39936
ds_read_b64_tr_b16 v[70:71], v2 offset:40192
ds_read_b64_tr_b16 v[72:73], v2 offset:40960
ds_read_b64_tr_b16 v[74:75], v2 offset:41216
v_mfma_f32_32x32x16_bf16 v[32:47], v[80:83], v[156:159], v[32:47]
v_mfma_f32_32x32x16_bf16 v[48:63], v[156:159], v[84:87], v[48:63]
s_waitcnt lgkmcnt(6)
v_mfma_f32_32x32x16_bf16 v[16:31], v[88:91], v[160:163], v[16:31]
ds_read_b64_tr_b16 v[76:77], v10 offset:6144
ds_read_b64_tr_b16 v[78:79], v10 offset:6400
ds_read_b64_tr_b16 v[80:81], v10 offset:7168
ds_read_b64_tr_b16 v[82:83], v10 offset:7424
ds_read_b64_tr_b16 v[84:85], v10 offset:8192
ds_read_b64_tr_b16 v[86:87], v10 offset:8448
v_mfma_f32_32x32x16_bf16 v[32:47], v[92:95], v[160:163], v[32:47]
v_mfma_f32_32x32x16_bf16 v[48:63], v[160:163], v[96:99], v[48:63]
s_waitcnt lgkmcnt(6)
v_mfma_f32_32x32x16_bf16 v[16:31], v[64:67], v[164:167], v[16:31]
ds_read_b64_tr_b16 v[88:89], v10 offset:38912
ds_read_b64_tr_b16 v[90:91], v10 offset:39168
ds_read_b64_tr_b16 v[92:93], v10 offset:39936
ds_read_b64_tr_b16 v[94:95], v10 offset:40192
ds_read_b64_tr_b16 v[96:97], v10 offset:40960
ds_read_b64_tr_b16 v[98:99], v10 offset:41216
v_mfma_f32_32x32x16_bf16 v[32:47], v[68:71], v[164:167], v[32:47]
v_mfma_f32_32x32x16_bf16 v[48:63], v[164:167], v[72:75], v[48:63]
s_waitcnt lgkmcnt(6)
v_mfma_f32_32x32x16_bf16 v[16:31], v[76:79], v[168:171], v[16:31]
ds_read_b64_tr_b16 v[64:65], v2 offset:9216
ds_read_b64_tr_b16 v[66:67], v2 offset:9472
ds_read_b64_tr_b16 v[68:69], v2 offset:10240
ds_read_b64_tr_b16 v[70:71], v2 offset:10496
ds_read_b64_tr_b16 v[72:73], v2 offset:11264
ds_read_b64_tr_b16 v[74:75], v2 offset:11520
v_mfma_f32_32x32x16_bf16 v[32:47], v[80:83], v[168:171], v[32:47]
v_mfma_f32_32x32x16_bf16 v[48:63], v[168:171], v[84:87], v[48:63]
s_waitcnt lgkmcnt(6)
v_mfma_f32_32x32x16_bf16 v[16:31], v[88:91], v[172:175], v[16:31]
ds_read_b64_tr_b16 v[76:77], v2 offset:41984
ds_read_b64_tr_b16 v[78:79], v2 offset:42240
ds_read_b64_tr_b16 v[80:81], v2 offset:43008
ds_read_b64_tr_b16 v[82:83], v2 offset:43264
ds_read_b64_tr_b16 v[84:85], v2 offset:44032
ds_read_b64_tr_b16 v[86:87], v2 offset:44288
v_mfma_f32_32x32x16_bf16 v[32:47], v[92:95], v[172:175], v[32:47]
v_mfma_f32_32x32x16_bf16 v[48:63], v[172:175], v[96:99], v[48:63]
s_waitcnt lgkmcnt(6)
v_mfma_f32_32x32x16_bf16 v[16:31], v[64:67], v[176:179], v[16:31]
ds_read_b64_tr_b16 v[88:89], v10 offset:9216
ds_read_b64_tr_b16 v[90:91], v10 offset:9472
ds_read_b64_tr_b16 v[92:93], v10 offset:10240
ds_read_b64_tr_b16 v[94:95], v10 offset:10496
ds_read_b64_tr_b16 v[96:97], v10 offset:11264
ds_read_b64_tr_b16 v[98:99], v10 offset:11520
v_mfma_f32_32x32x16_bf16 v[32:47], v[68:71], v[176:179], v[32:47]
v_mfma_f32_32x32x16_bf16 v[48:63], v[176:179], v[72:75], v[48:63]
s_waitcnt lgkmcnt(6)
v_mfma_f32_32x32x16_bf16 v[16:31], v[76:79], v[180:183], v[16:31]
ds_read_b64_tr_b16 v[64:65], v10 offset:41984
ds_read_b64_tr_b16 v[66:67], v10 offset:42240
ds_read_b64_tr_b16 v[68:69], v10 offset:43008
ds_read_b64_tr_b16 v[70:71], v10 offset:43264
ds_read_b64_tr_b16 v[72:73], v10 offset:44032
ds_read_b64_tr_b16 v[74:75], v10 offset:44288
v_mfma_f32_32x32x16_bf16 v[32:47], v[80:83], v[180:183], v[32:47]
v_mfma_f32_32x32x16_bf16 v[48:63], v[180:183], v[84:87], v[48:63]
s_waitcnt lgkmcnt(6)
v_mfma_f32_32x32x16_bf16 v[16:31], v[88:91], v[184:187], v[16:31]
ds_read_b64_tr_b16 v[76:77], v2 offset:12288
ds_read_b64_tr_b16 v[78:79], v2 offset:12544
ds_read_b64_tr_b16 v[80:81], v2 offset:13312
ds_read_b64_tr_b16 v[82:83], v2 offset:13568
ds_read_b64_tr_b16 v[84:85], v2 offset:14336
ds_read_b64_tr_b16 v[86:87], v2 offset:14592
v_mfma_f32_32x32x16_bf16 v[32:47], v[92:95], v[184:187], v[32:47]
v_mfma_f32_32x32x16_bf16 v[48:63], v[184:187], v[96:99], v[48:63]
s_waitcnt lgkmcnt(6)
v_mfma_f32_32x32x16_bf16 v[16:31], v[64:67], v[188:191], v[16:31]
ds_read_b64_tr_b16 v[88:89], v2 offset:45056
ds_read_b64_tr_b16 v[90:91], v2 offset:45312
ds_read_b64_tr_b16 v[92:93], v2 offset:46080
ds_read_b64_tr_b16 v[94:95], v2 offset:46336
ds_read_b64_tr_b16 v[96:97], v2 offset:47104
ds_read_b64_tr_b16 v[98:99], v2 offset:47360
v_mfma_f32_32x32x16_bf16 v[32:47], v[68:71], v[188:191], v[32:47]
v_mfma_f32_32x32x16_bf16 v[48:63], v[188:191], v[72:75], v[48:63]
s_waitcnt lgkmcnt(6)
v_mfma_f32_32x32x16_bf16 v[16:31], v[76:79], v[192:195], v[16:31]
ds_read_b64_tr_b16 v[64:65], v10 offset:12288
ds_read_b64_tr_b16 v[66:67], v10 offset:12544
ds_read_b64_tr_b16 v[68:69], v10 offset:13312
ds_read_b64_tr_b16 v[70:71], v10 offset:13568
ds_read_b64_tr_b16 v[72:73], v10 offset:14336
ds_read_b64_tr_b16 v[74:75], v10 offset:14592
v_mfma_f32_32x32x16_bf16 v[32:47], v[80:83], v[192:195], v[32:47]
v_mfma_f32_32x32x16_bf16 v[48:63], v[192:195], v[84:87], v[48:63]
s_waitcnt lgkmcnt(6)
v_mfma_f32_32x32x16_bf16 v[16:31], v[88:91], v[196:199], v[16:31]
ds_read_b64_tr_b16 v[76:77], v10 offset:45056
ds_read_b64_tr_b16 v[78:79], v10 offset:45312
ds_read_b64_tr_b16 v[80:81], v10 offset:46080
ds_read_b64_tr_b16 v[82:83], v10 offset:46336
ds_read_b64_tr_b16 v[84:85], v10 offset:47104
ds_read_b64_tr_b16 v[86:87], v10 offset:47360
v_mfma_f32_32x32x16_bf16 v[32:47], v[92:95], v[196:199], v[32:47]
v_mfma_f32_32x32x16_bf16 v[48:63], v[196:199], v[96:99], v[48:63]
s_waitcnt lgkmcnt(6)
v_mfma_f32_32x32x16_bf16 v[16:31], v[64:67], v[200:203], v[16:31]
ds_read_b64_tr_b16 v[88:89], v2 offset:15360
ds_read_b64_tr_b16 v[90:91], v2 offset:15616
ds_read_b64_tr_b16 v[92:93], v2 offset:16384
ds_read_b64_tr_b16 v[94:95], v2 offset:16640
ds_read_b64_tr_b16 v[96:97], v2 offset:17408
ds_read_b64_tr_b16 v[98:99], v2 offset:17664
v_mfma_f32_32x32x16_bf16 v[32:47], v[68:71], v[200:203], v[32:47]
v_mfma_f32_32x32x16_bf16 v[48:63], v[200:203], v[72:75], v[48:63]
s_waitcnt lgkmcnt(6)
v_mfma_f32_32x32x16_bf16 v[16:31], v[76:79], v[204:207], v[16:31]
ds_read_b64_tr_b16 v[64:65], v2 offset:48128
ds_read_b64_tr_b16 v[66:67], v2 offset:48384
ds_read_b64_tr_b16 v[68:69], v2 offset:49152
ds_read_b64_tr_b16 v[70:71], v2 offset:49408
ds_read_b64_tr_b16 v[72:73], v2 offset:50176
ds_read_b64_tr_b16 v[74:75], v2 offset:50432
v_mfma_f32_32x32x16_bf16 v[32:47], v[80:83], v[204:207], v[32:47]
v_mfma_f32_32x32x16_bf16 v[48:63], v[204:207], v[84:87], v[48:63]
s_waitcnt lgkmcnt(6)
v_mfma_f32_32x32x16_bf16 v[16:31], v[88:91], v[208:211], v[16:31]
ds_read_b64_tr_b16 v[76:77], v10 offset:15360
ds_read_b64_tr_b16 v[78:79], v10 offset:15616
ds_read_b64_tr_b16 v[80:81], v10 offset:16384
ds_read_b64_tr_b16 v[82:83], v10 offset:16640
ds_read_b64_tr_b16 v[84:85], v10 offset:17408
ds_read_b64_tr_b16 v[86:87], v10 offset:17664
v_mfma_f32_32x32x16_bf16 v[32:47], v[92:95], v[208:211], v[32:47]
v_mfma_f32_32x32x16_bf16 v[48:63], v[208:211], v[96:99], v[48:63]
s_waitcnt lgkmcnt(6)
v_mfma_f32_32x32x16_bf16 v[16:31], v[64:67], v[212:215], v[16:31]
ds_read_b64_tr_b16 v[88:89], v10 offset:48128
ds_read_b64_tr_b16 v[90:91], v10 offset:48384
ds_read_b64_tr_b16 v[92:93], v10 offset:49152
ds_read_b64_tr_b16 v[94:95], v10 offset:49408
ds_read_b64_tr_b16 v[96:97], v10 offset:50176
ds_read_b64_tr_b16 v[98:99], v10 offset:50432
v_mfma_f32_32x32x16_bf16 v[32:47], v[68:71], v[212:215], v[32:47]
v_mfma_f32_32x32x16_bf16 v[48:63], v[212:215], v[72:75], v[48:63]
s_waitcnt lgkmcnt(6)
v_mfma_f32_32x32x16_bf16 v[16:31], v[76:79], v[216:219], v[16:31]
ds_read_b64_tr_b16 v[64:65], v2 offset:18432
ds_read_b64_tr_b16 v[66:67], v2 offset:18688
ds_read_b64_tr_b16 v[68:69], v2 offset:19456
ds_read_b64_tr_b16 v[70:71], v2 offset:19712
ds_read_b64_tr_b16 v[72:73], v2 offset:20480
ds_read_b64_tr_b16 v[74:75], v2 offset:20736
v_mfma_f32_32x32x16_bf16 v[32:47], v[80:83], v[216:219], v[32:47]
v_mfma_f32_32x32x16_bf16 v[48:63], v[216:219], v[84:87], v[48:63]
s_waitcnt lgkmcnt(6)
v_mfma_f32_32x32x16_bf16 v[16:31], v[88:91], v[220:223], v[16:31]
ds_read_b64_tr_b16 v[76:77], v2 offset:51200
ds_read_b64_tr_b16 v[78:79], v2 offset:51456
ds_read_b64_tr_b16 v[80:81], v2 offset:52224
ds_read_b64_tr_b16 v[82:83], v2 offset:52480
ds_read_b64_tr_b16 v[84:85], v2 offset:53248
ds_read_b64_tr_b16 v[86:87], v2 offset:53504
v_mfma_f32_32x32x16_bf16 v[32:47], v[92:95], v[220:223], v[32:47]
v_mfma_f32_32x32x16_bf16 v[48:63], v[220:223], v[96:99], v[48:63]
s_waitcnt lgkmcnt(6)
v_mfma_f32_32x32x16_bf16 v[16:31], v[64:67], v[224:227], v[16:31]
ds_read_b64_tr_b16 v[88:89], v10 offset:18432
ds_read_b64_tr_b16 v[90:91], v10 offset:18688
ds_read_b64_tr_b16 v[92:93], v10 offset:19456
ds_read_b64_tr_b16 v[94:95], v10 offset:19712
ds_read_b64_tr_b16 v[96:97], v10 offset:20480
ds_read_b64_tr_b16 v[98:99], v10 offset:20736
v_mfma_f32_32x32x16_bf16 v[32:47], v[68:71], v[224:227], v[32:47]
v_mfma_f32_32x32x16_bf16 v[48:63], v[224:227], v[72:75], v[48:63]
s_waitcnt lgkmcnt(6)
v_mfma_f32_32x32x16_bf16 v[16:31], v[76:79], v[228:231], v[16:31]
ds_read_b64_tr_b16 v[64:65], v10 offset:51200
ds_read_b64_tr_b16 v[66:67], v10 offset:51456
ds_read_b64_tr_b16 v[68:69], v10 offset:52224
ds_read_b64_tr_b16 v[70:71], v10 offset:52480
ds_read_b64_tr_b16 v[72:73], v10 offset:53248
ds_read_b64_tr_b16 v[74:75], v10 offset:53504
v_mfma_f32_32x32x16_bf16 v[32:47], v[80:83], v[228:231], v[32:47]
v_mfma_f32_32x32x16_bf16 v[48:63], v[228:231], v[84:87], v[48:63]
s_waitcnt lgkmcnt(6)
v_mfma_f32_32x32x16_bf16 v[16:31], v[88:91], v[232:235], v[16:31]
ds_read_b64_tr_b16 v[76:77], v2 offset:21504
ds_read_b64_tr_b16 v[78:79], v2 offset:21760
ds_read_b64_tr_b16 v[80:81], v2 offset:22528
ds_read_b64_tr_b16 v[82:83], v2 offset:22784
ds_read_b64_tr_b16 v[84:85], v2 offset:23552
ds_read_b64_tr_b16 v[86:87], v2 offset:23808
v_mfma_f32_32x32x16_bf16 v[32:47], v[92:95], v[232:235], v[32:47]
v_mfma_f32_32x32x16_bf16 v[48:63], v[232:235], v[96:99], v[48:63]
s_waitcnt lgkmcnt(6)
v_mfma_f32_32x32x16_bf16 v[16:31], v[64:67], v[236:239], v[16:31]
ds_read_b64_tr_b16 v[88:89], v2 offset:54272
ds_read_b64_tr_b16 v[90:91], v2 offset:54528
ds_read_b64_tr_b16 v[92:93], v2 offset:55296
ds_read_b64_tr_b16 v[94:95], v2 offset:55552
ds_read_b64_tr_b16 v[96:97], v2 offset:56320
ds_read_b64_tr_b16 v[98:99], v2 offset:56576
v_mfma_f32_32x32x16_bf16 v[32:47], v[68:71], v[236:239], v[32:47]
v_mfma_f32_32x32x16_bf16 v[48:63], v[236:239], v[72:75], v[48:63]
s_waitcnt lgkmcnt(6)
v_mfma_f32_32x32x16_bf16 v[16:31], v[76:79], v[240:243], v[16:31]
ds_read_b64_tr_b16 v[64:65], v10 offset:21504
ds_read_b64_tr_b16 v[66:67], v10 offset:21760
ds_read_b64_tr_b16 v[68:69], v10 offset:22528
ds_read_b64_tr_b16 v[70:71], v10 offset:22784
ds_read_b64_tr_b16 v[72:73], v10 offset:23552
ds_read_b64_tr_b16 v[74:75], v10 offset:23808
v_mfma_f32_32x32x16_bf16 v[32:47], v[80:83], v[240:243], v[32:47]
v_mfma_f32_32x32x16_bf16 v[48:63], v[240:243], v[84:87], v[48:63]
s_waitcnt lgkmcnt(6)
v_mfma_f32_32x32x16_bf16 v[16:31], v[88:91], v[244:247], v[16:31]
ds_read_b64_tr_b16 v[76:77], v10 offset:54272
ds_read_b64_tr_b16 v[78:79], v10 offset:54528
ds_read_b64_tr_b16 v[80:81], v10 offset:55296
ds_read_b64_tr_b16 v[82:83], v10 offset:55552
ds_read_b64_tr_b16 v[84:85], v10 offset:56320
ds_read_b64_tr_b16 v[86:87], v10 offset:56576
v_mfma_f32_32x32x16_bf16 v[32:47], v[92:95], v[244:247], v[32:47]
v_mfma_f32_32x32x16_bf16 v[48:63], v[244:247], v[96:99], v[48:63]
s_waitcnt lgkmcnt(6)
v_mfma_f32_32x32x16_bf16 v[16:31], v[64:67], v[248:251], v[16:31]
v_mfma_f32_32x32x16_bf16 v[32:47], v[68:71], v[248:251], v[32:47]
v_mfma_f32_32x32x16_bf16 v[48:63], v[248:251], v[72:75], v[48:63]
s_waitcnt lgkmcnt(0)
v_mfma_f32_32x32x16_bf16 v[16:31], v[76:79], v[252:255], v[16:31]
v_mfma_f32_32x32x16_bf16 v[32:47], v[80:83], v[252:255], v[32:47]
v_mfma_f32_32x32x16_bf16 v[48:63], v[252:255], v[84:87], v[48:63]
s_mov_b32 s4, 0x3eb8aa3b
s_nop 9
v_cvt_pk_bf16_f32 v64, v32, v33
v_cvt_pk_bf16_f32 v65, v34, v35
v_cvt_pk_bf16_f32 v66, v36, v37
v_cvt_pk_bf16_f32 v67, v38, v39
v_cvt_pk_bf16_f32 v68, v40, v41
v_cvt_pk_bf16_f32 v69, v42, v43
v_cvt_pk_bf16_f32 v70, v44, v45
v_cvt_pk_bf16_f32 v71, v46, v47
v_cvt_pk_bf16_f32 v72, v48, v49
v_cvt_pk_bf16_f32 v73, v50, v51
v_cvt_pk_bf16_f32 v74, v52, v53
v_cvt_pk_bf16_f32 v75, v54, v55
v_cvt_pk_bf16_f32 v76, v56, v57
v_cvt_pk_bf16_f32 v77, v58, v59
v_cvt_pk_bf16_f32 v78, v60, v61
v_cvt_pk_bf16_f32 v79, v62, v63
s_lshl_b32 s6, s44, 15
s_lshl_b32 s5, s42, 11
s_add_u32 s6, s6, s5
s_add_u32 s7, s6, 8519680
s_add_u32 s6, s6, 4325376
buffer_store_dwordx4 v[64:67], v1, s[84:87], s6 offen offset:0 sc1
buffer_store_dwordx4 v[72:75], v1, s[84:87], s7 offen offset:0 sc1
buffer_store_dwordx4 v[68:71], v1, s[84:87], s6 offen offset:1024 sc1
buffer_store_dwordx4 v[76:79], v1, s[84:87], s7 offen offset:1024 sc1
v_mul_f32 v16, s4, v16
v_mul_f32 v17, s4, v17
v_mul_f32 v18, s4, v18
v_mul_f32 v19, s4, v19
v_mul_f32 v20, s4, v20
v_mul_f32 v21, s4, v21
v_mul_f32 v22, s4, v22
v_mul_f32 v23, s4, v23
v_mul_f32 v24, s4, v24
v_mul_f32 v25, s4, v25
v_mul_f32 v26, s4, v26
v_mul_f32 v27, s4, v27
v_mul_f32 v28, s4, v28
v_mul_f32 v29, s4, v29
v_mul_f32 v30, s4, v30
v_mul_f32 v31, s4, v31
v_cvt_pk_bf16_f32 v104, v16, v17
v_cvt_pk_bf16_f32 v105, v18, v19
v_cvt_pk_bf16_f32 v106, v20, v21
v_cvt_pk_bf16_f32 v107, v22, v23
v_cvt_pk_bf16_f32 v108, v24, v25
v_cvt_pk_bf16_f32 v109, v26, v27
v_cvt_pk_bf16_f32 v110, v28, v29
v_cvt_pk_bf16_f32 v111, v30, v31
v_and_b32 v14, 16, v0
v_cmp_eq_u32 s[98:99], 0, v14
s_mov_b32 s97, 0x3f803f80
v_mov_b32 v113, s97
s_lshl_b32 s5, s43, 11
s_add_u32 s5, s5, 65536
v_add_u32 v8, s5, v1
s_lshl_b32 s5, s43, 12
s_add_u32 s5, s5, 90112
v_add_u32 v9, s5, v1
s_waitcnt lgkmcnt(0)
s_barrier
ds_write_b128 v8, v[64:67] offset:16384
ds_write_b128 v8, v[68:71] offset:17408
v_cndmask_b32 v80, v113, v72, s[98:99]
v_cndmask_b32 v81, v113, v73, s[98:99]
v_cndmask_b32 v82, v113, v74, s[98:99]
v_cndmask_b32 v83, v113, v75, s[98:99]
v_cndmask_b32 v84, v113, v76, s[98:99]
v_cndmask_b32 v85, v113, v77, s[98:99]
v_cndmask_b32 v86, v113, v78, s[98:99]
v_cndmask_b32 v87, v113, v79, s[98:99]
ds_write_b128 v9, v[80:83] offset:32768
ds_write_b128 v9, v[84:87] offset:34816
v_cndmask_b32 v88, v72, v113, s[98:99]
v_cndmask_b32 v89, v73, v113, s[98:99]
v_cndmask_b32 v90, v74, v113, s[98:99]
v_cndmask_b32 v91, v75, v113, s[98:99]
v_cndmask_b32 v92, v76, v113, s[98:99]
v_cndmask_b32 v93, v77, v113, s[98:99]
v_cndmask_b32 v94, v78, v113, s[98:99]
v_cndmask_b32 v95, v79, v113, s[98:99]
ds_write_b128 v9, v[88:91] offset:33792
ds_write_b128 v9, v[92:95] offset:35840
s_lshl_b32 s5, s41, 6
s_lshl_b32 s6, s43, 4
s_add_u32 s5, s5, s6
s_add_u32 s100, s5, s42
s_waitcnt vmcnt(0)
s_lshl_b32 s4, s100, 2
s_add_u32 s4, s4, 32768
v_mov_b32 v14, s40
v_mov_b32 v15, 0
s_mov_b64 exec, 1
buffer_store_dword v14, v15, s[84:87], s4 offen sc1
s_mov_b64 exec, -1
v_add_u32 v10, s15, v3
ds_read_b64_tr_b16 v[160:161], v10 offset:0
ds_read_b64_tr_b16 v[162:163], v10 offset:512
ds_read_b64_tr_b16 v[164:165], v10 offset:1024
ds_read_b64_tr_b16 v[166:167], v10 offset:1536
ds_read_b64_tr_b16 v[168:169], v10 offset:2048
ds_read_b64_tr_b16 v[170:171], v10 offset:2560
v_accvgpr_read_b32 v48, a240
v_accvgpr_read_b32 v49, a241
v_accvgpr_read_b32 v50, a242
v_accvgpr_read_b32 v51, a243
v_accvgpr_read_b32 v52, a244
v_accvgpr_read_b32 v53, a245
v_accvgpr_read_b32 v54, a246
v_accvgpr_read_b32 v55, a247
v_accvgpr_read_b32 v6, a250
v_lshlrev_b32 v172, 16, v48
v_and_b32 v173, 0xffff0000, v48
v_lshlrev_b32 v174, 16, v49
v_and_b32 v175, 0xffff0000, v49
v_lshlrev_b32 v176, 16, v50
v_and_b32 v177, 0xffff0000, v50
v_lshlrev_b32 v178, 16, v51
v_and_b32 v179, 0xffff0000, v51
v_mul_f32 v172, v6, v172
v_mul_f32 v173, v6, v173
v_mul_f32 v174, v6, v174
v_mul_f32 v175, v6, v175
v_mul_f32 v176, v6, v176
v_mul_f32 v177, v6, v177
v_mul_f32 v178, v6, v178
v_mul_f32 v179, v6, v179
v_add_f32_dpp v172, v172, v172 row_shr:1 row_mask:0xf bank_mask:0xf
v_add_f32_dpp v173, v173, v173 row_shr:1 row_mask:0xf bank_mask:0xf
v_add_f32_dpp v174, v174, v174 row_shr:1 row_mask:0xf bank_mask:0xf
v_add_f32_dpp v175, v175, v175 row_shr:1 row_mask:0xf bank_mask:0xf
v_add_f32_dpp v176, v176, v176 row_shr:1 row_mask:0xf bank_mask:0xf
v_add_f32_dpp v177, v177, v177 row_shr:1 row_mask:0xf bank_mask:0xf
v_add_f32_dpp v178, v178, v178 row_shr:1 row_mask:0xf bank_mask:0xf
v_add_f32_dpp v179, v179, v179 row_shr:1 row_mask:0xf bank_mask:0xf
v_add_f32_dpp v172, v172, v172 row_shr:2 row_mask:0xf bank_mask:0xf
v_add_f32_dpp v173, v173, v173 row_shr:2 row_mask:0xf bank_mask:0xf
v_add_f32_dpp v174, v174, v174 row_shr:2 row_mask:0xf bank_mask:0xf
v_add_f32_dpp v175, v175, v175 row_shr:2 row_mask:0xf bank_mask:0xf
v_add_f32_dpp v176, v176, v176 row_shr:2 row_mask:0xf bank_mask:0xf
v_add_f32_dpp v177, v177, v177 row_shr:2 row_mask:0xf bank_mask:0xf
v_add_f32_dpp v178, v178, v178 row_shr:2 row_mask:0xf bank_mask:0xf
v_add_f32_dpp v179, v179, v179 row_shr:2 row_mask:0xf bank_mask:0xf
v_add_f32_dpp v172, v172, v172 row_shr:4 row_mask:0xf bank_mask:0xf
v_add_f32_dpp v173, v173, v173 row_shr:4 row_mask:0xf bank_mask:0xf
v_add_f32_dpp v174, v174, v174 row_shr:4 row_mask:0xf bank_mask:0xf
v_add_f32_dpp v175, v175, v175 row_shr:4 row_mask:0xf bank_mask:0xf
v_add_f32_dpp v176, v176, v176 row_shr:4 row_mask:0xf bank_mask:0xf
v_add_f32_dpp v177, v177, v177 row_shr:4 row_mask:0xf bank_mask:0xf
v_add_f32_dpp v178, v178, v178 row_shr:4 row_mask:0xf bank_mask:0xf
v_add_f32_dpp v179, v179, v179 row_shr:4 row_mask:0xf bank_mask:0xf
v_add_f32_dpp v172, v172, v172 row_shr:8 row_mask:0xf bank_mask:0xf
v_add_f32_dpp v173, v173, v173 row_shr:8 row_mask:0xf bank_mask:0xf
v_add_f32_dpp v174, v174, v174 row_shr:8 row_mask:0xf bank_mask:0xf
v_add_f32_dpp v175, v175, v175 row_shr:8 row_mask:0xf bank_mask:0xf
v_add_f32_dpp v176, v176, v176 row_shr:8 row_mask:0xf bank_mask:0xf
v_add_f32_dpp v177, v177, v177 row_shr:8 row_mask:0xf bank_mask:0xf
v_add_f32_dpp v178, v178, v178 row_shr:8 row_mask:0xf bank_mask:0xf
v_add_f32_dpp v179, v179, v179 row_shr:8 row_mask:0xf bank_mask:0xf
v_add_f32_dpp v172, v172, v172 row_bcast:15 row_mask:0xa bank_mask:0xf
v_add_f32_dpp v173, v173, v173 row_bcast:15 row_mask:0xa bank_mask:0xf
v_add_f32_dpp v174, v174, v174 row_bcast:15 row_mask:0xa bank_mask:0xf
v_add_f32_dpp v175, v175, v175 row_bcast:15 row_mask:0xa bank_mask:0xf
v_add_f32_dpp v176, v176, v176 row_bcast:15 row_mask:0xa bank_mask:0xf
v_add_f32_dpp v177, v177, v177 row_bcast:15 row_mask:0xa bank_mask:0xf
v_add_f32_dpp v178, v178, v178 row_bcast:15 row_mask:0xa bank_mask:0xf
v_add_f32_dpp v179, v179, v179 row_bcast:15 row_mask:0xa bank_mask:0xf
v_add_f32_dpp v172, v172, v172 row_bcast:31 row_mask:0xc bank_mask:0xf
v_add_f32_dpp v173, v173, v173 row_bcast:31 row_mask:0xc bank_mask:0xf
v_add_f32_dpp v174, v174, v174 row_bcast:31 row_mask:0xc bank_mask:0xf
v_add_f32_dpp v175, v175, v175 row_bcast:31 row_mask:0xc bank_mask:0xf
v_add_f32_dpp v176, v176, v176 row_bcast:31 row_mask:0xc bank_mask:0xf
v_add_f32_dpp v177, v177, v177 row_bcast:31 row_mask:0xc bank_mask:0xf
v_add_f32_dpp v178, v178, v178 row_bcast:31 row_mask:0xc bank_mask:0xf
v_add_f32_dpp v179, v179, v179 row_bcast:31 row_mask:0xc bank_mask:0xf
s_lshl_b32 s4, s43, 5
s_add_u32 s4, s4, 157312
v_mov_b32 v14, s4
s_mov_b32 exec_lo, 0
s_brev_b32 exec_hi, 1
ds_write_b128 v14, v[172:175]
ds_write_b128 v14, v[176:179] offset:16
s_mov_b64 exec, -1
v_lshlrev_b32 v180, 16, v52
v_and_b32 v181, 0xffff0000, v52
v_lshlrev_b32 v182, 16, v53
v_and_b32 v183, 0xffff0000, v53
v_lshlrev_b32 v184, 16, v54
v_and_b32 v185, 0xffff0000, v54
v_lshlrev_b32 v186, 16, v55
v_and_b32 v187, 0xffff0000, v55
v_mul_f32 v180, v6, v180
v_mul_f32 v181, v6, v181
v_mul_f32 v182, v6, v182
v_mul_f32 v183, v6, v183
v_mul_f32 v184, v6, v184
v_mul_f32 v185, v6, v185
v_mul_f32 v186, v6, v186
v_mul_f32 v187, v6, v187
v_add_f32_dpp v180, v180, v180 row_shr:1 row_mask:0xf bank_mask:0xf
v_add_f32_dpp v181, v181, v181 row_shr:1 row_mask:0xf bank_mask:0xf
v_add_f32_dpp v182, v182, v182 row_shr:1 row_mask:0xf bank_mask:0xf
v_add_f32_dpp v183, v183, v183 row_shr:1 row_mask:0xf bank_mask:0xf
v_add_f32_dpp v184, v184, v184 row_shr:1 row_mask:0xf bank_mask:0xf
v_add_f32_dpp v185, v185, v185 row_shr:1 row_mask:0xf bank_mask:0xf
v_add_f32_dpp v186, v186, v186 row_shr:1 row_mask:0xf bank_mask:0xf
v_add_f32_dpp v187, v187, v187 row_shr:1 row_mask:0xf bank_mask:0xf
v_add_f32_dpp v180, v180, v180 row_shr:2 row_mask:0xf bank_mask:0xf
v_add_f32_dpp v181, v181, v181 row_shr:2 row_mask:0xf bank_mask:0xf
v_add_f32_dpp v182, v182, v182 row_shr:2 row_mask:0xf bank_mask:0xf
v_add_f32_dpp v183, v183, v183 row_shr:2 row_mask:0xf bank_mask:0xf
v_add_f32_dpp v184, v184, v184 row_shr:2 row_mask:0xf bank_mask:0xf
v_add_f32_dpp v185, v185, v185 row_shr:2 row_mask:0xf bank_mask:0xf
v_add_f32_dpp v186, v186, v186 row_shr:2 row_mask:0xf bank_mask:0xf
v_add_f32_dpp v187, v187, v187 row_shr:2 row_mask:0xf bank_mask:0xf
v_add_f32_dpp v180, v180, v180 row_shr:4 row_mask:0xf bank_mask:0xf
v_add_f32_dpp v181, v181, v181 row_shr:4 row_mask:0xf bank_mask:0xf
v_add_f32_dpp v182, v182, v182 row_shr:4 row_mask:0xf bank_mask:0xf
v_add_f32_dpp v183, v183, v183 row_shr:4 row_mask:0xf bank_mask:0xf
v_add_f32_dpp v184, v184, v184 row_shr:4 row_mask:0xf bank_mask:0xf
v_add_f32_dpp v185, v185, v185 row_shr:4 row_mask:0xf bank_mask:0xf
v_add_f32_dpp v186, v186, v186 row_shr:4 row_mask:0xf bank_mask:0xf
v_add_f32_dpp v187, v187, v187 row_shr:4 row_mask:0xf bank_mask:0xf
v_add_f32_dpp v180, v180, v180 row_shr:8 row_mask:0xf bank_mask:0xf
v_add_f32_dpp v181, v181, v181 row_shr:8 row_mask:0xf bank_mask:0xf
v_add_f32_dpp v182, v182, v182 row_shr:8 row_mask:0xf bank_mask:0xf
v_add_f32_dpp v183, v183, v183 row_shr:8 row_mask:0xf bank_mask:0xf
v_add_f32_dpp v184, v184, v184 row_shr:8 row_mask:0xf bank_mask:0xf
v_add_f32_dpp v185, v185, v185 row_shr:8 row_mask:0xf bank_mask:0xf
v_add_f32_dpp v186, v186, v186 row_shr:8 row_mask:0xf bank_mask:0xf
v_add_f32_dpp v187, v187, v187 row_shr:8 row_mask:0xf bank_mask:0xf
v_add_f32_dpp v180, v180, v180 row_bcast:15 row_mask:0xa bank_mask:0xf
v_add_f32_dpp v181, v181, v181 row_bcast:15 row_mask:0xa bank_mask:0xf
v_add_f32_dpp v182, v182, v182 row_bcast:15 row_mask:0xa bank_mask:0xf
v_add_f32_dpp v183, v183, v183 row_bcast:15 row_mask:0xa bank_mask:0xf
v_add_f32_dpp v184, v184, v184 row_bcast:15 row_mask:0xa bank_mask:0xf
v_add_f32_dpp v185, v185, v185 row_bcast:15 row_mask:0xa bank_mask:0xf
v_add_f32_dpp v186, v186, v186 row_bcast:15 row_mask:0xa bank_mask:0xf
v_add_f32_dpp v187, v187, v187 row_bcast:15 row_mask:0xa bank_mask:0xf
v_add_f32_dpp v180, v180, v180 row_bcast:31 row_mask:0xc bank_mask:0xf
v_add_f32_dpp v181, v181, v181 row_bcast:31 row_mask:0xc bank_mask:0xf
v_add_f32_dpp v182, v182, v182 row_bcast:31 row_mask:0xc bank_mask:0xf
v_add_f32_dpp v183, v183, v183 row_bcast:31 row_mask:0xc bank_mask:0xf
v_add_f32_dpp v184, v184, v184 row_bcast:31 row_mask:0xc bank_mask:0xf
v_add_f32_dpp v185, v185, v185 row_bcast:31 row_mask:0xc bank_mask:0xf
v_add_f32_dpp v186, v186, v186 row_bcast:31 row_mask:0xc bank_mask:0xf
v_add_f32_dpp v187, v187, v187 row_bcast:31 row_mask:0xc bank_mask:0xf
s_lshl_b32 s4, s43, 5
s_add_u32 s4, s4, 157440
v_mov_b32 v14, s4
s_mov_b32 exec_lo, 0
s_brev_b32 exec_hi, 1
ds_write_b128 v14, v[180:183]
s_waitcnt lgkmcnt(11)
ds_write_b128 v14, v[184:187] offset:16
s_mov_b64 exec, -1
s_waitcnt lgkmcnt(0)
s_lshl_b32 s4, s13, 10
s_add_u32 s4, s4, 31588352
buffer_store_dwordx4 v[160:163], v1, s[84:87], s4 offen sc1
s_add_u32 s4, s4, 1048576
buffer_store_dwordx4 v[164:167], v1, s[84:87], s4 offen sc1
s_add_u32 s4, s4, 1048576
s_cmp_lt_u32 s13, 704
s_cbranch_scc0 L_nopk
buffer_store_dwordx4 v[168:171], v1, s[84:87], s4 offen sc1
s_add_u32 s4, s4, 1048576
L_nopk:
s_mov_b32 s88, s56
s_mov_b32 s89, s57
s_mov_b32 s90, s58
s_mov_b32 s91, 0x20000
s_lshr_b32 s4, s43, 1
s_and_b32 s5, s43, 1
s_mul_i32 s9, s4, 262144
s_lshl_b32 s7, s5, 13
s_add_u32 s9, s9, s7
s_and_b32 s7, s3, 7
s_lshl_b32 s7, s7, 7
s_add_u32 s9, s9, s7
s_add_u32 s9, s9, 0
s_mul_i32 s4, s4, 32768
s_lshl_b32 s5, s5, 10
s_add_u32 s4, s4, s5
s_add_u32 s10, s4, 0
s_mov_b32 s8, 16
s_mov_b32 s11, 2048
s_mov_b32 s12, 16384
v_lshrrev_b32 v12, 3, v0
v_and_b32 v15, 2, v12
v_lshlrev_b32 v15, 1, v15
v_xor_b32 v15, v15, v0
v_and_b32 v15, 7, v15
v_lshlrev_b32 v12, 10, v12
v_lshl_add_u32 v12, v15, 4, v12
v_and_b32 v14, 31, v0
v_lshlrev_b32 v15, 2, v5
v_sub_u32 v14, v14, v15
v_mov_b32 v15, 0xf149f2ca
v_cmp_gt_i32 vcc, 0, v14
s_nop 1
v_cndmask_b32 v128, v15, 0, vcc
v_cndmask_b32 v144, 0, v15, vcc
v_cmp_gt_i32 vcc, 1, v14
s_nop 1
v_cndmask_b32 v129, v15, 0, vcc
v_cndmask_b32 v145, 0, v15, vcc
v_cmp_gt_i32 vcc, 2, v14
s_nop 1
v_cndmask_b32 v130, v15, 0, vcc
v_cndmask_b32 v146, 0, v15, vcc
v_cmp_gt_i32 vcc, 3, v14
s_nop 1
v_cndmask_b32 v131, v15, 0, vcc
v_cndmask_b32 v147, 0, v15, vcc
v_cmp_gt_i32 vcc, 8, v14
s_nop 1
v_cndmask_b32 v132, v15, 0, vcc
v_cndmask_b32 v148, 0, v15, vcc
v_cmp_gt_i32 vcc, 9, v14
s_nop 1
v_cndmask_b32 v133, v15, 0, vcc
v_cndmask_b32 v149, 0, v15, vcc
v_cmp_gt_i32 vcc, 10, v14
s_nop 1
v_cndmask_b32 v134, v15, 0, vcc
v_cndmask_b32 v150, 0, v15, vcc
v_cmp_gt_i32 vcc, 11, v14
s_nop 1
v_cndmask_b32 v135, v15, 0, vcc
v_cndmask_b32 v151, 0, v15, vcc
v_cmp_gt_i32 vcc, 16, v14
s_nop 1
v_cndmask_b32 v136, v15, 0, vcc
v_cndmask_b32 v152, 0, v15, vcc
v_cmp_gt_i32 vcc, 17, v14
s_nop 1
v_cndmask_b32 v137, v15, 0, vcc
v_cndmask_b32 v153, 0, v15, vcc
v_cmp_gt_i32 vcc, 18, v14
s_nop 1
v_cndmask_b32 v138, v15, 0, vcc
v_cndmask_b32 v154, 0, v15, vcc
v_cmp_gt_i32 vcc, 19, v14
s_nop 1
v_cndmask_b32 v139, v15, 0, vcc
v_cndmask_b32 v155, 0, v15, vcc
v_cmp_gt_i32 vcc, 24, v14
s_nop 1
v_cndmask_b32 v140, v15, 0, vcc
v_cndmask_b32 v156, 0, v15, vcc
v_cmp_gt_i32 vcc, 25, v14
s_nop 1
v_cndmask_b32 v141, v15, 0, vcc
v_cndmask_b32 v157, 0, v15, vcc
v_cmp_gt_i32 vcc, 26, v14
s_nop 1
v_cndmask_b32 v142, v15, 0, vcc
v_cndmask_b32 v158, 0, v15, vcc
v_cmp_gt_i32 vcc, 27, v14
s_nop 1
v_cndmask_b32 v143, v15, 0, vcc
v_cndmask_b32 v159, 0, v15, vcc
s_waitcnt vmcnt(0)
s_waitcnt lgkmcnt(0)
s_barrier
s_cmp_lg_u32 s43, 1
s_cbranch_scc1 nw_11
v_and_b32 v15, 1, v0
v_lshlrev_b32 v15, 4, v15
v_add_u32 v14, 157312, v15
ds_read_b128 v[160:163], v14 offset:0
ds_read_b128 v[164:167], v14 offset:32
ds_read_b128 v[168:171], v14 offset:64
ds_read_b128 v[172:175], v14 offset:96
s_waitcnt lgkmcnt(0)
v_add_f32 v160, v160, v164
v_add_f32 v168, v168, v172
v_add_f32 v161, v161, v165
v_add_f32 v169, v169, v173
v_add_f32 v162, v162, v166
v_add_f32 v170, v170, v174
v_add_f32 v163, v163, v167
v_add_f32 v171, v171, v175
v_mov_b32 v14, 0xff
v_add_f32 v160, v160, v168
s_lshr_b32 s4, s40, 0
v_bfi_b32 v160, v14, s4, v160
v_add_f32 v161, v161, v169
s_lshr_b32 s4, s40, 8
v_bfi_b32 v161, v14, s4, v161
v_add_f32 v162, v162, v170
s_lshr_b32 s4, s40, 16
v_bfi_b32 v162, v14, s4, v162
v_add_f32 v163, v163, v171
s_lshr_b32 s4, s40, 24
v_bfi_b32 v163, v14, s4, v163
s_add_u32 s4, s94, 12288
s_mov_b64 exec, 3
buffer_store_dwordx4 v[160:163], v15, s[84:87], s4 offen sc1
s_mov_b64 exec, -1
nw_11:
s_cmp_lg_u32 s43, 2
s_cbranch_scc1 nw_12
v_and_b32 v15, 1, v0
v_lshlrev_b32 v15, 4, v15
v_add_u32 v14, 157440, v15
ds_read_b128 v[160:163], v14 offset:0
ds_read_b128 v[164:167], v14 offset:32
ds_read_b128 v[168:171], v14 offset:64
ds_read_b128 v[172:175], v14 offset:96
s_waitcnt lgkmcnt(0)
v_add_f32 v160, v160, v164
v_add_f32 v168, v168, v172
v_add_f32 v161, v161, v165
v_add_f32 v169, v169, v173
v_add_f32 v162, v162, v166
v_add_f32 v170, v170, v174
v_add_f32 v163, v163, v167
v_add_f32 v171, v171, v175
v_mov_b32 v14, 0xff
v_add_f32 v160, v160, v168
s_lshr_b32 s4, s40, 0
v_bfi_b32 v160, v14, s4, v160
v_add_f32 v161, v161, v169
s_lshr_b32 s4, s40, 8
v_bfi_b32 v161, v14, s4, v161
v_add_f32 v162, v162, v170
s_lshr_b32 s4, s40, 16
v_bfi_b32 v162, v14, s4, v162
v_add_f32 v163, v163, v171
s_lshr_b32 s4, s40, 24
v_bfi_b32 v163, v14, s4, v163
s_add_u32 s4, s94, 20480
s_mov_b64 exec, 3
buffer_store_dwordx4 v[160:163], v15, s[84:87], s4 offen sc1
s_mov_b64 exec, -1
nw_12:
s_min_u32 s5, s41, 2
s_min_u32 s6, s41, 1
s_lshl_b32 s5, s5, 8
s_lshl_b32 s6, s6, 8
v_and_b32 v14, 1, v0
v_cmp_eq_u32 vcc, 1, v14
v_mov_b32 v14, s5
v_mov_b32 v15, s6
v_cndmask_b32 v14, v14, v15, vcc
s_lshl_b32 s5, s100, 2
s_add_u32 s5, s5, 32768
v_sub_u32 v14, s5, v14
s_mov_b32 s47, 0x8000
poll_13:
buffer_load_dword v15, v14, s[84:87], 0 offen sc1
s_waitcnt vmcnt(0)
v_cmp_ne_u32 vcc, s40, v15
s_cbranch_vccz pd_14
s_sub_u32 s47, s47, 1
s_cbranch_scc0 poll_13
pd_14:
s_cmp_lt_u32 s41, 2
s_cbranch_scc1 nokv_16
s_sub_u32 s6, s44, 8
s_lshl_b32 s6, s6, 15
s_lshl_b32 s5, s42, 11
s_add_u32 s6, s6, s5
s_add_u32 s7, s6, 8519680
s_add_u32 s6, s6, 4325376
buffer_load_dwordx4 v[16:19], v1, s[84:87], s6 offen offset:0 sc1
buffer_load_dwordx4 v[24:27], v1, s[84:87], s7 offen offset:0 sc1
buffer_load_dwordx4 v[20:23], v1, s[84:87], s6 offen offset:1024 sc1
buffer_load_dwordx4 v[28:31], v1, s[84:87], s7 offen offset:1024 sc1
nokv_16:
s_cmp_lt_u32 s41, 1
s_cbranch_scc1 nokv_17
s_sub_u32 s6, s44, 4
s_lshl_b32 s6, s6, 15
s_lshl_b32 s5, s42, 11
s_add_u32 s6, s6, s5
s_add_u32 s7, s6, 8519680
s_add_u32 s6, s6, 4325376
buffer_load_dwordx4 v[32:35], v1, s[84:87], s6 offen offset:0 sc1
buffer_load_dwordx4 v[40:43], v1, s[84:87], s7 offen offset:0 sc1
buffer_load_dwordx4 v[36:39], v1, s[84:87], s6 offen offset:1024 sc1
buffer_load_dwordx4 v[44:47], v1, s[84:87], s7 offen offset:1024 sc1
nokv_17:
s_waitcnt vmcnt(0)
s_cmp_lt_u32 s41, 2
s_cbranch_scc1 nokv_18
ds_write_b128 v8, v[16:19] offset:0
ds_write_b128 v8, v[20:23] offset:1024
v_cndmask_b32 v80, v113, v24, s[98:99]
v_cndmask_b32 v81, v113, v25, s[98:99]
v_cndmask_b32 v82, v113, v26, s[98:99]
v_cndmask_b32 v83, v113, v27, s[98:99]
v_cndmask_b32 v84, v113, v28, s[98:99]
v_cndmask_b32 v85, v113, v29, s[98:99]
v_cndmask_b32 v86, v113, v30, s[98:99]
v_cndmask_b32 v87, v113, v31, s[98:99]
ds_write_b128 v9, v[80:83] offset:0
ds_write_b128 v9, v[84:87] offset:2048
v_cndmask_b32 v88, v24, v113, s[98:99]
v_cndmask_b32 v89, v25, v113, s[98:99]
v_cndmask_b32 v90, v26, v113, s[98:99]
v_cndmask_b32 v91, v27, v113, s[98:99]
v_cndmask_b32 v92, v28, v113, s[98:99]
v_cndmask_b32 v93, v29, v113, s[98:99]
v_cndmask_b32 v94, v30, v113, s[98:99]
v_cndmask_b32 v95, v31, v113, s[98:99]
ds_write_b128 v9, v[88:91] offset:1024
ds_write_b128 v9, v[92:95] offset:3072
s_waitcnt lgkmcnt(0)
nokv_18:
s_cmp_lt_u32 s41, 1
s_cbranch_scc1 nokv_19
ds_write_b128 v8, v[32:35] offset:8192
ds_write_b128 v8, v[36:39] offset:9216
v_cndmask_b32 v80, v113, v40, s[98:99]
v_cndmask_b32 v81, v113, v41, s[98:99]
v_cndmask_b32 v82, v113, v42, s[98:99]
v_cndmask_b32 v83, v113, v43, s[98:99]
v_cndmask_b32 v84, v113, v44, s[98:99]
v_cndmask_b32 v85, v113, v45, s[98:99]
v_cndmask_b32 v86, v113, v46, s[98:99]
v_cndmask_b32 v87, v113, v47, s[98:99]
ds_write_b128 v9, v[80:83] offset:16384
ds_write_b128 v9, v[84:87] offset:18432
v_cndmask_b32 v88, v40, v113, s[98:99]
v_cndmask_b32 v89, v41, v113, s[98:99]
v_cndmask_b32 v90, v42, v113, s[98:99]
v_cndmask_b32 v91, v43, v113, s[98:99]
v_cndmask_b32 v92, v44, v113, s[98:99]
v_cndmask_b32 v93, v45, v113, s[98:99]
v_cndmask_b32 v94, v46, v113, s[98:99]
v_cndmask_b32 v95, v47, v113, s[98:99]
ds_write_b128 v9, v[88:91] offset:17408
ds_write_b128 v9, v[92:95] offset:19456
s_waitcnt lgkmcnt(0)
nokv_19:
s_waitcnt lgkmcnt(0)
s_barrier
s_lshl_b32 s4, s41, 2
s_add_u32 s4, s4, s43
s_sub_i32 s101, 8, s4
s_max_i32 s101, s101, 0
s_lshl_b32 s5, s43, 11
s_add_u32 s5, s5, 65536
v_add_u32 v8, s5, v1
s_lshl_b32 s5, s43, 12
s_add_u32 s5, s5, 90112
v_add_u32 v9, s5, v1
s_lshr_b32 s13, s2, 3
s_mul_i32 s13, s13, 43
ds_read_b128 v[160:163], v8 offset:0
ds_read_b128 v[164:167], v8 offset:2048
ds_read_b128 v[168:171], v8 offset:4096
ds_read_b128 v[172:175], v8 offset:6144
ds_read_b128 v[176:179], v8 offset:8192
ds_read_b128 v[180:183], v8 offset:10240
ds_read_b128 v[184:187], v8 offset:12288
ds_read_b128 v[188:191], v8 offset:14336
ds_read_b128 v[192:195], v8 offset:16384
ds_read_b128 a[0:3], v9 offset:0
ds_read_b128 a[4:7], v9 offset:2048
ds_read_b128 a[8:11], v9 offset:4096
ds_read_b128 a[12:15], v9 offset:6144
ds_read_b128 a[16:19], v9 offset:8192
ds_read_b128 a[20:23], v9 offset:10240
s_waitcnt lgkmcnt(6)
v_mov_b32 v96, 0xf149f2ca
v_mov_b32 v97, 0xf149f2ca
v_mov_b32 v48, 0
v_mov_b32 v49, 0
v_mov_b32 v50, 0
v_mov_b32 v51, 0
v_mov_b32 v52, 0
v_mov_b32 v53, 0
v_mov_b32 v54, 0
v_mov_b32 v55, 0
v_mov_b32 v56, 0
v_mov_b32 v57, 0
v_mov_b32 v58, 0
v_mov_b32 v59, 0
v_mov_b32 v60, 0
v_mov_b32 v61, 0
v_mov_b32 v62, 0
v_mov_b32 v63, 0
ds_read_b128 a[24:27], v9 offset:12288
ds_read_b128 a[28:31], v9 offset:14336
ds_read_b128 a[32:35], v9 offset:16384
ds_read_b128 a[36:39], v9 offset:18432
ds_read_b128 a[40:43], v9 offset:20480
ds_read_b128 a[44:47], v9 offset:22528
ds_read_b128 a[48:51], v9 offset:24576
ds_read_b128 a[52:55], v9 offset:26624
ds_read_b128 a[56:59], v9 offset:28672
s_waitcnt lgkmcnt(11)
ds_read_b128 a[60:63], v9 offset:30720
ds_read_b128 a[64:67], v9 offset:32768
ds_read_b128 a[68:71], v9 offset:34816
s_cmp_eq_u32 s101, 0
s_cbranch_scc1 e1_20
s_cmp_eq_u32 s101, 1
s_cbranch_scc1 e1_21
s_cmp_eq_u32 s101, 2
s_cbranch_scc1 e1_22
s_cmp_eq_u32 s101, 3
s_cbranch_scc1 e1_23
s_cmp_eq_u32 s101, 4
s_cbranch_scc1 e1_24
s_cmp_eq_u32 s101, 5
s_cbranch_scc1 e1_25
s_cmp_eq_u32 s101, 6
s_cbranch_scc1 e1_26
s_cmp_eq_u32 s101, 7
s_cbranch_scc1 e1_27
s_cmp_eq_u32 s101, 8
s_cbranch_scc1 e1_28
e1_20:
v_mfma_f32_32x32x16_bf16 v[16:31], v[160:163], v[104:107], v[128:143]
v_mfma_f32_32x32x16_bf16 v[32:47], v[164:167], v[104:107], 0
j1_29:
v_mfma_f32_32x32x16_bf16 v[232:247], v[168:171], v[104:107], 0
s_nop 9
v_max3_f32 v96, v16, v17, v96
v_max3_f32 v97, v18, v19, v97
v_max3_f32 v96, v20, v21, v96
v_max3_f32 v97, v22, v23, v97
v_max3_f32 v96, v24, v25, v96
v_max3_f32 v97, v26, v27, v97
v_max3_f32 v96, v28, v29, v96
v_max3_f32 v97, v30, v31, v97
j1_30:
v_mfma_f32_32x32x16_bf16 v[16:31], v[172:175], v[104:107], 0
v_max3_f32 v96, v32, v33, v96
v_max3_f32 v97, v34, v35, v97
v_max3_f32 v96, v36, v37, v96
v_max3_f32 v97, v38, v39, v97
v_max3_f32 v96, v40, v41, v96
v_max3_f32 v97, v42, v43, v97
v_max3_f32 v96, v44, v45, v96
v_max3_f32 v97, v46, v47, v97
j1_31:
v_mfma_f32_32x32x16_bf16 v[32:47], v[176:179], v[104:107], 0
v_max3_f32 v96, v232, v233, v96
v_max3_f32 v97, v234, v235, v97
v_max3_f32 v96, v236, v237, v96
v_max3_f32 v97, v238, v239, v97
v_max3_f32 v96, v240, v241, v96
v_max3_f32 v97, v242, v243, v97
v_max3_f32 v96, v244, v245, v96
v_max3_f32 v97, v246, v247, v97
j1_32:
v_mfma_f32_32x32x16_bf16 v[232:247], v[180:183], v[104:107], 0
v_max3_f32 v96, v16, v17, v96
v_max3_f32 v97, v18, v19, v97
v_max3_f32 v96, v20, v21, v96
v_max3_f32 v97, v22, v23, v97
v_max3_f32 v96, v24, v25, v96
v_max3_f32 v97, v26, v27, v97
v_max3_f32 v96, v28, v29, v96
v_max3_f32 v97, v30, v31, v97
j1_33:
v_mfma_f32_32x32x16_bf16 v[16:31], v[184:187], v[104:107], 0
v_max3_f32 v96, v32, v33, v96
v_max3_f32 v97, v34, v35, v97
v_max3_f32 v96, v36, v37, v96
v_max3_f32 v97, v38, v39, v97
v_max3_f32 v96, v40, v41, v96
v_max3_f32 v97, v42, v43, v97
v_max3_f32 v96, v44, v45, v96
v_max3_f32 v97, v46, v47, v97
j1_34:
v_mfma_f32_32x32x16_bf16 v[32:47], v[188:191], v[104:107], 0
v_max3_f32 v96, v232, v233, v96
v_max3_f32 v97, v234, v235, v97
v_max3_f32 v96, v236, v237, v96
v_max3_f32 v97, v238, v239, v97
v_max3_f32 v96, v240, v241, v96
v_max3_f32 v97, v242, v243, v97
v_max3_f32 v96, v244, v245, v96
v_max3_f32 v97, v246, v247, v97
j1_35:
v_mfma_f32_32x32x16_bf16 v[232:247], v[192:195], v[104:107], v[144:159]
v_max3_f32 v96, v16, v17, v96
v_max3_f32 v97, v18, v19, v97
v_max3_f32 v96, v20, v21, v96
v_max3_f32 v97, v22, v23, v97
v_max3_f32 v96, v24, v25, v96
v_max3_f32 v97, v26, v27, v97
v_max3_f32 v96, v28, v29, v96
v_max3_f32 v97, v30, v31, v97
j1_36:
v_max3_f32 v96, v32, v33, v96
v_max3_f32 v97, v34, v35, v97
v_max3_f32 v96, v36, v37, v96
v_max3_f32 v97, v38, v39, v97
v_max3_f32 v96, v40, v41, v96
v_max3_f32 v97, v42, v43, v97
v_max3_f32 v96, v44, v45, v96
v_max3_f32 v97, v46, v47, v97
j1_37:
v_max3_f32 v96, v232, v233, v96
v_max3_f32 v97, v234, v235, v97
v_max3_f32 v96, v236, v237, v96
v_max3_f32 v97, v238, v239, v97
v_max3_f32 v96, v240, v241, v96
v_max3_f32 v97, v242, v243, v97
v_max3_f32 v96, v244, v245, v96
v_max3_f32 v97, v246, v247, v97
s_branch f1_38
e1_21:
v_mfma_f32_32x32x16_bf16 v[32:47], v[164:167], v[104:107], 0
v_mfma_f32_32x32x16_bf16 v[232:247], v[168:171], v[104:107], 0
s_nop 11
s_branch j1_30
e1_22:
v_mfma_f32_32x32x16_bf16 v[232:247], v[168:171], v[104:107], 0
v_mfma_f32_32x32x16_bf16 v[16:31], v[172:175], v[104:107], 0
s_nop 11
s_branch j1_31
e1_23:
v_mfma_f32_32x32x16_bf16 v[16:31], v[172:175], v[104:107], 0
v_mfma_f32_32x32x16_bf16 v[32:47], v[176:179], v[104:107], 0
s_nop 11
s_branch j1_32
e1_24:
v_mfma_f32_32x32x16_bf16 v[32:47], v[176:179], v[104:107], 0
v_mfma_f32_32x32x16_bf16 v[232:247], v[180:183], v[104:107], 0
s_nop 11
s_branch j1_33
e1_25:
v_mfma_f32_32x32x16_bf16 v[232:247], v[180:183], v[104:107], 0
v_mfma_f32_32x32x16_bf16 v[16:31], v[184:187], v[104:107], 0
s_nop 11
s_branch j1_34
e1_26:
v_mfma_f32_32x32x16_bf16 v[16:31], v[184:187], v[104:107], 0
v_mfma_f32_32x32x16_bf16 v[32:47], v[188:191], v[104:107], 0
s_nop 11
s_branch j1_35
e1_27:
v_mfma_f32_32x32x16_bf16 v[32:47], v[188:191], v[104:107], 0
v_mfma_f32_32x32x16_bf16 v[232:247], v[192:195], v[104:107], v[144:159]
s_nop 11
s_branch j1_36
e1_28:
v_mfma_f32_32x32x16_bf16 v[232:247], v[192:195], v[104:107], v[144:159]
s_nop 11
s_branch j1_37
f1_38:
v_max_f32 v96, v96, v97
v_mov_b32 v97, v96
s_nop 1
v_permlane32_swap_b32 v96, v97
v_max_f32 v96, v96, v97
v_sub_f32 v112, v144, v96
v_sub_f32 v113, v145, v96
v_sub_f32 v114, v146, v96
v_sub_f32 v115, v147, v96
v_sub_f32 v116, v148, v96
v_sub_f32 v117, v149, v96
v_sub_f32 v118, v150, v96
v_sub_f32 v119, v151, v96
v_sub_f32 v120, v152, v96
v_sub_f32 v121, v153, v96
v_sub_f32 v122, v154, v96
v_sub_f32 v123, v155, v96
v_sub_f32 v124, v156, v96
v_sub_f32 v125, v157, v96
v_sub_f32 v126, v158, v96
v_sub_f32 v127, v159, v96
v_sub_f32 v64, 0, v96
v_sub_f32 v65, 0, v96
v_sub_f32 v66, 0, v96
v_sub_f32 v67, 0, v96
v_sub_f32 v68, 0, v96
v_sub_f32 v69, 0, v96
v_sub_f32 v70, 0, v96
v_sub_f32 v71, 0, v96
v_sub_f32 v72, 0, v96
v_sub_f32 v73, 0, v96
v_sub_f32 v74, 0, v96
v_sub_f32 v75, 0, v96
v_sub_f32 v76, 0, v96
v_sub_f32 v77, 0, v96
v_sub_f32 v78, 0, v96
v_sub_f32 v79, 0, v96
v_sub_f32 v80, v128, v96
v_sub_f32 v81, v129, v96
v_sub_f32 v82, v130, v96
v_sub_f32 v83, v131, v96
v_sub_f32 v84, v132, v96
v_sub_f32 v85, v133, v96
v_sub_f32 v86, v134, v96
v_sub_f32 v87, v135, v96
v_sub_f32 v88, v136, v96
v_sub_f32 v89, v137, v96
v_sub_f32 v90, v138, v96
v_sub_f32 v91, v139, v96
v_sub_f32 v92, v140, v96
v_sub_f32 v93, v141, v96
v_sub_f32 v94, v142, v96
v_sub_f32 v95, v143, v96
ds_read_b128 v[196:199], v8 offset:1024
s_waitcnt lgkmcnt(11)
ds_read_b128 v[200:203], v8 offset:3072
ds_read_b128 v[204:207], v8 offset:5120
ds_read_b128 v[208:211], v8 offset:7168
ds_read_b128 v[212:215], v8 offset:9216
s_waitcnt lgkmcnt(11)
ds_read_b128 v[216:219], v8 offset:11264
ds_read_b128 v[220:223], v8 offset:13312
ds_read_b128 v[224:227], v8 offset:15360
ds_read_b128 v[228:231], v8 offset:17408
s_waitcnt lgkmcnt(11)
ds_read_b128 a[72:75], v9 offset:1024
ds_read_b128 a[76:79], v9 offset:3072
ds_read_b128 a[80:83], v9 offset:5120
ds_read_b128 a[84:87], v9 offset:7168
s_waitcnt lgkmcnt(11)
ds_read_b128 a[88:91], v9 offset:9216
ds_read_b128 a[92:95], v9 offset:11264
s_cmp_eq_u32 s101, 0
s_cbranch_scc1 e2_39
s_cmp_eq_u32 s101, 1
s_cbranch_scc1 e2_40
s_cmp_eq_u32 s101, 2
s_cbranch_scc1 e2_41
s_cmp_eq_u32 s101, 3
s_cbranch_scc1 e2_42
s_cmp_eq_u32 s101, 4
s_cbranch_scc1 e2_43
s_cmp_eq_u32 s101, 5
s_cbranch_scc1 e2_44
s_cmp_eq_u32 s101, 6
s_cbranch_scc1 e2_45
s_cmp_eq_u32 s101, 7
s_cbranch_scc1 e2_46
s_cmp_eq_u32 s101, 8
s_cbranch_scc1 e2_47
e2_39:
v_mfma_f32_32x32x16_bf16 v[16:31], v[160:163], v[104:107], v[80:95]
j2_48:
v_mfma_f32_32x32x16_bf16 v[32:47], v[164:167], v[104:107], v[64:79]
s_nop 10
v_exp_f32 v16, v16
v_exp_f32 v17, v17
v_exp_f32 v18, v18
v_exp_f32 v19, v19
v_exp_f32 v20, v20
v_exp_f32 v21, v21
v_exp_f32 v22, v22
v_exp_f32 v23, v23
v_cvt_pk_bf16_f32 v96, v16, v17
v_cvt_pk_bf16_f32 v97, v18, v19
v_cvt_pk_bf16_f32 v98, v20, v21
v_cvt_pk_bf16_f32 v99, v22, v23
v_exp_f32 v24, v24
v_exp_f32 v25, v25
v_exp_f32 v26, v26
v_exp_f32 v27, v27
v_exp_f32 v28, v28
v_exp_f32 v29, v29
v_exp_f32 v30, v30
v_exp_f32 v31, v31
v_mfma_f32_32x32x16_bf16 v[48:63], a[0:3], v[96:99], v[48:63]
v_cvt_pk_bf16_f32 v100, v24, v25
v_cvt_pk_bf16_f32 v101, v26, v27
v_cvt_pk_bf16_f32 v102, v28, v29
v_cvt_pk_bf16_f32 v103, v30, v31
s_nop 1
v_mfma_f32_32x32x16_bf16 v[48:63], a[4:7], v[100:103], v[48:63]
s_mov_b32 m0, s10
s_add_u32 s10, s10, s11
buffer_load_dwordx4 v12, s[88:91], s9 offen sc1 lds
s_add_u32 s9, s9, s12
s_sub_u32 s8, s8, 1
s_mov_b32 m0, s10
s_add_u32 s10, s10, s11
buffer_load_dwordx4 v12, s[88:91], s9 offen sc1 lds
s_add_u32 s9, s9, s12
s_sub_u32 s8, s8, 1
j2_49:
v_mfma_f32_32x32x16_bf16 v[16:31], v[168:171], v[104:107], v[64:79]
v_exp_f32 v32, v32
v_exp_f32 v33, v33
v_exp_f32 v34, v34
v_exp_f32 v35, v35
v_exp_f32 v36, v36
v_exp_f32 v37, v37
v_exp_f32 v38, v38
v_exp_f32 v39, v39
v_cvt_pk_bf16_f32 v96, v32, v33
v_cvt_pk_bf16_f32 v97, v34, v35
v_cvt_pk_bf16_f32 v98, v36, v37
v_cvt_pk_bf16_f32 v99, v38, v39
v_exp_f32 v40, v40
v_exp_f32 v41, v41
v_exp_f32 v42, v42
v_exp_f32 v43, v43
v_exp_f32 v44, v44
v_exp_f32 v45, v45
v_exp_f32 v46, v46
v_exp_f32 v47, v47
v_mfma_f32_32x32x16_bf16 v[48:63], a[8:11], v[96:99], v[48:63]
v_cvt_pk_bf16_f32 v100, v40, v41
v_cvt_pk_bf16_f32 v101, v42, v43
v_cvt_pk_bf16_f32 v102, v44, v45
v_cvt_pk_bf16_f32 v103, v46, v47
s_nop 1
v_mfma_f32_32x32x16_bf16 v[48:63], a[12:15], v[100:103], v[48:63]
s_mov_b32 m0, s10
s_add_u32 s10, s10, s11
buffer_load_dwordx4 v12, s[88:91], s9 offen sc1 lds
s_add_u32 s9, s9, s12
s_sub_u32 s8, s8, 1
s_mov_b32 m0, s10
s_add_u32 s10, s10, s11
buffer_load_dwordx4 v12, s[88:91], s9 offen sc1 lds
s_add_u32 s9, s9, s12
s_sub_u32 s8, s8, 1
j2_50:
v_mfma_f32_32x32x16_bf16 v[32:47], v[172:175], v[104:107], v[64:79]
v_exp_f32 v16, v16
v_exp_f32 v17, v17
v_exp_f32 v18, v18
v_exp_f32 v19, v19
v_exp_f32 v20, v20
v_exp_f32 v21, v21
v_exp_f32 v22, v22
v_exp_f32 v23, v23
v_cvt_pk_bf16_f32 v96, v16, v17
v_cvt_pk_bf16_f32 v97, v18, v19
v_cvt_pk_bf16_f32 v98, v20, v21
v_cvt_pk_bf16_f32 v99, v22, v23
v_exp_f32 v24, v24
v_exp_f32 v25, v25
v_exp_f32 v26, v26
v_exp_f32 v27, v27
v_exp_f32 v28, v28
v_exp_f32 v29, v29
v_exp_f32 v30, v30
v_exp_f32 v31, v31
v_mfma_f32_32x32x16_bf16 v[48:63], a[16:19], v[96:99], v[48:63]
v_cvt_pk_bf16_f32 v100, v24, v25
v_cvt_pk_bf16_f32 v101, v26, v27
v_cvt_pk_bf16_f32 v102, v28, v29
v_cvt_pk_bf16_f32 v103, v30, v31
s_nop 1
v_mfma_f32_32x32x16_bf16 v[48:63], a[20:23], v[100:103], v[48:63]
s_mov_b32 m0, s10
s_add_u32 s10, s10, s11
buffer_load_dwordx4 v12, s[88:91], s9 offen sc1 lds
s_add_u32 s9, s9, s12
s_sub_u32 s8, s8, 1
s_mov_b32 m0, s10
s_add_u32 s10, s10, s11
buffer_load_dwordx4 v12, s[88:91], s9 offen sc1 lds
s_add_u32 s9, s9, s12
s_sub_u32 s8, s8, 1
j2_51:
v_mfma_f32_32x32x16_bf16 v[16:31], v[176:179], v[104:107], v[64:79]
v_exp_f32 v32, v32
v_exp_f32 v33, v33
v_exp_f32 v34, v34
v_exp_f32 v35, v35
v_exp_f32 v36, v36
v_exp_f32 v37, v37
v_exp_f32 v38, v38
v_exp_f32 v39, v39
v_cvt_pk_bf16_f32 v96, v32, v33
v_cvt_pk_bf16_f32 v97, v34, v35
v_cvt_pk_bf16_f32 v98, v36, v37
v_cvt_pk_bf16_f32 v99, v38, v39
v_exp_f32 v40, v40
v_exp_f32 v41, v41
v_exp_f32 v42, v42
v_exp_f32 v43, v43
v_exp_f32 v44, v44
v_exp_f32 v45, v45
v_exp_f32 v46, v46
v_exp_f32 v47, v47
v_mfma_f32_32x32x16_bf16 v[48:63], a[24:27], v[96:99], v[48:63]
v_cvt_pk_bf16_f32 v100, v40, v41
v_cvt_pk_bf16_f32 v101, v42, v43
v_cvt_pk_bf16_f32 v102, v44, v45
v_cvt_pk_bf16_f32 v103, v46, v47
s_nop 1
v_mfma_f32_32x32x16_bf16 v[48:63], a[28:31], v[100:103], v[48:63]
s_mov_b32 m0, s10
s_add_u32 s10, s10, s11
buffer_load_dwordx4 v12, s[88:91], s9 offen sc1 lds
s_add_u32 s9, s9, s12
s_sub_u32 s8, s8, 1
s_mov_b32 m0, s10
s_add_u32 s10, s10, s11
buffer_load_dwordx4 v12, s[88:91], s9 offen sc1 lds
s_add_u32 s9, s9, s12
s_sub_u32 s8, s8, 1
j2_52:
v_mfma_f32_32x32x16_bf16 v[32:47], v[180:183], v[104:107], v[64:79]
v_exp_f32 v16, v16
v_exp_f32 v17, v17
v_exp_f32 v18, v18
v_exp_f32 v19, v19
v_exp_f32 v20, v20
v_exp_f32 v21, v21
v_exp_f32 v22, v22
v_exp_f32 v23, v23
v_cvt_pk_bf16_f32 v96, v16, v17
v_cvt_pk_bf16_f32 v97, v18, v19
v_cvt_pk_bf16_f32 v98, v20, v21
v_cvt_pk_bf16_f32 v99, v22, v23
v_exp_f32 v24, v24
v_exp_f32 v25, v25
v_exp_f32 v26, v26
v_exp_f32 v27, v27
v_exp_f32 v28, v28
v_exp_f32 v29, v29
v_exp_f32 v30, v30
v_exp_f32 v31, v31
v_mfma_f32_32x32x16_bf16 v[48:63], a[32:35], v[96:99], v[48:63]
v_cvt_pk_bf16_f32 v100, v24, v25
v_cvt_pk_bf16_f32 v101, v26, v27
v_cvt_pk_bf16_f32 v102, v28, v29
v_cvt_pk_bf16_f32 v103, v30, v31
s_nop 1
v_mfma_f32_32x32x16_bf16 v[48:63], a[36:39], v[100:103], v[48:63]
s_mov_b32 m0, s10
s_add_u32 s10, s10, s11
buffer_load_dwordx4 v12, s[88:91], s9 offen sc1 lds
s_add_u32 s9, s9, s12
s_sub_u32 s8, s8, 1
s_mov_b32 m0, s10
s_add_u32 s10, s10, s11
buffer_load_dwordx4 v12, s[88:91], s9 offen sc1 lds
s_add_u32 s9, s9, s12
s_sub_u32 s8, s8, 1
j2_53:
v_mfma_f32_32x32x16_bf16 v[16:31], v[184:187], v[104:107], v[64:79]
v_exp_f32 v32, v32
v_exp_f32 v33, v33
v_exp_f32 v34, v34
v_exp_f32 v35, v35
v_exp_f32 v36, v36
v_exp_f32 v37, v37
v_exp_f32 v38, v38
v_exp_f32 v39, v39
v_cvt_pk_bf16_f32 v96, v32, v33
v_cvt_pk_bf16_f32 v97, v34, v35
v_cvt_pk_bf16_f32 v98, v36, v37
v_cvt_pk_bf16_f32 v99, v38, v39
v_exp_f32 v40, v40
v_exp_f32 v41, v41
v_exp_f32 v42, v42
v_exp_f32 v43, v43
v_exp_f32 v44, v44
v_exp_f32 v45, v45
v_exp_f32 v46, v46
v_exp_f32 v47, v47
v_mfma_f32_32x32x16_bf16 v[48:63], a[40:43], v[96:99], v[48:63]
v_cvt_pk_bf16_f32 v100, v40, v41
v_cvt_pk_bf16_f32 v101, v42, v43
v_cvt_pk_bf16_f32 v102, v44, v45
v_cvt_pk_bf16_f32 v103, v46, v47
s_nop 1
v_mfma_f32_32x32x16_bf16 v[48:63], a[44:47], v[100:103], v[48:63]
s_mov_b32 m0, s10
s_add_u32 s10, s10, s11
buffer_load_dwordx4 v12, s[88:91], s9 offen sc1 lds
s_add_u32 s9, s9, s12
s_sub_u32 s8, s8, 1
s_mov_b32 m0, s10
s_add_u32 s10, s10, s11
buffer_load_dwordx4 v12, s[88:91], s9 offen sc1 lds
s_add_u32 s9, s9, s12
s_sub_u32 s8, s8, 1
j2_54:
v_mfma_f32_32x32x16_bf16 v[32:47], v[188:191], v[104:107], v[64:79]
v_exp_f32 v16, v16
v_exp_f32 v17, v17
v_exp_f32 v18, v18
v_exp_f32 v19, v19
v_exp_f32 v20, v20
v_exp_f32 v21, v21
v_exp_f32 v22, v22
v_exp_f32 v23, v23
v_cvt_pk_bf16_f32 v96, v16, v17
v_cvt_pk_bf16_f32 v97, v18, v19
v_cvt_pk_bf16_f32 v98, v20, v21
v_cvt_pk_bf16_f32 v99, v22, v23
v_exp_f32 v24, v24
v_exp_f32 v25, v25
v_exp_f32 v26, v26
v_exp_f32 v27, v27
v_exp_f32 v28, v28
v_exp_f32 v29, v29
v_exp_f32 v30, v30
v_exp_f32 v31, v31
v_mfma_f32_32x32x16_bf16 v[48:63], a[48:51], v[96:99], v[48:63]
v_cvt_pk_bf16_f32 v100, v24, v25
v_cvt_pk_bf16_f32 v101, v26, v27
v_cvt_pk_bf16_f32 v102, v28, v29
v_cvt_pk_bf16_f32 v103, v30, v31
s_nop 1
v_mfma_f32_32x32x16_bf16 v[48:63], a[52:55], v[100:103], v[48:63]
s_mov_b32 m0, s10
s_add_u32 s10, s10, s11
buffer_load_dwordx4 v12, s[88:91], s9 offen sc1 lds
s_add_u32 s9, s9, s12
s_sub_u32 s8, s8, 1
s_mov_b32 m0, s10
s_add_u32 s10, s10, s11
buffer_load_dwordx4 v12, s[88:91], s9 offen sc1 lds
s_add_u32 s9, s9, s12
s_sub_u32 s8, s8, 1
j2_55:
v_mfma_f32_32x32x16_bf16 v[16:31], v[192:195], v[104:107], v[112:127]
v_exp_f32 v32, v32
v_exp_f32 v33, v33
v_exp_f32 v34, v34
v_exp_f32 v35, v35
v_exp_f32 v36, v36
v_exp_f32 v37, v37
v_exp_f32 v38, v38
v_exp_f32 v39, v39
v_cvt_pk_bf16_f32 v96, v32, v33
v_cvt_pk_bf16_f32 v97, v34, v35
v_cvt_pk_bf16_f32 v98, v36, v37
v_cvt_pk_bf16_f32 v99, v38, v39
v_exp_f32 v40, v40
v_exp_f32 v41, v41
v_exp_f32 v42, v42
v_exp_f32 v43, v43
v_exp_f32 v44, v44
v_exp_f32 v45, v45
v_exp_f32 v46, v46
v_exp_f32 v47, v47
v_mfma_f32_32x32x16_bf16 v[48:63], a[56:59], v[96:99], v[48:63]
v_cvt_pk_bf16_f32 v100, v40, v41
v_cvt_pk_bf16_f32 v101, v42, v43
v_cvt_pk_bf16_f32 v102, v44, v45
v_cvt_pk_bf16_f32 v103, v46, v47
s_nop 1
v_mfma_f32_32x32x16_bf16 v[48:63], a[60:63], v[100:103], v[48:63]
s_mov_b32 m0, s10
s_add_u32 s10, s10, s11
buffer_load_dwordx4 v12, s[88:91], s9 offen sc1 lds
s_add_u32 s9, s9, s12
s_sub_u32 s8, s8, 1
s_mov_b32 m0, s10
s_add_u32 s10, s10, s11
buffer_load_dwordx4 v12, s[88:91], s9 offen sc1 lds
s_add_u32 s9, s9, s12
s_sub_u32 s8, s8, 1
j2_56:
s_nop 0
v_exp_f32 v16, v16
v_exp_f32 v17, v17
v_exp_f32 v18, v18
v_exp_f32 v19, v19
v_exp_f32 v20, v20
v_exp_f32 v21, v21
v_exp_f32 v22, v22
v_exp_f32 v23, v23
v_cvt_pk_bf16_f32 v96, v16, v17
v_cvt_pk_bf16_f32 v97, v18, v19
v_cvt_pk_bf16_f32 v98, v20, v21
v_cvt_pk_bf16_f32 v99, v22, v23
v_exp_f32 v24, v24
v_exp_f32 v25, v25
v_exp_f32 v26, v26
v_exp_f32 v27, v27
v_exp_f32 v28, v28
v_exp_f32 v29, v29
v_exp_f32 v30, v30
v_exp_f32 v31, v31
v_mfma_f32_32x32x16_bf16 v[48:63], a[64:67], v[96:99], v[48:63]
v_cvt_pk_bf16_f32 v100, v24, v25
v_cvt_pk_bf16_f32 v101, v26, v27
v_cvt_pk_bf16_f32 v102, v28, v29
v_cvt_pk_bf16_f32 v103, v30, v31
s_nop 1
v_mfma_f32_32x32x16_bf16 v[48:63], a[68:71], v[100:103], v[48:63]
s_nop 11
s_branch f2_57
e2_40:
v_mfma_f32_32x32x16_bf16 v[32:47], v[164:167], v[104:107], v[64:79]
s_nop 11
s_branch j2_49
e2_41:
v_mfma_f32_32x32x16_bf16 v[16:31], v[168:171], v[104:107], v[64:79]
s_nop 11
s_branch j2_50
e2_42:
v_mfma_f32_32x32x16_bf16 v[32:47], v[172:175], v[104:107], v[64:79]
s_nop 11
s_branch j2_51
e2_43:
v_mfma_f32_32x32x16_bf16 v[16:31], v[176:179], v[104:107], v[64:79]
s_nop 11
s_branch j2_52
e2_44:
v_mfma_f32_32x32x16_bf16 v[32:47], v[180:183], v[104:107], v[64:79]
s_nop 11
s_branch j2_53
e2_45:
v_mfma_f32_32x32x16_bf16 v[16:31], v[184:187], v[104:107], v[64:79]
s_nop 11
s_branch j2_54
e2_46:
v_mfma_f32_32x32x16_bf16 v[32:47], v[188:191], v[104:107], v[64:79]
s_nop 11
s_branch j2_55
e2_47:
v_mfma_f32_32x32x16_bf16 v[16:31], v[192:195], v[104:107], v[112:127]
s_nop 11
s_branch j2_56
f2_57:
br_58:
s_cmp_eq_u32 s8, 0
s_cbranch_scc1 bd_59
s_mov_b32 m0, s10
s_add_u32 s10, s10, s11
buffer_load_dwordx4 v12, s[88:91], s9 offen sc1 lds
s_add_u32 s9, s9, s12
s_sub_u32 s8, s8, 1
s_branch br_58
bd_59:
ds_read_b128 a[96:99], v9 offset:13312
ds_read_b128 a[100:103], v9 offset:15360
s_waitcnt lgkmcnt(11)
ds_read_b128 a[104:107], v9 offset:17408
ds_read_b128 a[108:111], v9 offset:19456
ds_read_b128 a[112:115], v9 offset:21504
ds_read_b128 a[116:119], v9 offset:23552
s_waitcnt lgkmcnt(11)
ds_read_b128 a[120:123], v9 offset:25600
ds_read_b128 a[124:127], v9 offset:27648
ds_read_b128 a[128:131], v9 offset:29696
ds_read_b128 a[132:135], v9 offset:31744
s_waitcnt lgkmcnt(11)
ds_read_b128 a[136:139], v9 offset:33792
ds_read_b128 a[140:143], v9 offset:35840
s_waitcnt lgkmcnt(0)
v_lshlrev_b32 v8, 4, v4
v_add_u32 v6, 12288, v8
s_mov_b32 s5, 0
buffer_load_dwordx4 v[168:171], v6, s[84:87], s5 offen sc1
s_mov_b32 s5, 4096
buffer_load_dwordx4 v[172:175], v6, s[84:87], s5 offen sc1
s_mov_b32 s5, 8192
buffer_load_dwordx4 v[176:179], v6, s[84:87], s5 offen sc1
s_mov_b32 s5, 12288
buffer_load_dwordx4 v[180:183], v6, s[84:87], s5 offen sc1
s_and_b32 s4, s3, 7
s_lshl_b32 s4, s4, 1
s_add_u32 s97, s4, s93
v_and_b32 v14, 31, v0
v_lshlrev_b32 v11, 10, v14
v_lshl_add_u32 v11, v5, 3, v11
s_lshl_b32 s4, s45, 15
s_lshl_b32 s5, s97, 6
s_add_u32 s98, s4, s5
buffer_load_dwordx2 a[232:233], v11, s[48:51], s98 offen offset:0
buffer_load_dwordx2 a[234:235], v11, s[48:51], s98 offen offset:16
buffer_load_dwordx2 a[236:237], v11, s[48:51], s98 offen offset:32
buffer_load_dwordx2 a[238:239], v11, s[48:51], s98 offen offset:48
v_rcp_f32 v56, v56
s_nop 0
v_mul_f32 v48, v48, v56
v_mul_f32 v49, v49, v56
v_mul_f32 v50, v50, v56
v_mul_f32 v51, v51, v56
v_mul_f32 v52, v52, v56
v_mul_f32 v53, v53, v56
v_mul_f32 v54, v54, v56
v_mul_f32 v55, v55, v56
v_cvt_pk_bf16_f32 v248, v48, v49
v_cvt_pk_bf16_f32 v249, v50, v51
v_cvt_pk_bf16_f32 v250, v52, v53
v_cvt_pk_bf16_f32 v251, v54, v55
s_lshl_b32 s6, s44, 15
s_lshl_b32 s5, s42, 11
s_add_u32 s6, s6, s5
s_add_u32 s6, s6, 12713984
buffer_store_dwordx4 v[248:251], v1, s[84:87], s6 offen offset:0 sc1
v_mov_b32 v96, 0xf149f2ca
v_mov_b32 v97, 0xf149f2ca
v_mov_b32 v48, 0
v_mov_b32 v49, 0
v_mov_b32 v50, 0
v_mov_b32 v51, 0
v_mov_b32 v52, 0
v_mov_b32 v53, 0
v_mov_b32 v54, 0
v_mov_b32 v55, 0
v_mov_b32 v56, 0
v_mov_b32 v57, 0
v_mov_b32 v58, 0
v_mov_b32 v59, 0
v_mov_b32 v60, 0
v_mov_b32 v61, 0
v_mov_b32 v62, 0
v_mov_b32 v63, 0
s_cmp_eq_u32 s101, 0
s_cbranch_scc1 e1_60
s_cmp_eq_u32 s101, 1
s_cbranch_scc1 e1_61
s_cmp_eq_u32 s101, 2
s_cbranch_scc1 e1_62
s_cmp_eq_u32 s101, 3
s_cbranch_scc1 e1_63
s_cmp_eq_u32 s101, 4
s_cbranch_scc1 e1_64
s_cmp_eq_u32 s101, 5
s_cbranch_scc1 e1_65
s_cmp_eq_u32 s101, 6
s_cbranch_scc1 e1_66
s_cmp_eq_u32 s101, 7
s_cbranch_scc1 e1_67
s_cmp_eq_u32 s101, 8
s_cbranch_scc1 e1_68
e1_60:
v_mfma_f32_32x32x16_bf16 v[16:31], v[196:199], v[108:111], v[128:143]
v_mfma_f32_32x32x16_bf16 v[32:47], v[200:203], v[108:111], 0
j1_69:
v_mfma_f32_32x32x16_bf16 v[232:247], v[204:207], v[108:111], 0
s_nop 9
v_max3_f32 v96, v16, v17, v96
v_max3_f32 v97, v18, v19, v97
v_max3_f32 v96, v20, v21, v96
v_max3_f32 v97, v22, v23, v97
v_max3_f32 v96, v24, v25, v96
v_max3_f32 v97, v26, v27, v97
v_max3_f32 v96, v28, v29, v96
v_max3_f32 v97, v30, v31, v97
j1_70:
v_mfma_f32_32x32x16_bf16 v[16:31], v[208:211], v[108:111], 0
v_max3_f32 v96, v32, v33, v96
v_max3_f32 v97, v34, v35, v97
v_max3_f32 v96, v36, v37, v96
v_max3_f32 v97, v38, v39, v97
v_max3_f32 v96, v40, v41, v96
v_max3_f32 v97, v42, v43, v97
v_max3_f32 v96, v44, v45, v96
v_max3_f32 v97, v46, v47, v97
j1_71:
v_mfma_f32_32x32x16_bf16 v[32:47], v[212:215], v[108:111], 0
v_max3_f32 v96, v232, v233, v96
v_max3_f32 v97, v234, v235, v97
v_max3_f32 v96, v236, v237, v96
v_max3_f32 v97, v238, v239, v97
v_max3_f32 v96, v240, v241, v96
v_max3_f32 v97, v242, v243, v97
v_max3_f32 v96, v244, v245, v96
v_max3_f32 v97, v246, v247, v97
j1_72:
v_mfma_f32_32x32x16_bf16 v[232:247], v[216:219], v[108:111], 0
v_max3_f32 v96, v16, v17, v96
v_max3_f32 v97, v18, v19, v97
v_max3_f32 v96, v20, v21, v96
v_max3_f32 v97, v22, v23, v97
v_max3_f32 v96, v24, v25, v96
v_max3_f32 v97, v26, v27, v97
v_max3_f32 v96, v28, v29, v96
v_max3_f32 v97, v30, v31, v97
j1_73:
v_mfma_f32_32x32x16_bf16 v[16:31], v[220:223], v[108:111], 0
v_max3_f32 v96, v32, v33, v96
v_max3_f32 v97, v34, v35, v97
v_max3_f32 v96, v36, v37, v96
v_max3_f32 v97, v38, v39, v97
v_max3_f32 v96, v40, v41, v96
v_max3_f32 v97, v42, v43, v97
v_max3_f32 v96, v44, v45, v96
v_max3_f32 v97, v46, v47, v97
j1_74:
v_mfma_f32_32x32x16_bf16 v[32:47], v[224:227], v[108:111], 0
v_max3_f32 v96, v232, v233, v96
v_max3_f32 v97, v234, v235, v97
v_max3_f32 v96, v236, v237, v96
v_max3_f32 v97, v238, v239, v97
v_max3_f32 v96, v240, v241, v96
v_max3_f32 v97, v242, v243, v97
v_max3_f32 v96, v244, v245, v96
v_max3_f32 v97, v246, v247, v97
j1_75:
v_mfma_f32_32x32x16_bf16 v[232:247], v[228:231], v[108:111], v[144:159]
v_max3_f32 v96, v16, v17, v96
v_max3_f32 v97, v18, v19, v97
v_max3_f32 v96, v20, v21, v96
v_max3_f32 v97, v22, v23, v97
v_max3_f32 v96, v24, v25, v96
v_max3_f32 v97, v26, v27, v97
v_max3_f32 v96, v28, v29, v96
v_max3_f32 v97, v30, v31, v97
j1_76:
v_max3_f32 v96, v32, v33, v96
v_max3_f32 v97, v34, v35, v97
v_max3_f32 v96, v36, v37, v96
v_max3_f32 v97, v38, v39, v97
v_max3_f32 v96, v40, v41, v96
v_max3_f32 v97, v42, v43, v97
v_max3_f32 v96, v44, v45, v96
v_max3_f32 v97, v46, v47, v97
j1_77:
v_max3_f32 v96, v232, v233, v96
v_max3_f32 v97, v234, v235, v97
v_max3_f32 v96, v236, v237, v96
v_max3_f32 v97, v238, v239, v97
v_max3_f32 v96, v240, v241, v96
v_max3_f32 v97, v242, v243, v97
v_max3_f32 v96, v244, v245, v96
v_max3_f32 v97, v246, v247, v97
s_branch f1_78
e1_61:
v_mfma_f32_32x32x16_bf16 v[32:47], v[200:203], v[108:111], 0
v_mfma_f32_32x32x16_bf16 v[232:247], v[204:207], v[108:111], 0
s_nop 11
s_branch j1_70
e1_62:
v_mfma_f32_32x32x16_bf16 v[232:247], v[204:207], v[108:111], 0
v_mfma_f32_32x32x16_bf16 v[16:31], v[208:211], v[108:111], 0
s_nop 11
s_branch j1_71
e1_63:
v_mfma_f32_32x32x16_bf16 v[16:31], v[208:211], v[108:111], 0
v_mfma_f32_32x32x16_bf16 v[32:47], v[212:215], v[108:111], 0
s_nop 11
s_branch j1_72
e1_64:
v_mfma_f32_32x32x16_bf16 v[32:47], v[212:215], v[108:111], 0
v_mfma_f32_32x32x16_bf16 v[232:247], v[216:219], v[108:111], 0
s_nop 11
s_branch j1_73
e1_65:
v_mfma_f32_32x32x16_bf16 v[232:247], v[216:219], v[108:111], 0
v_mfma_f32_32x32x16_bf16 v[16:31], v[220:223], v[108:111], 0
s_nop 11
s_branch j1_74
e1_66:
v_mfma_f32_32x32x16_bf16 v[16:31], v[220:223], v[108:111], 0
v_mfma_f32_32x32x16_bf16 v[32:47], v[224:227], v[108:111], 0
s_nop 11
s_branch j1_75
e1_67:
v_mfma_f32_32x32x16_bf16 v[32:47], v[224:227], v[108:111], 0
v_mfma_f32_32x32x16_bf16 v[232:247], v[228:231], v[108:111], v[144:159]
s_nop 11
s_branch j1_76
e1_68:
v_mfma_f32_32x32x16_bf16 v[232:247], v[228:231], v[108:111], v[144:159]
s_nop 11
s_branch j1_77
f1_78:
v_max_f32 v96, v96, v97
v_mov_b32 v97, v96
s_nop 1
v_permlane32_swap_b32 v96, v97
v_max_f32 v96, v96, v97
v_sub_f32 v112, v144, v96
v_sub_f32 v113, v145, v96
v_sub_f32 v114, v146, v96
v_sub_f32 v115, v147, v96
v_sub_f32 v116, v148, v96
v_sub_f32 v117, v149, v96
v_sub_f32 v118, v150, v96
v_sub_f32 v119, v151, v96
v_sub_f32 v120, v152, v96
v_sub_f32 v121, v153, v96
v_sub_f32 v122, v154, v96
v_sub_f32 v123, v155, v96
v_sub_f32 v124, v156, v96
v_sub_f32 v125, v157, v96
v_sub_f32 v126, v158, v96
v_sub_f32 v127, v159, v96
v_sub_f32 v64, 0, v96
v_sub_f32 v65, 0, v96
v_sub_f32 v66, 0, v96
v_sub_f32 v67, 0, v96
v_sub_f32 v68, 0, v96
v_sub_f32 v69, 0, v96
v_sub_f32 v70, 0, v96
v_sub_f32 v71, 0, v96
v_sub_f32 v72, 0, v96
v_sub_f32 v73, 0, v96
v_sub_f32 v74, 0, v96
v_sub_f32 v75, 0, v96
v_sub_f32 v76, 0, v96
v_sub_f32 v77, 0, v96
v_sub_f32 v78, 0, v96
v_sub_f32 v79, 0, v96
v_sub_f32 v80, v128, v96
v_sub_f32 v81, v129, v96
v_sub_f32 v82, v130, v96
v_sub_f32 v83, v131, v96
v_sub_f32 v84, v132, v96
v_sub_f32 v85, v133, v96
v_sub_f32 v86, v134, v96
v_sub_f32 v87, v135, v96
v_sub_f32 v88, v136, v96
v_sub_f32 v89, v137, v96
v_sub_f32 v90, v138, v96
v_sub_f32 v91, v139, v96
v_sub_f32 v92, v140, v96
v_sub_f32 v93, v141, v96
v_sub_f32 v94, v142, v96
v_sub_f32 v95, v143, v96
s_cmp_eq_u32 s101, 0
s_cbranch_scc1 e2_79
s_cmp_eq_u32 s101, 1
s_cbranch_scc1 e2_80
s_cmp_eq_u32 s101, 2
s_cbranch_scc1 e2_81
s_cmp_eq_u32 s101, 3
s_cbranch_scc1 e2_82
s_cmp_eq_u32 s101, 4
s_cbranch_scc1 e2_83
s_cmp_eq_u32 s101, 5
s_cbranch_scc1 e2_84
s_cmp_eq_u32 s101, 6
s_cbranch_scc1 e2_85
s_cmp_eq_u32 s101, 7
s_cbranch_scc1 e2_86
s_cmp_eq_u32 s101, 8
s_cbranch_scc1 e2_87
e2_79:
v_mfma_f32_32x32x16_bf16 v[16:31], v[196:199], v[108:111], v[80:95]
j2_88:
v_mfma_f32_32x32x16_bf16 v[32:47], v[200:203], v[108:111], v[64:79]
s_nop 10
v_exp_f32 v16, v16
v_exp_f32 v17, v17
v_exp_f32 v18, v18
v_exp_f32 v19, v19
v_exp_f32 v20, v20
v_exp_f32 v21, v21
v_exp_f32 v22, v22
v_exp_f32 v23, v23
v_cvt_pk_bf16_f32 v96, v16, v17
v_cvt_pk_bf16_f32 v97, v18, v19
v_cvt_pk_bf16_f32 v98, v20, v21
v_cvt_pk_bf16_f32 v99, v22, v23
v_exp_f32 v24, v24
v_exp_f32 v25, v25
v_exp_f32 v26, v26
v_exp_f32 v27, v27
v_exp_f32 v28, v28
v_exp_f32 v29, v29
v_exp_f32 v30, v30
v_exp_f32 v31, v31
v_mfma_f32_32x32x16_bf16 v[48:63], a[72:75], v[96:99], v[48:63]
v_cvt_pk_bf16_f32 v100, v24, v25
v_cvt_pk_bf16_f32 v101, v26, v27
v_cvt_pk_bf16_f32 v102, v28, v29
v_cvt_pk_bf16_f32 v103, v30, v31
s_nop 1
v_mfma_f32_32x32x16_bf16 v[48:63], a[76:79], v[100:103], v[48:63]
j2_89:
v_mfma_f32_32x32x16_bf16 v[16:31], v[204:207], v[108:111], v[64:79]
v_exp_f32 v32, v32
v_exp_f32 v33, v33
v_exp_f32 v34, v34
v_exp_f32 v35, v35
v_exp_f32 v36, v36
v_exp_f32 v37, v37
v_exp_f32 v38, v38
v_exp_f32 v39, v39
v_cvt_pk_bf16_f32 v96, v32, v33
v_cvt_pk_bf16_f32 v97, v34, v35
v_cvt_pk_bf16_f32 v98, v36, v37
v_cvt_pk_bf16_f32 v99, v38, v39
v_exp_f32 v40, v40
v_exp_f32 v41, v41
v_exp_f32 v42, v42
v_exp_f32 v43, v43
v_exp_f32 v44, v44
v_exp_f32 v45, v45
v_exp_f32 v46, v46
v_exp_f32 v47, v47
v_mfma_f32_32x32x16_bf16 v[48:63], a[80:83], v[96:99], v[48:63]
v_cvt_pk_bf16_f32 v100, v40, v41
v_cvt_pk_bf16_f32 v101, v42, v43
v_cvt_pk_bf16_f32 v102, v44, v45
v_cvt_pk_bf16_f32 v103, v46, v47
s_nop 1
v_mfma_f32_32x32x16_bf16 v[48:63], a[84:87], v[100:103], v[48:63]
j2_90:
v_mfma_f32_32x32x16_bf16 v[32:47], v[208:211], v[108:111], v[64:79]
v_exp_f32 v16, v16
v_exp_f32 v17, v17
v_exp_f32 v18, v18
v_exp_f32 v19, v19
v_exp_f32 v20, v20
v_exp_f32 v21, v21
v_exp_f32 v22, v22
v_exp_f32 v23, v23
v_cvt_pk_bf16_f32 v96, v16, v17
v_cvt_pk_bf16_f32 v97, v18, v19
v_cvt_pk_bf16_f32 v98, v20, v21
v_cvt_pk_bf16_f32 v99, v22, v23
v_exp_f32 v24, v24
v_exp_f32 v25, v25
v_exp_f32 v26, v26
v_exp_f32 v27, v27
v_exp_f32 v28, v28
v_exp_f32 v29, v29
v_exp_f32 v30, v30
v_exp_f32 v31, v31
v_mfma_f32_32x32x16_bf16 v[48:63], a[88:91], v[96:99], v[48:63]
v_cvt_pk_bf16_f32 v100, v24, v25
v_cvt_pk_bf16_f32 v101, v26, v27
v_cvt_pk_bf16_f32 v102, v28, v29
v_cvt_pk_bf16_f32 v103, v30, v31
s_nop 1
v_mfma_f32_32x32x16_bf16 v[48:63], a[92:95], v[100:103], v[48:63]
j2_91:
v_mfma_f32_32x32x16_bf16 v[16:31], v[212:215], v[108:111], v[64:79]
v_exp_f32 v32, v32
v_exp_f32 v33, v33
v_exp_f32 v34, v34
v_exp_f32 v35, v35
v_exp_f32 v36, v36
v_exp_f32 v37, v37
v_exp_f32 v38, v38
v_exp_f32 v39, v39
v_cvt_pk_bf16_f32 v96, v32, v33
v_cvt_pk_bf16_f32 v97, v34, v35
v_cvt_pk_bf16_f32 v98, v36, v37
v_cvt_pk_bf16_f32 v99, v38, v39
v_exp_f32 v40, v40
v_exp_f32 v41, v41
v_exp_f32 v42, v42
v_exp_f32 v43, v43
v_exp_f32 v44, v44
v_exp_f32 v45, v45
v_exp_f32 v46, v46
v_exp_f32 v47, v47
v_mfma_f32_32x32x16_bf16 v[48:63], a[96:99], v[96:99], v[48:63]
v_cvt_pk_bf16_f32 v100, v40, v41
v_cvt_pk_bf16_f32 v101, v42, v43
v_cvt_pk_bf16_f32 v102, v44, v45
v_cvt_pk_bf16_f32 v103, v46, v47
s_nop 1
v_mfma_f32_32x32x16_bf16 v[48:63], a[100:103], v[100:103], v[48:63]
j2_92:
v_mfma_f32_32x32x16_bf16 v[32:47], v[216:219], v[108:111], v[64:79]
v_exp_f32 v16, v16
v_exp_f32 v17, v17
v_exp_f32 v18, v18
v_exp_f32 v19, v19
v_exp_f32 v20, v20
v_exp_f32 v21, v21
v_exp_f32 v22, v22
v_exp_f32 v23, v23
v_cvt_pk_bf16_f32 v96, v16, v17
v_cvt_pk_bf16_f32 v97, v18, v19
v_cvt_pk_bf16_f32 v98, v20, v21
v_cvt_pk_bf16_f32 v99, v22, v23
v_exp_f32 v24, v24
v_exp_f32 v25, v25
v_exp_f32 v26, v26
v_exp_f32 v27, v27
v_exp_f32 v28, v28
v_exp_f32 v29, v29
v_exp_f32 v30, v30
v_exp_f32 v31, v31
v_mfma_f32_32x32x16_bf16 v[48:63], a[104:107], v[96:99], v[48:63]
v_cvt_pk_bf16_f32 v100, v24, v25
v_cvt_pk_bf16_f32 v101, v26, v27
v_cvt_pk_bf16_f32 v102, v28, v29
v_cvt_pk_bf16_f32 v103, v30, v31
s_nop 1
v_mfma_f32_32x32x16_bf16 v[48:63], a[108:111], v[100:103], v[48:63]
j2_93:
v_mfma_f32_32x32x16_bf16 v[16:31], v[220:223], v[108:111], v[64:79]
v_exp_f32 v32, v32
v_exp_f32 v33, v33
v_exp_f32 v34, v34
v_exp_f32 v35, v35
v_exp_f32 v36, v36
v_exp_f32 v37, v37
v_exp_f32 v38, v38
v_exp_f32 v39, v39
v_cvt_pk_bf16_f32 v96, v32, v33
v_cvt_pk_bf16_f32 v97, v34, v35
v_cvt_pk_bf16_f32 v98, v36, v37
v_cvt_pk_bf16_f32 v99, v38, v39
v_exp_f32 v40, v40
v_exp_f32 v41, v41
v_exp_f32 v42, v42
v_exp_f32 v43, v43
v_exp_f32 v44, v44
v_exp_f32 v45, v45
v_exp_f32 v46, v46
v_exp_f32 v47, v47
v_mfma_f32_32x32x16_bf16 v[48:63], a[112:115], v[96:99], v[48:63]
v_cvt_pk_bf16_f32 v100, v40, v41
v_cvt_pk_bf16_f32 v101, v42, v43
v_cvt_pk_bf16_f32 v102, v44, v45
v_cvt_pk_bf16_f32 v103, v46, v47
s_nop 1
v_mfma_f32_32x32x16_bf16 v[48:63], a[116:119], v[100:103], v[48:63]
j2_94:
v_mfma_f32_32x32x16_bf16 v[32:47], v[224:227], v[108:111], v[64:79]
v_exp_f32 v16, v16
v_exp_f32 v17, v17
v_exp_f32 v18, v18
v_exp_f32 v19, v19
v_exp_f32 v20, v20
v_exp_f32 v21, v21
v_exp_f32 v22, v22
v_exp_f32 v23, v23
v_cvt_pk_bf16_f32 v96, v16, v17
v_cvt_pk_bf16_f32 v97, v18, v19
v_cvt_pk_bf16_f32 v98, v20, v21
v_cvt_pk_bf16_f32 v99, v22, v23
v_exp_f32 v24, v24
v_exp_f32 v25, v25
v_exp_f32 v26, v26
v_exp_f32 v27, v27
v_exp_f32 v28, v28
v_exp_f32 v29, v29
v_exp_f32 v30, v30
v_exp_f32 v31, v31
v_mfma_f32_32x32x16_bf16 v[48:63], a[120:123], v[96:99], v[48:63]
v_cvt_pk_bf16_f32 v100, v24, v25
v_cvt_pk_bf16_f32 v101, v26, v27
v_cvt_pk_bf16_f32 v102, v28, v29
v_cvt_pk_bf16_f32 v103, v30, v31
s_nop 1
v_mfma_f32_32x32x16_bf16 v[48:63], a[124:127], v[100:103], v[48:63]
j2_95:
v_mfma_f32_32x32x16_bf16 v[16:31], v[228:231], v[108:111], v[112:127]
v_exp_f32 v32, v32
v_exp_f32 v33, v33
v_exp_f32 v34, v34
v_exp_f32 v35, v35
v_exp_f32 v36, v36
v_exp_f32 v37, v37
v_exp_f32 v38, v38
v_exp_f32 v39, v39
v_cvt_pk_bf16_f32 v96, v32, v33
v_cvt_pk_bf16_f32 v97, v34, v35
v_cvt_pk_bf16_f32 v98, v36, v37
v_cvt_pk_bf16_f32 v99, v38, v39
v_exp_f32 v40, v40
v_exp_f32 v41, v41
v_exp_f32 v42, v42
v_exp_f32 v43, v43
v_exp_f32 v44, v44
v_exp_f32 v45, v45
v_exp_f32 v46, v46
v_exp_f32 v47, v47
v_mfma_f32_32x32x16_bf16 v[48:63], a[128:131], v[96:99], v[48:63]
v_cvt_pk_bf16_f32 v100, v40, v41
v_cvt_pk_bf16_f32 v101, v42, v43
v_cvt_pk_bf16_f32 v102, v44, v45
v_cvt_pk_bf16_f32 v103, v46, v47
s_nop 1
v_mfma_f32_32x32x16_bf16 v[48:63], a[132:135], v[100:103], v[48:63]
j2_96:
s_nop 0
v_exp_f32 v16, v16
v_exp_f32 v17, v17
v_exp_f32 v18, v18
v_exp_f32 v19, v19
v_exp_f32 v20, v20
v_exp_f32 v21, v21
v_exp_f32 v22, v22
v_exp_f32 v23, v23
v_cvt_pk_bf16_f32 v96, v16, v17
v_cvt_pk_bf16_f32 v97, v18, v19
v_cvt_pk_bf16_f32 v98, v20, v21
v_cvt_pk_bf16_f32 v99, v22, v23
v_exp_f32 v24, v24
v_exp_f32 v25, v25
v_exp_f32 v26, v26
v_exp_f32 v27, v27
v_exp_f32 v28, v28
v_exp_f32 v29, v29
v_exp_f32 v30, v30
v_exp_f32 v31, v31
v_mfma_f32_32x32x16_bf16 v[48:63], a[136:139], v[96:99], v[48:63]
v_cvt_pk_bf16_f32 v100, v24, v25
v_cvt_pk_bf16_f32 v101, v26, v27
v_cvt_pk_bf16_f32 v102, v28, v29
v_cvt_pk_bf16_f32 v103, v30, v31
s_nop 1
v_mfma_f32_32x32x16_bf16 v[48:63], a[140:143], v[100:103], v[48:63]
s_nop 11
s_branch f2_97
e2_80:
v_mfma_f32_32x32x16_bf16 v[32:47], v[200:203], v[108:111], v[64:79]
s_nop 11
s_branch j2_89
e2_81:
v_mfma_f32_32x32x16_bf16 v[16:31], v[204:207], v[108:111], v[64:79]
s_nop 11
s_branch j2_90
e2_82:
v_mfma_f32_32x32x16_bf16 v[32:47], v[208:211], v[108:111], v[64:79]
s_nop 11
s_branch j2_91
e2_83:
v_mfma_f32_32x32x16_bf16 v[16:31], v[212:215], v[108:111], v[64:79]
s_nop 11
s_branch j2_92
e2_84:
v_mfma_f32_32x32x16_bf16 v[32:47], v[216:219], v[108:111], v[64:79]
s_nop 11
s_branch j2_93
e2_85:
v_mfma_f32_32x32x16_bf16 v[16:31], v[220:223], v[108:111], v[64:79]
s_nop 11
s_branch j2_94
e2_86:
v_mfma_f32_32x32x16_bf16 v[32:47], v[224:227], v[108:111], v[64:79]
s_nop 11
s_branch j2_95
e2_87:
v_mfma_f32_32x32x16_bf16 v[16:31], v[228:231], v[108:111], v[112:127]
s_nop 11
s_branch j2_96
f2_97:
v_rcp_f32 v48, v48
s_nop 0
v_mul_f32 v56, v56, v48
v_mul_f32 v57, v57, v48
v_mul_f32 v58, v58, v48
v_mul_f32 v59, v59, v48
v_mul_f32 v60, v60, v48
v_mul_f32 v61, v61, v48
v_mul_f32 v62, v62, v48
v_mul_f32 v63, v63, v48
v_cvt_pk_bf16_f32 v252, v56, v57
v_cvt_pk_bf16_f32 v253, v58, v59
v_cvt_pk_bf16_f32 v254, v60, v61
v_cvt_pk_bf16_f32 v255, v62, v63
s_lshl_b32 s6, s44, 15
s_lshl_b32 s5, s42, 11
s_add_u32 s6, s6, s5
s_add_u32 s6, s6, 12713984
buffer_store_dwordx4 v[252:255], v1, s[84:87], s6 offen offset:1024 sc1
s_waitcnt vmcnt(0)
s_lshl_b32 s4, s100, 2
s_add_u32 s4, s4, 36864
v_mov_b32 v14, s40
v_mov_b32 v15, 0
s_mov_b64 exec, 1
buffer_store_dword v14, v15, s[84:87], s4 offen sc1
s_mov_b64 exec, -1
s_lshr_b32 s4, s40, 0
v_xor_b32 v201, s4, v168
v_mov_b32 v200, v201
s_lshr_b32 s4, s40, 8
v_xor_b32 v201, s4, v169
v_or_b32 v200, v200, v201
s_lshr_b32 s4, s40, 16
v_xor_b32 v201, s4, v170
v_or_b32 v200, v200, v201
s_lshr_b32 s4, s40, 24
v_xor_b32 v201, s4, v171
v_or_b32 v200, v200, v201
s_lshr_b32 s4, s40, 0
v_xor_b32 v201, s4, v172
v_or_b32 v200, v200, v201
s_lshr_b32 s4, s40, 8
v_xor_b32 v201, s4, v173
v_or_b32 v200, v200, v201
s_lshr_b32 s4, s40, 16
v_xor_b32 v201, s4, v174
v_or_b32 v200, v200, v201
s_lshr_b32 s4, s40, 24
v_xor_b32 v201, s4, v175
v_or_b32 v200, v200, v201
s_lshr_b32 s4, s40, 0
v_xor_b32 v201, s4, v176
v_or_b32 v200, v200, v201
s_lshr_b32 s4, s40, 8
v_xor_b32 v201, s4, v177
v_or_b32 v200, v200, v201
s_lshr_b32 s4, s40, 16
v_xor_b32 v201, s4, v178
v_or_b32 v200, v200, v201
s_lshr_b32 s4, s40, 24
v_xor_b32 v201, s4, v179
v_or_b32 v200, v200, v201
s_lshr_b32 s4, s40, 0
v_xor_b32 v201, s4, v180
v_or_b32 v200, v200, v201
s_lshr_b32 s4, s40, 8
v_xor_b32 v201, s4, v181
v_or_b32 v200, v200, v201
s_lshr_b32 s4, s40, 16
v_xor_b32 v201, s4, v182
v_or_b32 v200, v200, v201
s_lshr_b32 s4, s40, 24
v_xor_b32 v201, s4, v183
v_or_b32 v200, v200, v201
v_and_b32 v200, 0xff, v200
v_add_u32 v200, s40, v200
v_cmp_ne_u32 vcc, s40, v200
s_cbranch_vccz ok_98
s_mov_b32 s47, 0x8000
mp_99:
s_mov_b32 s5, 0
buffer_load_dwordx4 v[168:171], v6, s[84:87], s5 offen sc1
s_mov_b32 s5, 4096
buffer_load_dwordx4 v[172:175], v6, s[84:87], s5 offen sc1
s_mov_b32 s5, 8192
buffer_load_dwordx4 v[176:179], v6, s[84:87], s5 offen sc1
s_mov_b32 s5, 12288
buffer_load_dwordx4 v[180:183], v6, s[84:87], s5 offen sc1
s_waitcnt vmcnt(0)
s_lshr_b32 s4, s40, 0
v_xor_b32 v201, s4, v168
v_mov_b32 v200, v201
s_lshr_b32 s4, s40, 8
v_xor_b32 v201, s4, v169
v_or_b32 v200, v200, v201
s_lshr_b32 s4, s40, 16
v_xor_b32 v201, s4, v170
v_or_b32 v200, v200, v201
s_lshr_b32 s4, s40, 24
v_xor_b32 v201, s4, v171
v_or_b32 v200, v200, v201
s_lshr_b32 s4, s40, 0
v_xor_b32 v201, s4, v172
v_or_b32 v200, v200, v201
s_lshr_b32 s4, s40, 8
v_xor_b32 v201, s4, v173
v_or_b32 v200, v200, v201
s_lshr_b32 s4, s40, 16
v_xor_b32 v201, s4, v174
v_or_b32 v200, v200, v201
s_lshr_b32 s4, s40, 24
v_xor_b32 v201, s4, v175
v_or_b32 v200, v200, v201
s_lshr_b32 s4, s40, 0
v_xor_b32 v201, s4, v176
v_or_b32 v200, v200, v201
s_lshr_b32 s4, s40, 8
v_xor_b32 v201, s4, v177
v_or_b32 v200, v200, v201
s_lshr_b32 s4, s40, 16
v_xor_b32 v201, s4, v178
v_or_b32 v200, v200, v201
s_lshr_b32 s4, s40, 24
v_xor_b32 v201, s4, v179
v_or_b32 v200, v200, v201
s_lshr_b32 s4, s40, 0
v_xor_b32 v201, s4, v180
v_or_b32 v200, v200, v201
s_lshr_b32 s4, s40, 8
v_xor_b32 v201, s4, v181
v_or_b32 v200, v200, v201
s_lshr_b32 s4, s40, 16
v_xor_b32 v201, s4, v182
v_or_b32 v200, v200, v201
s_lshr_b32 s4, s40, 24
v_xor_b32 v201, s4, v183
v_or_b32 v200, v200, v201
v_and_b32 v200, 0xff, v200
v_add_u32 v200, s40, v200
v_cmp_ne_u32 vcc, s40, v200
s_cbranch_vccz md_100
s_sub_u32 s47, s47, 1
s_cbranch_scc0 mp_99
md_100:
ok_98:
v_add_f32 v168, v168, v172
v_add_f32 v169, v169, v173
v_add_f32 v170, v170, v174
v_add_f32 v171, v171, v175
v_cvt_pk_bf16_f32 v168, v168, v169
v_cvt_pk_bf16_f32 v169, v170, v171
v_add_f32 v176, v176, v180
v_add_f32 v177, v177, v181
v_add_f32 v178, v178, v182
v_add_f32 v179, v179, v183
v_cvt_pk_bf16_f32 v172, v176, v177
v_cvt_pk_bf16_f32 v173, v178, v179
s_cmp_lt_u32 s43, 2
s_cbranch_scc0 L_tb
v_lshlrev_b32 v176, 16, v168
v_and_b32 v177, 0xffff0000, v168
v_lshlrev_b32 v180, 16, v172
v_and_b32 v181, 0xffff0000, v172
v_lshlrev_b32 v178, 16, v169
v_and_b32 v179, 0xffff0000, v169
v_lshlrev_b32 v182, 16, v173
v_and_b32 v183, 0xffff0000, v173
v_add_f32 v180, 1.0, v180
v_add_f32 v181, 1.0, v181
v_add_f32 v182, 1.0, v182
v_add_f32 v183, 1.0, v183
v_cvt_pk_bf16_f32 v172, v180, v181
v_cvt_pk_bf16_f32 v173, v182, v183
v_lshlrev_b32 v180, 16, v172
v_and_b32 v181, 0xffff0000, v172
v_lshlrev_b32 v182, 16, v173
v_and_b32 v183, 0xffff0000, v173
v_add_u32 v6, 147456, v8
ds_write_b128 v6, v[176:179]
ds_write_b128 v6, v[180:183] offset:2048
v_lshrrev_b32 v8, 1, v8
v_add_u32 v8, 153600, v8
ds_write_b64 v8, v[172:173]
s_branch L_tc
L_tb:
v_lshlrev_b32 v176, 16, v172
v_and_b32 v177, 0xffff0000, v172
v_lshlrev_b32 v178, 16, v173
v_and_b32 v179, 0xffff0000, v173
v_add_u32 v6, 149504, v8
ds_write_b128 v6, v[176:179]
v_lshrrev_b32 v8, 1, v8
v_add_u32 v8, 153600, v8
ds_write_b64 v8, v[168:169]
L_tc:
s_waitcnt lgkmcnt(0)
s_barrier
s_cmp_ge_u32 s41, 6
s_cbranch_scc1 L_noc
s_and_b32 s4, s41, 1
s_mul_i32 s4, s4, 43
s_lshr_b32 s7, s41, 1
s_add_u32 s7, s7, s92
s_min_u32 s7, s7, 42
s_add_u32 s4, s4, s7
s_lshl_b32 s4, s4, 15
s_lshl_b32 s6, s43, 13
s_add_u32 s6, s6, s4
s_add_u32 s6, s6, 31588352
buffer_load_dwordx4 v[192:195], v1, s[84:87], s6 offen offset:0 sc1
buffer_load_dwordx4 v[196:199], v1, s[84:87], s6 offen offset:1024 sc1
buffer_load_dwordx4 v[200:203], v1, s[84:87], s6 offen offset:2048 sc1
buffer_load_dwordx4 v[204:207], v1, s[84:87], s6 offen offset:3072 sc1
s_add_u32 s6, s6, 4096
buffer_load_dwordx4 v[208:211], v1, s[84:87], s6 offen offset:0 sc1
buffer_load_dwordx4 v[212:215], v1, s[84:87], s6 offen offset:1024 sc1
buffer_load_dwordx4 v[216:219], v1, s[84:87], s6 offen offset:2048 sc1
buffer_load_dwordx4 v[220:223], v1, s[84:87], s6 offen offset:3072 sc1
v_and_b32 v14, 31, v0
v_cmp_eq_u32 vcc, 1, v14
v_mov_b32 v15, 153600
v_mov_b32 v14, 154624
v_cndmask_b32 v7, v15, v14, vcc
v_lshl_add_u32 v7, v5, 3, v7
s_lshl_b32 s4, s43, 8
v_add_u32 v7, s4, v7
ds_read_b64 v[160:161], v7 offset:0
ds_read_b64 v[162:163], v7 offset:16
ds_read_b64 v[164:165], v7 offset:32
ds_read_b64 v[166:167], v7 offset:48
ds_read_b64 v[168:169], v7 offset:64
ds_read_b64 v[170:171], v7 offset:80
ds_read_b64 v[172:173], v7 offset:96
ds_read_b64 v[174:175], v7 offset:112
ds_read_b64 v[176:177], v7 offset:128
ds_read_b64 v[178:179], v7 offset:144
ds_read_b64 v[180:181], v7 offset:160
ds_read_b64 v[182:183], v7 offset:176
ds_read_b64 v[184:185], v7 offset:192
ds_read_b64 v[186:187], v7 offset:208
ds_read_b64 v[188:189], v7 offset:224
s_waitcnt lgkmcnt(11)
ds_read_b64 v[190:191], v7 offset:240
s_waitcnt lgkmcnt(0)
s_waitcnt vmcnt(7)
v_mfma_f32_32x32x16_bf16 v[16:31], v[192:195], v[160:163], 0
s_waitcnt vmcnt(6)
v_mfma_f32_32x32x16_bf16 v[16:31], v[196:199], v[164:167], v[16:31]
s_waitcnt vmcnt(5)
v_mfma_f32_32x32x16_bf16 v[16:31], v[200:203], v[168:171], v[16:31]
s_waitcnt vmcnt(4)
v_mfma_f32_32x32x16_bf16 v[16:31], v[204:207], v[172:175], v[16:31]
s_waitcnt vmcnt(3)
v_mfma_f32_32x32x16_bf16 v[16:31], v[208:211], v[176:179], v[16:31]
s_waitcnt vmcnt(2)
v_mfma_f32_32x32x16_bf16 v[16:31], v[212:215], v[180:183], v[16:31]
s_waitcnt vmcnt(1)
v_mfma_f32_32x32x16_bf16 v[16:31], v[216:219], v[184:187], v[16:31]
s_waitcnt vmcnt(0)
v_mfma_f32_32x32x16_bf16 v[16:31], v[220:223], v[188:191], v[16:31]
v_and_b32 v14, 1, v0
v_lshlrev_b32 v14, 7, v14
v_lshl_add_u32 v14, v5, 4, v14
s_add_u32 s4, s4, 155648
v_add_u32 v14, s4, v14
s_mov_b32 exec_lo, 3
s_mov_b32 exec_hi, 3
s_nop 4
ds_write_b128 v14, v[16:19] offset:0
ds_write_b128 v14, v[20:23] offset:32
ds_write_b128 v14, v[24:27] offset:64
ds_write_b128 v14, v[28:31] offset:96
s_mov_b64 exec, -1
s_waitcnt lgkmcnt(0)
s_barrier
s_cmp_lg_u32 s43, 3
s_cbranch_scc1 nw_101
v_lshlrev_b32 v14, 2, v0
v_add_u32 v15, 155648, v14
ds_read_b32 v16, v15 offset:0
ds_read_b32 v18, v15 offset:256
ds_read_b32 v20, v15 offset:512
ds_read_b32 v22, v15 offset:768
s_waitcnt lgkmcnt(0)
v_add_f32 v16, v16, v18
v_add_f32 v20, v20, v22
v_add_f32 v16, v16, v20
v_mov_b32 v17, s40
v_lshlrev_b32 v14, 1, v14
s_mul_i32 s4, s3, 6
s_add_u32 s4, s4, s41
s_lshl_b32 s4, s4, 9
s_add_u32 s4, s4, 131072
buffer_store_dwordx2 v[16:17], v14, s[84:87], s4 offen sc1
nw_101:
L_noc:
s_mov_b32 s88, s84
s_mov_b32 s89, s85
s_mov_b32 s90, s86
s_mov_b32 s91, 0x20000
s_mul_i32 s9, s93, 43
s_add_u32 s9, s9, s92
s_add_u32 s9, s9, 0
s_lshl_b32 s9, s9, 1
s_and_b32 s5, s43, 1
s_add_u32 s9, s9, s5
s_lshl_b32 s9, s9, 14
s_add_u32 s9, s9, 31588352
s_lshl_b32 s4, s43, 14
s_add_u32 s10, s4, 65536
s_mov_b32 s8, 16
s_mov_b32 s11, 1024
s_mov_b32 s12, 1024
v_mov_b32 v12, v1
s_mov_b32 s100, s98
s_lshl_b32 s4, s41, 6
s_lshl_b32 s5, s46, 4
s_add_u32 s96, s4, s5
s_lshl_b32 s4, s93, 3
s_add_u32 s4, s4, s96
s_lshl_b32 s4, s4, 2
s_add_u32 s5, s4, 36864
v_and_b32 v14, 7, v0
v_lshlrev_b32 v14, 2, v14
s_mov_b32 s47, 0x8000
poll_102:
s_cmp_eq_u32 s8, 0
s_cbranch_scc1 pb_104
s_mov_b32 m0, s10
s_add_u32 s10, s10, s11
buffer_load_dwordx4 v12, s[88:91], s9 offen sc1 lds
s_add_u32 s9, s9, s12
s_sub_u32 s8, s8, 1
s_cmp_eq_u32 s8, 0
s_cbranch_scc1 pb_104
s_mov_b32 m0, s10
s_add_u32 s10, s10, s11
buffer_load_dwordx4 v12, s[88:91], s9 offen sc1 lds
s_add_u32 s9, s9, s12
s_sub_u32 s8, s8, 1
s_cmp_eq_u32 s8, 0
s_cbranch_scc1 pb_104
s_mov_b32 m0, s10
s_add_u32 s10, s10, s11
buffer_load_dwordx4 v12, s[88:91], s9 offen sc1 lds
s_add_u32 s9, s9, s12
s_sub_u32 s8, s8, 1
s_cmp_eq_u32 s8, 0
s_cbranch_scc1 pb_104
s_mov_b32 m0, s10
s_add_u32 s10, s10, s11
buffer_load_dwordx4 v12, s[88:91], s9 offen sc1 lds
s_add_u32 s9, s9, s12
s_sub_u32 s8, s8, 1
s_cmp_eq_u32 s8, 0
s_cbranch_scc1 pb_104
s_mov_b32 m0, s10
s_add_u32 s10, s10, s11
buffer_load_dwordx4 v12, s[88:91], s9 offen sc1 lds
s_add_u32 s9, s9, s12
s_sub_u32 s8, s8, 1
s_cmp_eq_u32 s8, 0
s_cbranch_scc1 pb_104
s_mov_b32 m0, s10
s_add_u32 s10, s10, s11
buffer_load_dwordx4 v12, s[88:91], s9 offen sc1 lds
s_add_u32 s9, s9, s12
s_sub_u32 s8, s8, 1
s_cmp_eq_u32 s8, 0
s_cbranch_scc1 pb_104
s_mov_b32 m0, s10
s_add_u32 s10, s10, s11
buffer_load_dwordx4 v12, s[88:91], s9 offen sc1 lds
s_add_u32 s9, s9, s12
s_sub_u32 s8, s8, 1
s_cmp_eq_u32 s8, 0
s_cbranch_scc1 pb_104
s_mov_b32 m0, s10
s_add_u32 s10, s10, s11
buffer_load_dwordx4 v12, s[88:91], s9 offen sc1 lds
s_add_u32 s9, s9, s12
s_sub_u32 s8, s8, 1
pb_104:
buffer_load_dword v15, v14, s[84:87], s5 offen sc1
s_waitcnt vmcnt(0)
v_cmp_ne_u32 vcc, s40, v15
s_cbranch_vccz pd_103
s_sub_u32 s47, s47, 1
s_cbranch_scc0 poll_102
pd_103:
s_lshl_b32 s6, s45, 15
s_lshl_b32 s5, s93, 14
s_add_u32 s6, s6, s5
s_add_u32 s6, s6, 12713984
buffer_load_dwordx4 a[144:147], v1, s[84:87], s6 offen offset:0 sc1
buffer_load_dwordx4 a[148:151], v1, s[84:87], s6 offen offset:1024 sc1
buffer_load_dwordx4 a[152:155], v1, s[84:87], s6 offen offset:2048 sc1
buffer_load_dwordx4 a[156:159], v1, s[84:87], s6 offen offset:3072 sc1
s_add_u32 s6, s6, 4096
buffer_load_dwordx4 a[160:163], v1, s[84:87], s6 offen offset:0 sc1
buffer_load_dwordx4 a[164:167], v1, s[84:87], s6 offen offset:1024 sc1
buffer_load_dwordx4 a[168:171], v1, s[84:87], s6 offen offset:2048 sc1
buffer_load_dwordx4 a[172:175], v1, s[84:87], s6 offen offset:3072 sc1
s_lshl_b32 s4, s93, 15
v_add_u32 v9, s4, v13
v_xor_b32 v10, 64, v9
ds_read_b64_tr_b16 v[64:65], v9 offset:0
ds_read_b64_tr_b16 v[66:67], v9 offset:1024
ds_read_b64_tr_b16 v[68:69], v10 offset:0
ds_read_b64_tr_b16 v[70:71], v10 offset:1024
ds_read_b64_tr_b16 v[72:73], v9 offset:2048
ds_read_b64_tr_b16 v[74:75], v9 offset:3072
ds_read_b64_tr_b16 v[76:77], v10 offset:2048
ds_read_b64_tr_b16 v[78:79], v10 offset:3072
s_add_u32 s6, s6, 4096
buffer_load_dwordx4 a[176:179], v1, s[84:87], s6 offen offset:0 sc1
ds_read_b64_tr_b16 v[80:81], v9 offset:4096
ds_read_b64_tr_b16 v[82:83], v9 offset:5120
ds_read_b64_tr_b16 v[84:85], v10 offset:4096
ds_read_b64_tr_b16 v[86:87], v10 offset:5120
s_waitcnt vmcnt(8)
s_waitcnt lgkmcnt(8)
v_mfma_f32_32x32x16_bf16 v[16:31], v[64:67], a[144:147], 0
v_mfma_f32_32x32x16_bf16 v[32:47], v[68:71], a[144:147], 0
buffer_load_dwordx4 a[180:183], v1, s[84:87], s6 offen offset:1024 sc1
ds_read_b64_tr_b16 v[64:65], v9 offset:6144
ds_read_b64_tr_b16 v[66:67], v9 offset:7168
ds_read_b64_tr_b16 v[68:69], v10 offset:6144
ds_read_b64_tr_b16 v[70:71], v10 offset:7168
s_waitcnt vmcnt(8)
s_waitcnt lgkmcnt(8)
v_mfma_f32_32x32x16_bf16 v[16:31], v[72:75], a[148:151], v[16:31]
v_mfma_f32_32x32x16_bf16 v[32:47], v[76:79], a[148:151], v[32:47]
buffer_load_dwordx4 a[184:187], v1, s[84:87], s6 offen offset:2048 sc1
ds_read_b64_tr_b16 v[72:73], v9 offset:8192
ds_read_b64_tr_b16 v[74:75], v9 offset:9216
ds_read_b64_tr_b16 v[76:77], v10 offset:8192
ds_read_b64_tr_b16 v[78:79], v10 offset:9216
s_waitcnt vmcnt(8)
s_waitcnt lgkmcnt(8)
v_mfma_f32_32x32x16_bf16 v[16:31], v[80:83], a[152:155], v[16:31]
v_mfma_f32_32x32x16_bf16 v[32:47], v[84:87], a[152:155], v[32:47]
buffer_load_dwordx4 a[188:191], v1, s[84:87], s6 offen offset:3072 sc1
ds_read_b64_tr_b16 v[80:81], v9 offset:10240
ds_read_b64_tr_b16 v[82:83], v9 offset:11264
ds_read_b64_tr_b16 v[84:85], v10 offset:10240
ds_read_b64_tr_b16 v[86:87], v10 offset:11264
s_waitcnt vmcnt(8)
s_waitcnt lgkmcnt(8)
v_mfma_f32_32x32x16_bf16 v[16:31], v[64:67], a[156:159], v[16:31]
v_mfma_f32_32x32x16_bf16 v[32:47], v[68:71], a[156:159], v[32:47]
s_add_u32 s6, s6, 4096
buffer_load_dwordx4 a[192:195], v1, s[84:87], s6 offen offset:0 sc1
ds_read_b64_tr_b16 v[64:65], v9 offset:12288
ds_read_b64_tr_b16 v[66:67], v9 offset:13312
ds_read_b64_tr_b16 v[68:69], v10 offset:12288
ds_read_b64_tr_b16 v[70:71], v10 offset:13312
s_waitcnt vmcnt(8)
s_waitcnt lgkmcnt(8)
v_mfma_f32_32x32x16_bf16 v[16:31], v[72:75], a[160:163], v[16:31]
v_mfma_f32_32x32x16_bf16 v[32:47], v[76:79], a[160:163], v[32:47]
buffer_load_dwordx4 a[196:199], v1, s[84:87], s6 offen offset:1024 sc1
ds_read_b64_tr_b16 v[72:73], v9 offset:14336
ds_read_b64_tr_b16 v[74:75], v9 offset:15360
ds_read_b64_tr_b16 v[76:77], v10 offset:14336
ds_read_b64_tr_b16 v[78:79], v10 offset:15360
s_waitcnt vmcnt(8)
s_waitcnt lgkmcnt(8)
v_mfma_f32_32x32x16_bf16 v[16:31], v[80:83], a[164:167], v[16:31]
v_mfma_f32_32x32x16_bf16 v[32:47], v[84:87], a[164:167], v[32:47]
buffer_load_dwordx4 a[200:203], v1, s[84:87], s6 offen offset:2048 sc1
ds_read_b64_tr_b16 v[80:81], v9 offset:16384
ds_read_b64_tr_b16 v[82:83], v9 offset:17408
ds_read_b64_tr_b16 v[84:85], v10 offset:16384
ds_read_b64_tr_b16 v[86:87], v10 offset:17408
s_waitcnt vmcnt(8)
s_waitcnt lgkmcnt(8)
v_mfma_f32_32x32x16_bf16 v[16:31], v[64:67], a[168:171], v[16:31]
v_mfma_f32_32x32x16_bf16 v[32:47], v[68:71], a[168:171], v[32:47]
buffer_load_dwordx4 a[204:207], v1, s[84:87], s6 offen offset:3072 sc1
ds_read_b64_tr_b16 v[64:65], v9 offset:18432
ds_read_b64_tr_b16 v[66:67], v9 offset:19456
ds_read_b64_tr_b16 v[68:69], v10 offset:18432
ds_read_b64_tr_b16 v[70:71], v10 offset:19456
s_waitcnt vmcnt(8)
s_waitcnt lgkmcnt(8)
v_mfma_f32_32x32x16_bf16 v[16:31], v[72:75], a[172:175], v[16:31]
v_mfma_f32_32x32x16_bf16 v[32:47], v[76:79], a[172:175], v[32:47]
ds_read_b64_tr_b16 v[72:73], v9 offset:20480
ds_read_b64_tr_b16 v[74:75], v9 offset:21504
ds_read_b64_tr_b16 v[76:77], v10 offset:20480
ds_read_b64_tr_b16 v[78:79], v10 offset:21504
s_waitcnt vmcnt(7)
s_waitcnt lgkmcnt(8)
v_mfma_f32_32x32x16_bf16 v[16:31], v[80:83], a[176:179], v[16:31]
v_mfma_f32_32x32x16_bf16 v[32:47], v[84:87], a[176:179], v[32:47]
ds_read_b64_tr_b16 v[80:81], v9 offset:22528
ds_read_b64_tr_b16 v[82:83], v9 offset:23552
ds_read_b64_tr_b16 v[84:85], v10 offset:22528
ds_read_b64_tr_b16 v[86:87], v10 offset:23552
s_waitcnt vmcnt(6)
s_waitcnt lgkmcnt(8)
v_mfma_f32_32x32x16_bf16 v[16:31], v[64:67], a[180:183], v[16:31]
v_mfma_f32_32x32x16_bf16 v[32:47], v[68:71], a[180:183], v[32:47]
ds_read_b64_tr_b16 v[64:65], v9 offset:24576
ds_read_b64_tr_b16 v[66:67], v9 offset:25600
ds_read_b64_tr_b16 v[68:69], v10 offset:24576
ds_read_b64_tr_b16 v[70:71], v10 offset:25600
s_waitcnt vmcnt(5)
s_waitcnt lgkmcnt(8)
v_mfma_f32_32x32x16_bf16 v[16:31], v[72:75], a[184:187], v[16:31]
v_mfma_f32_32x32x16_bf16 v[32:47], v[76:79], a[184:187], v[32:47]
ds_read_b64_tr_b16 v[72:73], v9 offset:26624
ds_read_b64_tr_b16 v[74:75], v9 offset:27648
ds_read_b64_tr_b16 v[76:77], v10 offset:26624
ds_read_b64_tr_b16 v[78:79], v10 offset:27648
s_waitcnt vmcnt(4)
s_waitcnt lgkmcnt(8)
v_mfma_f32_32x32x16_bf16 v[16:31], v[80:83], a[188:191], v[16:31]
v_mfma_f32_32x32x16_bf16 v[32:47], v[84:87], a[188:191], v[32:47]
ds_read_b64_tr_b16 v[80:81], v9 offset:28672
ds_read_b64_tr_b16 v[82:83], v9 offset:29696
ds_read_b64_tr_b16 v[84:85], v10 offset:28672
ds_read_b64_tr_b16 v[86:87], v10 offset:29696
s_waitcnt vmcnt(3)
s_waitcnt lgkmcnt(8)
v_mfma_f32_32x32x16_bf16 v[16:31], v[64:67], a[192:195], v[16:31]
v_mfma_f32_32x32x16_bf16 v[32:47], v[68:71], a[192:195], v[32:47]
ds_read_b64_tr_b16 v[64:65], v9 offset:30720
ds_read_b64_tr_b16 v[66:67], v9 offset:31744
ds_read_b64_tr_b16 v[68:69], v10 offset:30720
ds_read_b64_tr_b16 v[70:71], v10 offset:31744
s_waitcnt vmcnt(2)
s_waitcnt lgkmcnt(8)
v_mfma_f32_32x32x16_bf16 v[16:31], v[72:75], a[196:199], v[16:31]
v_mfma_f32_32x32x16_bf16 v[32:47], v[76:79], a[196:199], v[32:47]
s_waitcnt vmcnt(1)
s_waitcnt lgkmcnt(4)
v_mfma_f32_32x32x16_bf16 v[16:31], v[80:83], a[200:203], v[16:31]
v_mfma_f32_32x32x16_bf16 v[32:47], v[84:87], a[200:203], v[32:47]
s_waitcnt vmcnt(0)
s_waitcnt lgkmcnt(0)
v_mfma_f32_32x32x16_bf16 v[16:31], v[64:67], a[204:207], v[16:31]
v_mfma_f32_32x32x16_bf16 v[32:47], v[68:71], a[204:207], v[32:47]
s_nop 7
s_nop 3
s_cmp_eq_u32 s93, 0
s_cbranch_scc1 x_105
v_swap_b32 v16, v32
v_swap_b32 v17, v33
v_swap_b32 v18, v34
v_swap_b32 v19, v35
v_swap_b32 v20, v36
v_swap_b32 v21, v37
v_swap_b32 v22, v38
v_swap_b32 v23, v39
v_swap_b32 v24, v40
v_swap_b32 v25, v41
v_swap_b32 v26, v42
v_swap_b32 v27, v43
v_swap_b32 v28, v44
v_swap_b32 v29, v45
v_swap_b32 v30, v46
v_swap_b32 v31, v47
x_105:
s_lshl_b32 s4, s43, 12
s_add_u32 s4, s4, 131072
v_add_u32 v14, s4, v1
s_xor_b32 s4, s4, 0x2000
v_add_u32 v15, s4, v1
ds_write_b128 v14, v[32:35] offset:0
ds_write_b128 v14, v[36:39] offset:1024
ds_write_b128 v14, v[40:43] offset:2048
ds_write_b128 v14, v[44:47] offset:3072
s_waitcnt lgkmcnt(0)
s_barrier
ds_read_b128 v[32:35], v15 offset:0
ds_read_b128 v[36:39], v15 offset:1024
ds_read_b128 v[40:43], v15 offset:2048
ds_read_b128 v[44:47], v15 offset:3072
v_accvgpr_read_b32 v128, a232
v_accvgpr_read_b32 v129, a233
v_accvgpr_read_b32 v130, a234
v_accvgpr_read_b32 v131, a235
v_accvgpr_read_b32 v132, a236
v_accvgpr_read_b32 v133, a237
v_accvgpr_read_b32 v134, a238
v_accvgpr_read_b32 v135, a239
s_lshl_b32 s4, s97, 7
s_add_u32 s4, s4, 147456
v_lshlrev_b32 v14, 4, v5
v_add_u32 v9, s4, v14
ds_read_b128 v[48:51], v9 offset:0
ds_read_b128 v[64:67], v9 offset:2048
ds_read_b128 v[52:55], v9 offset:32
ds_read_b128 v[68:71], v9 offset:2080
ds_read_b128 v[56:59], v9 offset:64
ds_read_b128 v[72:75], v9 offset:2112
ds_read_b128 v[60:63], v9 offset:96
ds_read_b128 v[76:79], v9 offset:2144
s_waitcnt lgkmcnt(0)
v_add_f32 v16, v16, v32
v_lshlrev_b32 v232, 16, v128
v_fmac_f32 v232, v16, v48
v_add_f32 v17, v17, v33
v_and_b32 v233, 0xffff0000, v128
v_fmac_f32 v233, v17, v49
v_add_f32 v18, v18, v34
v_lshlrev_b32 v234, 16, v129
v_fmac_f32 v234, v18, v50
v_add_f32 v19, v19, v35
v_and_b32 v235, 0xffff0000, v129
v_fmac_f32 v235, v19, v51
v_add_f32 v20, v20, v36
v_lshlrev_b32 v236, 16, v130
v_fmac_f32 v236, v20, v52
v_add_f32 v21, v21, v37
v_and_b32 v237, 0xffff0000, v130
v_fmac_f32 v237, v21, v53
v_add_f32 v22, v22, v38
v_lshlrev_b32 v238, 16, v131
v_fmac_f32 v238, v22, v54
v_add_f32 v23, v23, v39
v_and_b32 v239, 0xffff0000, v131
v_fmac_f32 v239, v23, v55
v_add_f32 v24, v24, v40
v_lshlrev_b32 v240, 16, v132
v_fmac_f32 v240, v24, v56
v_add_f32 v25, v25, v41
v_and_b32 v241, 0xffff0000, v132
v_fmac_f32 v241, v25, v57
v_add_f32 v26, v26, v42
v_lshlrev_b32 v242, 16, v133
v_fmac_f32 v242, v26, v58
v_add_f32 v27, v27, v43
v_and_b32 v243, 0xffff0000, v133
v_fmac_f32 v243, v27, v59
v_add_f32 v28, v28, v44
v_lshlrev_b32 v244, 16, v134
v_fmac_f32 v244, v28, v60
v_add_f32 v29, v29, v45
v_and_b32 v245, 0xffff0000, v134
v_fmac_f32 v245, v29, v61
v_add_f32 v30, v30, v46
v_lshlrev_b32 v246, 16, v135
v_fmac_f32 v246, v30, v62
v_add_f32 v31, v31, v47
v_and_b32 v247, 0xffff0000, v135
v_fmac_f32 v247, v31, v63
v_mul_f32 v16, v232, v64
v_mul_f32 v17, v233, v65
v_mul_f32 v18, v234, v66
v_mul_f32 v19, v235, v67
v_mul_f32 v20, v236, v68
v_mul_f32 v21, v237, v69
v_mul_f32 v22, v238, v70
v_mul_f32 v23, v239, v71
v_mul_f32 v24, v240, v72
v_mul_f32 v25, v241, v73
v_mul_f32 v26, v242, v74
v_mul_f32 v27, v243, v75
v_mul_f32 v28, v244, v76
v_mul_f32 v29, v245, v77
v_mul_f32 v30, v246, v78
v_mul_f32 v31, v247, v79
v_cvt_pk_bf16_f32 v32, v16, v17
v_cvt_pk_bf16_f32 v33, v18, v19
v_cvt_pk_bf16_f32 v34, v20, v21
v_cvt_pk_bf16_f32 v35, v22, v23
v_cvt_pk_bf16_f32 v36, v24, v25
v_cvt_pk_bf16_f32 v37, v26, v27
v_cvt_pk_bf16_f32 v38, v28, v29
v_cvt_pk_bf16_f32 v39, v30, v31
s_lshl_b32 s6, s45, 15
s_lshl_b32 s5, s97, 11
s_add_u32 s6, s6, s5
s_add_u32 s6, s6, 16908288
buffer_store_dwordx4 v[32:35], v1, s[84:87], s6 offen offset:0 sc1
buffer_store_dwordx4 v[36:39], v1, s[84:87], s6 offen offset:1024 sc1
v_add_f32 v48, v232, v233
v_mul_f32 v49, v232, v232
v_fmac_f32 v49, v233, v233
v_add_f32 v48, v48, v234
v_fmac_f32 v49, v234, v234
v_add_f32 v48, v48, v235
v_fmac_f32 v49, v235, v235
v_add_f32 v48, v48, v236
v_fmac_f32 v49, v236, v236
v_add_f32 v48, v48, v237
v_fmac_f32 v49, v237, v237
v_add_f32 v48, v48, v238
v_fmac_f32 v49, v238, v238
v_add_f32 v48, v48, v239
v_fmac_f32 v49, v239, v239
v_add_f32 v48, v48, v240
v_fmac_f32 v49, v240, v240
v_add_f32 v48, v48, v241
v_fmac_f32 v49, v241, v241
v_add_f32 v48, v48, v242
v_fmac_f32 v49, v242, v242
v_add_f32 v48, v48, v243
v_fmac_f32 v49, v243, v243
v_add_f32 v48, v48, v244
v_fmac_f32 v49, v244, v244
v_add_f32 v48, v48, v245
v_fmac_f32 v49, v245, v245
v_add_f32 v48, v48, v246
v_fmac_f32 v49, v246, v246
v_add_f32 v48, v48, v247
v_fmac_f32 v49, v247, v247
v_mov_b32 v50, v48
v_mov_b32 v51, v49
s_nop 0
v_permlane32_swap_b32 v48, v50
v_permlane32_swap_b32 v49, v51
v_add_f32 v48, v48, v50
v_add_f32 v49, v49, v51
s_lshl_b32 s6, s45, 12
s_lshl_b32 s5, s97, 8
s_add_u32 s6, s6, s5
s_add_u32 s6, s6, 1048576
v_and_b32 v14, 31, v0
v_lshlrev_b32 v14, 3, v14
buffer_store_dwordx2 v[48:49], v14, s[84:87], s6 offen sc1
s_add_u32 s7, s96, s97
s_waitcnt vmcnt(0)
s_lshl_b32 s4, s7, 2
s_add_u32 s4, s4, 40960
v_mov_b32 v14, s40
v_mov_b32 v15, 0
s_mov_b64 exec, 1
buffer_store_dword v14, v15, s[84:87], s4 offen sc1
s_mov_b64 exec, -1
br_106:
s_cmp_eq_u32 s8, 0
s_cbranch_scc1 bd_107
s_mov_b32 m0, s10
s_add_u32 s10, s10, s11
buffer_load_dwordx4 v12, s[88:91], s9 offen sc1 lds
s_add_u32 s9, s9, s12
s_sub_u32 s8, s8, 1
s_branch br_106
bd_107:
s_mov_b32 s88, s84
s_mov_b32 s89, s85
s_mov_b32 s90, s86
s_mov_b32 s91, 0x20000
s_mul_i32 s9, s93, 43
s_add_u32 s9, s9, s92
s_add_u32 s9, s9, 1
s_lshl_b32 s9, s9, 1
s_and_b32 s5, s43, 1
s_add_u32 s9, s9, s5
s_lshl_b32 s9, s9, 14
s_add_u32 s9, s9, 31588352
s_lshl_b32 s4, s43, 14
s_add_u32 s10, s4, 0
s_mov_b32 s8, 16
s_mov_b32 s11, 1024
s_mov_b32 s12, 1024
v_mov_b32 v12, v1
s_lshl_b32 s4, s41, 6
s_lshl_b32 s5, s43, 4
s_add_u32 s96, s4, s5
s_lshl_b32 s4, s96, 2
s_add_u32 s5, s4, 40960
v_and_b32 v14, 15, v0
v_lshlrev_b32 v14, 2, v14
s_mov_b32 s47, 0x8000
poll_108:
s_cmp_eq_u32 s8, 0
s_cbranch_scc1 pb_110
s_mov_b32 m0, s10
s_add_u32 s10, s10, s11
buffer_load_dwordx4 v12, s[88:91], s9 offen sc1 lds
s_add_u32 s9, s9, s12
s_sub_u32 s8, s8, 1
s_cmp_eq_u32 s8, 0
s_cbranch_scc1 pb_110
s_mov_b32 m0, s10
s_add_u32 s10, s10, s11
buffer_load_dwordx4 v12, s[88:91], s9 offen sc1 lds
s_add_u32 s9, s9, s12
s_sub_u32 s8, s8, 1
s_cmp_eq_u32 s8, 0
s_cbranch_scc1 pb_110
s_mov_b32 m0, s10
s_add_u32 s10, s10, s11
buffer_load_dwordx4 v12, s[88:91], s9 offen sc1 lds
s_add_u32 s9, s9, s12
s_sub_u32 s8, s8, 1
s_cmp_eq_u32 s8, 0
s_cbranch_scc1 pb_110
s_mov_b32 m0, s10
s_add_u32 s10, s10, s11
buffer_load_dwordx4 v12, s[88:91], s9 offen sc1 lds
s_add_u32 s9, s9, s12
s_sub_u32 s8, s8, 1
s_cmp_eq_u32 s8, 0
s_cbranch_scc1 pb_110
s_mov_b32 m0, s10
s_add_u32 s10, s10, s11
buffer_load_dwordx4 v12, s[88:91], s9 offen sc1 lds
s_add_u32 s9, s9, s12
s_sub_u32 s8, s8, 1
s_cmp_eq_u32 s8, 0
s_cbranch_scc1 pb_110
s_mov_b32 m0, s10
s_add_u32 s10, s10, s11
buffer_load_dwordx4 v12, s[88:91], s9 offen sc1 lds
s_add_u32 s9, s9, s12
s_sub_u32 s8, s8, 1
s_cmp_eq_u32 s8, 0
s_cbranch_scc1 pb_110
s_mov_b32 m0, s10
s_add_u32 s10, s10, s11
buffer_load_dwordx4 v12, s[88:91], s9 offen sc1 lds
s_add_u32 s9, s9, s12
s_sub_u32 s8, s8, 1
s_cmp_eq_u32 s8, 0
s_cbranch_scc1 pb_110
s_mov_b32 m0, s10
s_add_u32 s10, s10, s11
buffer_load_dwordx4 v12, s[88:91], s9 offen sc1 lds
s_add_u32 s9, s9, s12
s_sub_u32 s8, s8, 1
s_cmp_eq_u32 s8, 0
s_cbranch_scc1 pb_110
s_mov_b32 m0, s10
s_add_u32 s10, s10, s11
buffer_load_dwordx4 v12, s[88:91], s9 offen sc1 lds
s_add_u32 s9, s9, s12
s_sub_u32 s8, s8, 1
s_cmp_eq_u32 s8, 0
s_cbranch_scc1 pb_110
s_mov_b32 m0, s10
s_add_u32 s10, s10, s11
buffer_load_dwordx4 v12, s[88:91], s9 offen sc1 lds
s_add_u32 s9, s9, s12
s_sub_u32 s8, s8, 1
s_cmp_eq_u32 s8, 0
s_cbranch_scc1 pb_110
s_mov_b32 m0, s10
s_add_u32 s10, s10, s11
buffer_load_dwordx4 v12, s[88:91], s9 offen sc1 lds
s_add_u32 s9, s9, s12
s_sub_u32 s8, s8, 1
s_cmp_eq_u32 s8, 0
s_cbranch_scc1 pb_110
s_mov_b32 m0, s10
s_add_u32 s10, s10, s11
buffer_load_dwordx4 v12, s[88:91], s9 offen sc1 lds
s_add_u32 s9, s9, s12
s_sub_u32 s8, s8, 1
s_cmp_eq_u32 s8, 0
s_cbranch_scc1 pb_110
s_mov_b32 m0, s10
s_add_u32 s10, s10, s11
buffer_load_dwordx4 v12, s[88:91], s9 offen sc1 lds
s_add_u32 s9, s9, s12
s_sub_u32 s8, s8, 1
s_cmp_eq_u32 s8, 0
s_cbranch_scc1 pb_110
s_mov_b32 m0, s10
s_add_u32 s10, s10, s11
buffer_load_dwordx4 v12, s[88:91], s9 offen sc1 lds
s_add_u32 s9, s9, s12
s_sub_u32 s8, s8, 1
s_cmp_eq_u32 s8, 0
s_cbranch_scc1 pb_110
s_mov_b32 m0, s10
s_add_u32 s10, s10, s11
buffer_load_dwordx4 v12, s[88:91], s9 offen sc1 lds
s_add_u32 s9, s9, s12
s_sub_u32 s8, s8, 1
s_cmp_eq_u32 s8, 0
s_cbranch_scc1 pb_110
s_mov_b32 m0, s10
s_add_u32 s10, s10, s11
buffer_load_dwordx4 v12, s[88:91], s9 offen sc1 lds
s_add_u32 s9, s9, s12
s_sub_u32 s8, s8, 1
pb_110:
buffer_load_dword v15, v14, s[84:87], s5 offen sc1
s_waitcnt vmcnt(0)
v_cmp_ne_u32 vcc, s40, v15
s_cbranch_vccz pd_109
s_sub_u32 s47, s47, 1
s_cbranch_scc0 poll_108
pd_109:
s_lshl_b32 s6, s44, 12
s_add_u32 s6, s6, 1048576
v_lshlrev_b32 v14, 3, v0
buffer_load_dwordx2 v[184:185], v14, s[84:87], s6 offen offset:0 sc1
buffer_load_dwordx2 v[186:187], v14, s[84:87], s6 offen offset:512 sc1
buffer_load_dwordx2 v[188:189], v14, s[84:87], s6 offen offset:1024 sc1
buffer_load_dwordx2 v[190:191], v14, s[84:87], s6 offen offset:1536 sc1
buffer_load_dwordx2 v[192:193], v14, s[84:87], s6 offen offset:2048 sc1
buffer_load_dwordx2 v[194:195], v14, s[84:87], s6 offen offset:2560 sc1
buffer_load_dwordx2 v[196:197], v14, s[84:87], s6 offen offset:3072 sc1
buffer_load_dwordx2 v[198:199], v14, s[84:87], s6 offen offset:3584 sc1
s_lshl_b32 s6, s44, 15
s_add_u32 s6, s6, 16908288
buffer_load_dwordx4 a[0:3], v1, s[84:87], s6 offen offset:0 sc1
buffer_load_dwordx4 a[4:7], v1, s[84:87], s6 offen offset:1024 sc1
buffer_load_dwordx4 a[8:11], v1, s[84:87], s6 offen offset:2048 sc1
buffer_load_dwordx4 a[12:15], v1, s[84:87], s6 offen offset:3072 sc1
s_add_u32 s6, s6, 4096
buffer_load_dwordx4 a[16:19], v1, s[84:87], s6 offen offset:0 sc1
buffer_load_dwordx4 a[20:23], v1, s[84:87], s6 offen offset:1024 sc1
buffer_load_dwordx4 a[24:27], v1, s[84:87], s6 offen offset:2048 sc1
buffer_load_dwordx4 a[28:31], v1, s[84:87], s6 offen offset:3072 sc1
v_lshlrev_b32 v9, 4, v5
v_add_u32 v9, 155648, v9
v_add_u32 v10, 65536, v1
s_mul_i32 s4, s44, 98304
s_lshl_b32 s5, s92, 11
s_add_u32 s4, s4, s5
s_add_u32 s97, s4, 20971520
s_add_u32 s13, s97, 4096
s_barrier
ds_read_b128 v[80:83], v10 offset:0
ds_read_b128 v[84:87], v10 offset:32768
ds_read_b128 v[88:91], v10 offset:1024
ds_read_b128 v[92:95], v10 offset:33792
s_waitcnt vmcnt(8)
v_add_f32 v184, v184, v186
v_add_f32 v185, v185, v187
v_add_f32 v184, v184, v188
v_add_f32 v185, v185, v189
v_add_f32 v184, v184, v190
v_add_f32 v185, v185, v191
v_add_f32 v184, v184, v192
v_add_f32 v185, v185, v193
v_add_f32 v184, v184, v194
v_add_f32 v185, v185, v195
v_add_f32 v184, v184, v196
v_add_f32 v185, v185, v197
v_add_f32 v184, v184, v198
v_add_f32 v185, v185, v199
v_mov_b32 v186, v184
v_mov_b32 v187, v185
s_nop 0
v_permlane32_swap_b32 v184, v186
v_permlane32_swap_b32 v185, v187
v_add_f32 v184, v184, v186
v_add_f32 v185, v185, v187
v_mul_f32 v184, 0x3b000000, v184
v_mul_f32 v185, 0x3b000000, v185
v_fma_f32 v185, -v184, v184, v185
v_max_f32 v185, 0, v185
v_add_f32 v185, 0x3727c5ac, v185
v_rsq_f32 v145, v185
s_nop 0
v_mul_f32 v144, v184, v145
v_sub_f32 v144, 0, v144
v_mul_f32 v146, 0xbfb8aa3b, v145
s_add_u32 s6, s6, 4096
buffer_load_dwordx4 a[32:35], v1, s[84:87], s6 offen offset:0 sc1
s_waitcnt vmcnt(8)
s_waitcnt lgkmcnt(2)
v_mfma_f32_32x32x16_bf16 v[16:31], v[80:83], a[0:3], 0
ds_read_b128 v[96:99], v10 offset:2048
ds_read_b128 v[100:103], v10 offset:34816
v_mfma_f32_32x32x16_bf16 v[32:47], v[84:87], a[0:3], 0
buffer_load_dwordx4 a[36:39], v1, s[84:87], s6 offen offset:1024 sc1
s_waitcnt vmcnt(8)
s_waitcnt lgkmcnt(2)
v_mfma_f32_32x32x16_bf16 v[16:31], v[88:91], a[4:7], v[16:31]
ds_read_b128 v[80:83], v10 offset:3072
ds_read_b128 v[84:87], v10 offset:35840
v_mfma_f32_32x32x16_bf16 v[32:47], v[92:95], a[4:7], v[32:47]
s_cmp_eq_u32 s8, 0
s_cbranch_scc1 pq_111
s_mov_b32 m0, s10
s_add_u32 s10, s10, s11
buffer_load_dwordx4 v12, s[88:91], s9 offen sc1 lds
s_add_u32 s9, s9, s12
s_sub_u32 s8, s8, 1
pq_111:
buffer_load_dwordx4 a[40:43], v1, s[84:87], s6 offen offset:2048 sc1
s_waitcnt vmcnt(8)
s_waitcnt lgkmcnt(2)
v_mfma_f32_32x32x16_bf16 v[16:31], v[96:99], a[8:11], v[16:31]
ds_read_b128 v[88:91], v10 offset:4096
ds_read_b128 v[92:95], v10 offset:36864
v_mfma_f32_32x32x16_bf16 v[32:47], v[100:103], a[8:11], v[32:47]
buffer_load_dwordx4 a[44:47], v1, s[84:87], s6 offen offset:3072 sc1
s_waitcnt vmcnt(8)
s_waitcnt lgkmcnt(2)
v_mfma_f32_32x32x16_bf16 v[16:31], v[80:83], a[12:15], v[16:31]
ds_read_b128 v[96:99], v10 offset:5120
ds_read_b128 v[100:103], v10 offset:37888
v_mfma_f32_32x32x16_bf16 v[32:47], v[84:87], a[12:15], v[32:47]
s_cmp_eq_u32 s8, 0
s_cbranch_scc1 pq_112
s_mov_b32 m0, s10
s_add_u32 s10, s10, s11
buffer_load_dwordx4 v12, s[88:91], s9 offen sc1 lds
s_add_u32 s9, s9, s12
s_sub_u32 s8, s8, 1
pq_112:
s_add_u32 s6, s6, 4096
buffer_load_dwordx4 a[48:51], v1, s[84:87], s6 offen offset:0 sc1
s_waitcnt vmcnt(8)
s_waitcnt lgkmcnt(2)
v_mfma_f32_32x32x16_bf16 v[16:31], v[88:91], a[16:19], v[16:31]
ds_read_b128 v[80:83], v10 offset:6144
ds_read_b128 v[84:87], v10 offset:38912
v_mfma_f32_32x32x16_bf16 v[32:47], v[92:95], a[16:19], v[32:47]
buffer_load_dwordx4 a[52:55], v1, s[84:87], s6 offen offset:1024 sc1
s_waitcnt vmcnt(8)
s_waitcnt lgkmcnt(2)
v_mfma_f32_32x32x16_bf16 v[16:31], v[96:99], a[20:23], v[16:31]
ds_read_b128 v[88:91], v10 offset:7168
ds_read_b128 v[92:95], v10 offset:39936
v_mfma_f32_32x32x16_bf16 v[32:47], v[100:103], a[20:23], v[32:47]
s_cmp_eq_u32 s8, 0
s_cbranch_scc1 pq_113
s_mov_b32 m0, s10
s_add_u32 s10, s10, s11
buffer_load_dwordx4 v12, s[88:91], s9 offen sc1 lds
s_add_u32 s9, s9, s12
s_sub_u32 s8, s8, 1
pq_113:
buffer_load_dwordx4 a[56:59], v1, s[84:87], s6 offen offset:2048 sc1
s_waitcnt vmcnt(8)
s_waitcnt lgkmcnt(2)
v_mfma_f32_32x32x16_bf16 v[16:31], v[80:83], a[24:27], v[16:31]
ds_read_b128 v[96:99], v10 offset:8192
ds_read_b128 v[100:103], v10 offset:40960
v_mfma_f32_32x32x16_bf16 v[32:47], v[84:87], a[24:27], v[32:47]
buffer_load_dwordx4 a[60:63], v1, s[84:87], s6 offen offset:3072 sc1
s_waitcnt vmcnt(8)
s_waitcnt lgkmcnt(2)
v_mfma_f32_32x32x16_bf16 v[16:31], v[88:91], a[28:31], v[16:31]
ds_read_b128 v[80:83], v10 offset:9216
ds_read_b128 v[84:87], v10 offset:41984
v_mfma_f32_32x32x16_bf16 v[32:47], v[92:95], a[28:31], v[32:47]
s_cmp_eq_u32 s8, 0
s_cbranch_scc1 pq_114
s_mov_b32 m0, s10
s_add_u32 s10, s10, s11
buffer_load_dwordx4 v12, s[88:91], s9 offen sc1 lds
s_add_u32 s9, s9, s12
s_sub_u32 s8, s8, 1
pq_114:
s_add_u32 s6, s6, 4096
buffer_load_dwordx4 a[64:67], v1, s[84:87], s6 offen offset:0 sc1
s_waitcnt vmcnt(8)
s_waitcnt lgkmcnt(2)
v_mfma_f32_32x32x16_bf16 v[16:31], v[96:99], a[32:35], v[16:31]
ds_read_b128 v[88:91], v10 offset:10240
ds_read_b128 v[92:95], v10 offset:43008
v_mfma_f32_32x32x16_bf16 v[32:47], v[100:103], a[32:35], v[32:47]
buffer_load_dwordx4 a[68:71], v1, s[84:87], s6 offen offset:1024 sc1
s_waitcnt vmcnt(8)
s_waitcnt lgkmcnt(2)
v_mfma_f32_32x32x16_bf16 v[16:31], v[80:83], a[36:39], v[16:31]
ds_read_b128 v[96:99], v10 offset:11264
ds_read_b128 v[100:103], v10 offset:44032
v_mfma_f32_32x32x16_bf16 v[32:47], v[84:87], a[36:39], v[32:47]
s_cmp_eq_u32 s8, 0
s_cbranch_scc1 pq_115
s_mov_b32 m0, s10
s_add_u32 s10, s10, s11
buffer_load_dwordx4 v12, s[88:91], s9 offen sc1 lds
s_add_u32 s9, s9, s12
s_sub_u32 s8, s8, 1
pq_115:
buffer_load_dwordx4 a[72:75], v1, s[84:87], s6 offen offset:2048 sc1
s_waitcnt vmcnt(8)
s_waitcnt lgkmcnt(2)
v_mfma_f32_32x32x16_bf16 v[16:31], v[88:91], a[40:43], v[16:31]
ds_read_b128 v[80:83], v10 offset:12288
ds_read_b128 v[84:87], v10 offset:45056
v_mfma_f32_32x32x16_bf16 v[32:47], v[92:95], a[40:43], v[32:47]
buffer_load_dwordx4 a[76:79], v1, s[84:87], s6 offen offset:3072 sc1
s_waitcnt vmcnt(8)
s_waitcnt lgkmcnt(2)
v_mfma_f32_32x32x16_bf16 v[16:31], v[96:99], a[44:47], v[16:31]
ds_read_b128 v[88:91], v10 offset:13312
ds_read_b128 v[92:95], v10 offset:46080
v_mfma_f32_32x32x16_bf16 v[32:47], v[100:103], a[44:47], v[32:47]
s_cmp_eq_u32 s8, 0
s_cbranch_scc1 pq_116
s_mov_b32 m0, s10
s_add_u32 s10, s10, s11
buffer_load_dwordx4 v12, s[88:91], s9 offen sc1 lds
s_add_u32 s9, s9, s12
s_sub_u32 s8, s8, 1
pq_116:
s_add_u32 s6, s6, 4096
buffer_load_dwordx4 a[80:83], v1, s[84:87], s6 offen offset:0 sc1
s_waitcnt vmcnt(8)
s_waitcnt lgkmcnt(2)
v_mfma_f32_32x32x16_bf16 v[16:31], v[80:83], a[48:51], v[16:31]
ds_read_b128 v[96:99], v10 offset:14336
ds_read_b128 v[100:103], v10 offset:47104
v_mfma_f32_32x32x16_bf16 v[32:47], v[84:87], a[48:51], v[32:47]
buffer_load_dwordx4 a[84:87], v1, s[84:87], s6 offen offset:1024 sc1
s_waitcnt vmcnt(8)
s_waitcnt lgkmcnt(2)
v_mfma_f32_32x32x16_bf16 v[16:31], v[88:91], a[52:55], v[16:31]
ds_read_b128 v[80:83], v10 offset:15360
ds_read_b128 v[84:87], v10 offset:48128
v_mfma_f32_32x32x16_bf16 v[32:47], v[92:95], a[52:55], v[32:47]
s_cmp_eq_u32 s8, 0
s_cbranch_scc1 pq_117
s_mov_b32 m0, s10
s_add_u32 s10, s10, s11
buffer_load_dwordx4 v12, s[88:91], s9 offen sc1 lds
s_add_u32 s9, s9, s12
s_sub_u32 s8, s8, 1
pq_117:
buffer_load_dwordx4 a[88:91], v1, s[84:87], s6 offen offset:2048 sc1
s_waitcnt vmcnt(8)
s_waitcnt lgkmcnt(2)
v_mfma_f32_32x32x16_bf16 v[16:31], v[96:99], a[56:59], v[16:31]
ds_read_b128 v[88:91], v10 offset:16384
ds_read_b128 v[92:95], v10 offset:49152
v_mfma_f32_32x32x16_bf16 v[32:47], v[100:103], a[56:59], v[32:47]
buffer_load_dwordx4 a[92:95], v1, s[84:87], s6 offen offset:3072 sc1
s_waitcnt vmcnt(8)
s_waitcnt lgkmcnt(2)
v_mfma_f32_32x32x16_bf16 v[16:31], v[80:83], a[60:63], v[16:31]
ds_read_b128 v[96:99], v10 offset:17408
ds_read_b128 v[100:103], v10 offset:50176
v_mfma_f32_32x32x16_bf16 v[32:47], v[84:87], a[60:63], v[32:47]
s_cmp_eq_u32 s8, 0
s_cbranch_scc1 pq_118
s_mov_b32 m0, s10
s_add_u32 s10, s10, s11
buffer_load_dwordx4 v12, s[88:91], s9 offen sc1 lds
s_add_u32 s9, s9, s12
s_sub_u32 s8, s8, 1
pq_118:
s_add_u32 s6, s6, 4096
buffer_load_dwordx4 a[96:99], v1, s[84:87], s6 offen offset:0 sc1
s_waitcnt vmcnt(8)
s_waitcnt lgkmcnt(2)
v_mfma_f32_32x32x16_bf16 v[16:31], v[88:91], a[64:67], v[16:31]
ds_read_b128 v[80:83], v10 offset:18432
ds_read_b128 v[84:87], v10 offset:51200
v_mfma_f32_32x32x16_bf16 v[32:47], v[92:95], a[64:67], v[32:47]
buffer_load_dwordx4 a[100:103], v1, s[84:87], s6 offen offset:1024 sc1
s_waitcnt vmcnt(8)
s_waitcnt lgkmcnt(2)
v_mfma_f32_32x32x16_bf16 v[16:31], v[96:99], a[68:71], v[16:31]
ds_read_b128 v[88:91], v10 offset:19456
ds_read_b128 v[92:95], v10 offset:52224
v_mfma_f32_32x32x16_bf16 v[32:47], v[100:103], a[68:71], v[32:47]
s_cmp_eq_u32 s8, 0
s_cbranch_scc1 pq_119
s_mov_b32 m0, s10
s_add_u32 s10, s10, s11
buffer_load_dwordx4 v12, s[88:91], s9 offen sc1 lds
s_add_u32 s9, s9, s12
s_sub_u32 s8, s8, 1
pq_119:
buffer_load_dwordx4 a[104:107], v1, s[84:87], s6 offen offset:2048 sc1
s_waitcnt vmcnt(8)
s_waitcnt lgkmcnt(2)
v_mfma_f32_32x32x16_bf16 v[16:31], v[80:83], a[72:75], v[16:31]
ds_read_b128 v[96:99], v10 offset:20480
ds_read_b128 v[100:103], v10 offset:53248
v_mfma_f32_32x32x16_bf16 v[32:47], v[84:87], a[72:75], v[32:47]
buffer_load_dwordx4 a[108:111], v1, s[84:87], s6 offen offset:3072 sc1
s_waitcnt vmcnt(8)
s_waitcnt lgkmcnt(2)
v_mfma_f32_32x32x16_bf16 v[16:31], v[88:91], a[76:79], v[16:31]
ds_read_b128 v[80:83], v10 offset:21504
ds_read_b128 v[84:87], v10 offset:54272
v_mfma_f32_32x32x16_bf16 v[32:47], v[92:95], a[76:79], v[32:47]
s_cmp_eq_u32 s8, 0
s_cbranch_scc1 pq_120
s_mov_b32 m0, s10
s_add_u32 s10, s10, s11
buffer_load_dwordx4 v12, s[88:91], s9 offen sc1 lds
s_add_u32 s9, s9, s12
s_sub_u32 s8, s8, 1
pq_120:
s_add_u32 s6, s6, 4096
buffer_load_dwordx4 a[112:115], v1, s[84:87], s6 offen offset:0 sc1
s_waitcnt vmcnt(8)
s_waitcnt lgkmcnt(2)
v_mfma_f32_32x32x16_bf16 v[16:31], v[96:99], a[80:83], v[16:31]
ds_read_b128 v[88:91], v10 offset:22528
ds_read_b128 v[92:95], v10 offset:55296
v_mfma_f32_32x32x16_bf16 v[32:47], v[100:103], a[80:83], v[32:47]
buffer_load_dwordx4 a[116:119], v1, s[84:87], s6 offen offset:1024 sc1
s_waitcnt vmcnt(8)
s_waitcnt lgkmcnt(2)
v_mfma_f32_32x32x16_bf16 v[16:31], v[80:83], a[84:87], v[16:31]
ds_read_b128 v[96:99], v10 offset:23552
ds_read_b128 v[100:103], v10 offset:56320
v_mfma_f32_32x32x16_bf16 v[32:47], v[84:87], a[84:87], v[32:47]
s_cmp_eq_u32 s8, 0
s_cbranch_scc1 pq_121
s_mov_b32 m0, s10
s_add_u32 s10, s10, s11
buffer_load_dwordx4 v12, s[88:91], s9 offen sc1 lds
s_add_u32 s9, s9, s12
s_sub_u32 s8, s8, 1
pq_121:
buffer_load_dwordx4 a[120:123], v1, s[84:87], s6 offen offset:2048 sc1
s_waitcnt vmcnt(8)
s_waitcnt lgkmcnt(2)
v_mfma_f32_32x32x16_bf16 v[16:31], v[88:91], a[88:91], v[16:31]
ds_read_b128 v[80:83], v10 offset:24576
ds_read_b128 v[84:87], v10 offset:57344
v_mfma_f32_32x32x16_bf16 v[32:47], v[92:95], a[88:91], v[32:47]
buffer_load_dwordx4 a[124:127], v1, s[84:87], s6 offen offset:3072 sc1
s_waitcnt vmcnt(8)
s_waitcnt lgkmcnt(2)
v_mfma_f32_32x32x16_bf16 v[16:31], v[96:99], a[92:95], v[16:31]
ds_read_b128 v[88:91], v10 offset:25600
ds_read_b128 v[92:95], v10 offset:58368
v_mfma_f32_32x32x16_bf16 v[32:47], v[100:103], a[92:95], v[32:47]
s_cmp_eq_u32 s8, 0
s_cbranch_scc1 pq_122
s_mov_b32 m0, s10
s_add_u32 s10, s10, s11
buffer_load_dwordx4 v12, s[88:91], s9 offen sc1 lds
s_add_u32 s9, s9, s12
s_sub_u32 s8, s8, 1
pq_122:
s_waitcnt vmcnt(7)
s_waitcnt lgkmcnt(2)
v_mfma_f32_32x32x16_bf16 v[16:31], v[80:83], a[96:99], v[16:31]
ds_read_b128 v[96:99], v10 offset:26624
ds_read_b128 v[100:103], v10 offset:59392
v_mfma_f32_32x32x16_bf16 v[32:47], v[84:87], a[96:99], v[32:47]
s_mul_i32 s4, s3, 3072
s_add_u32 s4, s4, 131072
s_lshl_b32 s14, s43, 9
s_add_u32 s14, s14, s4
v_lshlrev_b32 v147, 3, v0
s_and_b32 s15, s43, 1
s_add_u32 s15, s15, 4
s_lshl_b32 s15, s15, 9
s_add_u32 s15, s15, s4
buffer_load_dwordx2 v[148:149], v147, s[84:87], s14 offen sc1
buffer_load_dwordx2 v[150:151], v147, s[84:87], s15 offen sc1
s_cmp_eq_u32 s8, 0
s_cbranch_scc1 pq_123
s_mov_b32 m0, s10
s_add_u32 s10, s10, s11
buffer_load_dwordx4 v12, s[88:91], s9 offen sc1 lds
s_add_u32 s9, s9, s12
s_sub_u32 s8, s8, 1
pq_123:
s_waitcnt vmcnt(8)
s_waitcnt lgkmcnt(2)
v_mfma_f32_32x32x16_bf16 v[16:31], v[88:91], a[100:103], v[16:31]
ds_read_b128 v[80:83], v10 offset:27648
ds_read_b128 v[84:87], v10 offset:60416
v_mfma_f32_32x32x16_bf16 v[32:47], v[92:95], a[100:103], v[32:47]
s_cmp_eq_u32 s8, 0
s_cbranch_scc1 pq_124
s_mov_b32 m0, s10
s_add_u32 s10, s10, s11
buffer_load_dwordx4 v12, s[88:91], s9 offen sc1 lds
s_add_u32 s9, s9, s12
s_sub_u32 s8, s8, 1
pq_124:
s_waitcnt vmcnt(7)
s_waitcnt lgkmcnt(2)
v_mfma_f32_32x32x16_bf16 v[16:31], v[96:99], a[104:107], v[16:31]
ds_read_b128 v[88:91], v10 offset:28672
ds_read_b128 v[92:95], v10 offset:61440
v_mfma_f32_32x32x16_bf16 v[32:47], v[100:103], a[104:107], v[32:47]
s_cmp_eq_u32 s8, 0
s_cbranch_scc1 pq_125
s_mov_b32 m0, s10
s_add_u32 s10, s10, s11
buffer_load_dwordx4 v12, s[88:91], s9 offen sc1 lds
s_add_u32 s9, s9, s12
s_sub_u32 s8, s8, 1
pq_125:
s_waitcnt vmcnt(6)
s_waitcnt lgkmcnt(2)
v_mfma_f32_32x32x16_bf16 v[16:31], v[80:83], a[108:111], v[16:31]
ds_read_b128 v[96:99], v10 offset:29696
ds_read_b128 v[100:103], v10 offset:62464
v_mfma_f32_32x32x16_bf16 v[32:47], v[84:87], a[108:111], v[32:47]
s_cmp_eq_u32 s8, 0
s_cbranch_scc1 pq_126
s_mov_b32 m0, s10
s_add_u32 s10, s10, s11
buffer_load_dwordx4 v12, s[88:91], s9 offen sc1 lds
s_add_u32 s9, s9, s12
s_sub_u32 s8, s8, 1
pq_126:
s_waitcnt vmcnt(5)
s_waitcnt lgkmcnt(2)
v_mfma_f32_32x32x16_bf16 v[16:31], v[88:91], a[112:115], v[16:31]
ds_read_b128 v[80:83], v10 offset:30720
ds_read_b128 v[84:87], v10 offset:63488
v_mfma_f32_32x32x16_bf16 v[32:47], v[92:95], a[112:115], v[32:47]
s_cmp_eq_u32 s8, 0
s_cbranch_scc1 pq_127
s_mov_b32 m0, s10
s_add_u32 s10, s10, s11
buffer_load_dwordx4 v12, s[88:91], s9 offen sc1 lds
s_add_u32 s9, s9, s12
s_sub_u32 s8, s8, 1
pq_127:
s_waitcnt vmcnt(4)
s_waitcnt lgkmcnt(2)
v_mfma_f32_32x32x16_bf16 v[16:31], v[96:99], a[116:119], v[16:31]
ds_read_b128 v[88:91], v10 offset:31744
ds_read_b128 v[92:95], v10 offset:64512
v_mfma_f32_32x32x16_bf16 v[32:47], v[100:103], a[116:119], v[32:47]
s_cmp_eq_u32 s8, 0
s_cbranch_scc1 pq_128
s_mov_b32 m0, s10
s_add_u32 s10, s10, s11
buffer_load_dwordx4 v12, s[88:91], s9 offen sc1 lds
s_add_u32 s9, s9, s12
s_sub_u32 s8, s8, 1
pq_128:
s_waitcnt vmcnt(3)
s_waitcnt lgkmcnt(2)
v_mfma_f32_32x32x16_bf16 v[16:31], v[80:83], a[120:123], v[16:31]
v_mfma_f32_32x32x16_bf16 v[32:47], v[84:87], a[120:123], v[32:47]
s_cmp_eq_u32 s8, 0
s_cbranch_scc1 pq_129
s_mov_b32 m0, s10
s_add_u32 s10, s10, s11
buffer_load_dwordx4 v12, s[88:91], s9 offen sc1 lds
s_add_u32 s9, s9, s12
s_sub_u32 s8, s8, 1
pq_129:
s_waitcnt vmcnt(2)
s_waitcnt lgkmcnt(0)
v_mfma_f32_32x32x16_bf16 v[16:31], v[88:91], a[124:127], v[16:31]
v_mfma_f32_32x32x16_bf16 v[32:47], v[92:95], a[124:127], v[32:47]
s_cmp_eq_u32 s8, 0
s_cbranch_scc1 pq_130
s_mov_b32 m0, s10
s_add_u32 s10, s10, s11
buffer_load_dwordx4 v12, s[88:91], s9 offen sc1 lds
s_add_u32 s9, s9, s12
s_sub_u32 s8, s8, 1
pq_130:
br_131:
s_cmp_eq_u32 s8, 0
s_cbranch_scc1 bd_132
s_mov_b32 m0, s10
s_add_u32 s10, s10, s11
buffer_load_dwordx4 v12, s[88:91], s9 offen sc1 lds
s_add_u32 s9, s9, s12
s_sub_u32 s8, s8, 1
s_branch br_131
bd_132:
s_waitcnt vmcnt(0)
v_cmp_ne_u32 vcc, s40, v149
v_cmp_ne_u32 s[4:5], s40, v151
s_nop 0
s_or_b64 vcc, vcc, s[4:5]
s_cbranch_vccz ok_133
s_mov_b32 s47, 0x8000
poll_134:
buffer_load_dwordx2 v[148:149], v147, s[84:87], s14 offen sc1
s_waitcnt vmcnt(0)
v_cmp_ne_u32 vcc, s40, v149
s_cbranch_vccz pd_135
s_sub_u32 s47, s47, 1
s_cbranch_scc0 poll_134
pd_135:
s_mov_b32 s47, 0x8000
poll_137:
buffer_load_dwordx2 v[150:151], v147, s[84:87], s15 offen sc1
s_waitcnt vmcnt(0)
v_cmp_ne_u32 vcc, s40, v151
s_cbranch_vccz pd_138
s_sub_u32 s47, s47, 1
s_cbranch_scc0 poll_137
pd_138:
ok_133:
s_and_b32 s5, s43, 1
s_cmp_eq_u32 s5, 0
s_cselect_b32 s6, 0xbfb8aa3b, 1.0
v_mul_f32 v148, s6, v148
v_mul_f32 v150, s6, v150
s_lshl_b32 s6, s43, 8
s_add_u32 s6, s6, 155648
v_lshl_add_u32 v14, v0, 2, s6
s_lshl_b32 s5, s5, 8
s_add_u32 s5, s5, 156672
v_lshl_add_u32 v15, v0, 2, s5
ds_write_b32 v14, v148
ds_write_b32 v15, v150
s_waitcnt vmcnt(0)
s_waitcnt lgkmcnt(0)
s_barrier
s_cmp_ge_u32 s3, 11
s_cbranch_scc1 L_two
s_mov_b32 s88, s84
s_mov_b32 s89, s85
s_mov_b32 s90, s86
s_mov_b32 s91, 0x20000
s_mul_i32 s9, s93, 43
s_add_u32 s9, s9, s92
s_add_u32 s9, s9, 2
s_lshl_b32 s9, s9, 1
s_and_b32 s5, s43, 1
s_add_u32 s9, s9, s5
s_lshl_b32 s9, s9, 14
s_add_u32 s9, s9, 31588352
s_lshl_b32 s4, s43, 14
s_add_u32 s10, s4, 65536
s_mov_b32 s8, 16
s_mov_b32 s11, 1024
s_mov_b32 s12, 1024
v_mov_b32 v12, v1
ds_read_b128 v[80:83], v1 offset:0
ds_read_b128 v[84:87], v1 offset:32768
ds_read_b128 v[88:91], v1 offset:1024
ds_read_b128 v[92:95], v1 offset:33792
s_mov_b32 m0, s10
s_waitcnt lgkmcnt(2)
v_mfma_f32_32x32x16_bf16 v[48:63], v[80:83], a[0:3], 0
ds_read_b128 v[96:99], v1 offset:2048
ds_read_b128 v[100:103], v1 offset:34816
v_mfma_f32_32x32x16_bf16 v[64:79], v[84:87], a[0:3], 0
buffer_load_dwordx4 v12, s[88:91], s9 offen sc1 lds
s_add_u32 m0, m0, s11
s_add_u32 s9, s9, s12
s_waitcnt lgkmcnt(2)
v_mfma_f32_32x32x16_bf16 v[48:63], v[88:91], a[4:7], v[48:63]
ds_read_b128 v[80:83], v1 offset:3072
ds_read_b128 v[84:87], v1 offset:35840
ds_read_b128 v[104:107], v9 offset:0
ds_read_b128 v[108:111], v9 offset:128
ds_read_b128 v[112:115], v9 offset:256
v_mfma_f32_32x32x16_bf16 v[64:79], v[92:95], a[4:7], v[64:79]
ds_read_b128 v[116:119], v9 offset:384
s_waitcnt lgkmcnt(0)
v_fmac_f32 v108, v104, v144
v_mfma_f32_32x32x16_bf16 v[48:63], v[96:99], a[8:11], v[48:63]
ds_read_b128 v[88:91], v1 offset:4096
ds_read_b128 v[92:95], v1 offset:36864
v_fmac_f32 v109, v105, v144
v_fmac_f32 v110, v106, v144
v_fmac_f32 v111, v107, v144
v_mfma_f32_32x32x16_bf16 v[64:79], v[100:103], a[8:11], v[64:79]
v_fmac_f32 v108, v16, v146
v_fmac_f32 v109, v17, v146
v_fmac_f32 v110, v18, v146
buffer_load_dwordx4 v12, s[88:91], s9 offen sc1 lds
s_add_u32 m0, m0, s11
s_add_u32 s9, s9, s12
v_mfma_f32_32x32x16_bf16 v[48:63], v[80:83], a[12:15], v[48:63]
ds_read_b128 v[96:99], v1 offset:5120
ds_read_b128 v[100:103], v1 offset:37888
v_fmac_f32 v111, v19, v146
v_exp_f32 v108, v108
v_exp_f32 v109, v109
v_mfma_f32_32x32x16_bf16 v[64:79], v[84:87], a[12:15], v[64:79]
v_exp_f32 v110, v110
v_exp_f32 v111, v111
v_fmac_f32 v116, v112, v144
s_waitcnt lgkmcnt(2)
v_mfma_f32_32x32x16_bf16 v[48:63], v[88:91], a[16:19], v[48:63]
ds_read_b128 v[80:83], v1 offset:6144
ds_read_b128 v[84:87], v1 offset:38912
v_fmac_f32 v117, v113, v144
v_fmac_f32 v118, v114, v144
v_fmac_f32 v119, v115, v144
v_mfma_f32_32x32x16_bf16 v[64:79], v[92:95], a[16:19], v[64:79]
v_add_f32 v108, 1.0, v108
v_add_f32 v109, 1.0, v109
v_add_f32 v110, 1.0, v110
buffer_load_dwordx4 v12, s[88:91], s9 offen sc1 lds
s_add_u32 m0, m0, s11
s_add_u32 s9, s9, s12
s_waitcnt lgkmcnt(2)
v_mfma_f32_32x32x16_bf16 v[48:63], v[96:99], a[20:23], v[48:63]
ds_read_b128 v[88:91], v1 offset:7168
ds_read_b128 v[92:95], v1 offset:39936
v_add_f32 v111, 1.0, v111
v_rcp_f32 v108, v108
v_rcp_f32 v109, v109
v_mfma_f32_32x32x16_bf16 v[64:79], v[100:103], a[20:23], v[64:79]
v_rcp_f32 v110, v110
v_rcp_f32 v111, v111
v_fmac_f32 v116, v32, v145
s_waitcnt lgkmcnt(2)
v_mfma_f32_32x32x16_bf16 v[48:63], v[80:83], a[24:27], v[48:63]
ds_read_b128 v[96:99], v1 offset:8192
ds_read_b128 v[100:103], v1 offset:40960
v_fmac_f32 v117, v33, v145
v_fmac_f32 v118, v34, v145
v_fmac_f32 v119, v35, v145
v_mfma_f32_32x32x16_bf16 v[64:79], v[84:87], a[24:27], v[64:79]
v_mul_f32 v116, v116, v108
v_mul_f32 v117, v117, v109
v_mul_f32 v118, v118, v110
buffer_load_dwordx4 v12, s[88:91], s9 offen sc1 lds
s_add_u32 m0, m0, s11
s_add_u32 s9, s9, s12
s_waitcnt lgkmcnt(2)
v_mfma_f32_32x32x16_bf16 v[48:63], v[88:91], a[28:31], v[48:63]
ds_read_b128 v[80:83], v1 offset:9216
ds_read_b128 v[84:87], v1 offset:41984
v_mul_f32 v119, v119, v111
v_cvt_pk_bf16_f32 v136, v116, v117
v_cvt_pk_bf16_f32 v137, v118, v119
v_mfma_f32_32x32x16_bf16 v[64:79], v[92:95], a[28:31], v[64:79]
ds_read_b128 v[104:107], v9 offset:32
ds_read_b128 v[108:111], v9 offset:160
ds_read_b128 v[112:115], v9 offset:288
s_waitcnt lgkmcnt(5)
v_mfma_f32_32x32x16_bf16 v[48:63], v[96:99], a[32:35], v[48:63]
ds_read_b128 v[88:91], v1 offset:10240
ds_read_b128 v[92:95], v1 offset:43008
ds_read_b128 v[116:119], v9 offset:416
s_waitcnt lgkmcnt(0)
v_fmac_f32 v108, v104, v144
v_mfma_f32_32x32x16_bf16 v[64:79], v[100:103], a[32:35], v[64:79]
v_fmac_f32 v109, v105, v144
v_fmac_f32 v110, v106, v144
v_fmac_f32 v111, v107, v144
buffer_load_dwordx4 v12, s[88:91], s9 offen sc1 lds
s_add_u32 m0, m0, s11
s_add_u32 s9, s9, s12
v_mfma_f32_32x32x16_bf16 v[48:63], v[80:83], a[36:39], v[48:63]
ds_read_b128 v[96:99], v1 offset:11264
ds_read_b128 v[100:103], v1 offset:44032
v_fmac_f32 v108, v20, v146
v_fmac_f32 v109, v21, v146
v_fmac_f32 v110, v22, v146
v_mfma_f32_32x32x16_bf16 v[64:79], v[84:87], a[36:39], v[64:79]
v_fmac_f32 v111, v23, v146
v_exp_f32 v108, v108
v_exp_f32 v109, v109
v_mfma_f32_32x32x16_bf16 v[48:63], v[88:91], a[40:43], v[48:63]
ds_read_b128 v[80:83], v1 offset:12288
ds_read_b128 v[84:87], v1 offset:45056
v_exp_f32 v110, v110
v_exp_f32 v111, v111
v_fmac_f32 v116, v112, v144
v_mfma_f32_32x32x16_bf16 v[64:79], v[92:95], a[40:43], v[64:79]
v_fmac_f32 v117, v113, v144
v_fmac_f32 v118, v114, v144
v_fmac_f32 v119, v115, v144
buffer_load_dwordx4 v12, s[88:91], s9 offen sc1 lds
s_add_u32 m0, m0, s11
s_add_u32 s9, s9, s12
s_waitcnt lgkmcnt(2)
v_mfma_f32_32x32x16_bf16 v[48:63], v[96:99], a[44:47], v[48:63]
ds_read_b128 v[88:91], v1 offset:13312
ds_read_b128 v[92:95], v1 offset:46080
v_add_f32 v108, 1.0, v108
v_add_f32 v109, 1.0, v109
v_add_f32 v110, 1.0, v110
v_mfma_f32_32x32x16_bf16 v[64:79], v[100:103], a[44:47], v[64:79]
v_add_f32 v111, 1.0, v111
v_rcp_f32 v108, v108
v_rcp_f32 v109, v109
s_waitcnt lgkmcnt(2)
v_mfma_f32_32x32x16_bf16 v[48:63], v[80:83], a[48:51], v[48:63]
ds_read_b128 v[96:99], v1 offset:14336
ds_read_b128 v[100:103], v1 offset:47104
v_rcp_f32 v110, v110
v_rcp_f32 v111, v111
v_fmac_f32 v116, v36, v145
v_mfma_f32_32x32x16_bf16 v[64:79], v[84:87], a[48:51], v[64:79]
v_fmac_f32 v117, v37, v145
v_fmac_f32 v118, v38, v145
v_fmac_f32 v119, v39, v145
buffer_load_dwordx4 v12, s[88:91], s9 offen sc1 lds
s_add_u32 m0, m0, s11
s_add_u32 s9, s9, s12
s_waitcnt lgkmcnt(2)
v_mfma_f32_32x32x16_bf16 v[48:63], v[88:91], a[52:55], v[48:63]
ds_read_b128 v[80:83], v1 offset:15360
ds_read_b128 v[84:87], v1 offset:48128
v_mul_f32 v116, v116, v108
v_mul_f32 v117, v117, v109
v_mul_f32 v118, v118, v110
v_mfma_f32_32x32x16_bf16 v[64:79], v[92:95], a[52:55], v[64:79]
v_mul_f32 v119, v119, v111
v_cvt_pk_bf16_f32 v138, v116, v117
v_cvt_pk_bf16_f32 v139, v118, v119
s_waitcnt lgkmcnt(2)
v_mfma_f32_32x32x16_bf16 v[48:63], v[96:99], a[56:59], v[48:63]
ds_read_b128 v[88:91], v1 offset:16384
ds_read_b128 v[92:95], v1 offset:49152
buffer_store_dwordx4 v[136:139], v1, s[84:87], s97 offen offset:0 sc1
ds_read_b128 v[104:107], v9 offset:64
ds_read_b128 v[108:111], v9 offset:192
v_mfma_f32_32x32x16_bf16 v[64:79], v[100:103], a[56:59], v[64:79]
ds_read_b128 v[112:115], v9 offset:320
ds_read_b128 v[116:119], v9 offset:448
s_waitcnt lgkmcnt(0)
buffer_load_dwordx4 v12, s[88:91], s9 offen sc1 lds
s_add_u32 m0, m0, s11
s_add_u32 s9, s9, s12
v_mfma_f32_32x32x16_bf16 v[48:63], v[80:83], a[60:63], v[48:63]
ds_read_b128 v[96:99], v1 offset:17408
ds_read_b128 v[100:103], v1 offset:50176
v_fmac_f32 v108, v104, v144
v_fmac_f32 v109, v105, v144
v_fmac_f32 v110, v106, v144
v_mfma_f32_32x32x16_bf16 v[64:79], v[84:87], a[60:63], v[64:79]
v_fmac_f32 v111, v107, v144
v_fmac_f32 v108, v24, v146
v_fmac_f32 v109, v25, v146
v_mfma_f32_32x32x16_bf16 v[48:63], v[88:91], a[64:67], v[48:63]
ds_read_b128 v[80:83], v1 offset:18432
ds_read_b128 v[84:87], v1 offset:51200
v_fmac_f32 v110, v26, v146
v_fmac_f32 v111, v27, v146
v_exp_f32 v108, v108
v_mfma_f32_32x32x16_bf16 v[64:79], v[92:95], a[64:67], v[64:79]
v_exp_f32 v109, v109
v_exp_f32 v110, v110
v_exp_f32 v111, v111
buffer_load_dwordx4 v12, s[88:91], s9 offen sc1 lds
s_add_u32 m0, m0, s11
s_add_u32 s9, s9, s12
s_waitcnt lgkmcnt(2)
v_mfma_f32_32x32x16_bf16 v[48:63], v[96:99], a[68:71], v[48:63]
ds_read_b128 v[88:91], v1 offset:19456
ds_read_b128 v[92:95], v1 offset:52224
v_fmac_f32 v116, v112, v144
v_fmac_f32 v117, v113, v144
v_fmac_f32 v118, v114, v144
v_mfma_f32_32x32x16_bf16 v[64:79], v[100:103], a[68:71], v[64:79]
v_fmac_f32 v119, v115, v144
v_add_f32 v108, 1.0, v108
v_add_f32 v109, 1.0, v109
s_waitcnt lgkmcnt(2)
v_mfma_f32_32x32x16_bf16 v[48:63], v[80:83], a[72:75], v[48:63]
ds_read_b128 v[96:99], v1 offset:20480
ds_read_b128 v[100:103], v1 offset:53248
v_add_f32 v110, 1.0, v110
v_add_f32 v111, 1.0, v111
v_rcp_f32 v108, v108
v_mfma_f32_32x32x16_bf16 v[64:79], v[84:87], a[72:75], v[64:79]
v_rcp_f32 v109, v109
v_rcp_f32 v110, v110
v_rcp_f32 v111, v111
buffer_load_dwordx4 v12, s[88:91], s9 offen sc1 lds
s_add_u32 m0, m0, s11
s_add_u32 s9, s9, s12
s_waitcnt lgkmcnt(2)
v_mfma_f32_32x32x16_bf16 v[48:63], v[88:91], a[76:79], v[48:63]
ds_read_b128 v[80:83], v1 offset:21504
ds_read_b128 v[84:87], v1 offset:54272
v_fmac_f32 v116, v40, v145
v_fmac_f32 v117, v41, v145
v_fmac_f32 v118, v42, v145
v_mfma_f32_32x32x16_bf16 v[64:79], v[92:95], a[76:79], v[64:79]
v_fmac_f32 v119, v43, v145
v_mul_f32 v116, v116, v108
v_mul_f32 v117, v117, v109
s_waitcnt lgkmcnt(2)
v_mfma_f32_32x32x16_bf16 v[48:63], v[96:99], a[80:83], v[48:63]
ds_read_b128 v[88:91], v1 offset:22528
ds_read_b128 v[92:95], v1 offset:55296
v_mul_f32 v118, v118, v110
v_mul_f32 v119, v119, v111
v_cvt_pk_bf16_f32 v140, v116, v117
v_mfma_f32_32x32x16_bf16 v[64:79], v[100:103], a[80:83], v[64:79]
v_cvt_pk_bf16_f32 v141, v118, v119
ds_read_b128 v[104:107], v9 offset:96
ds_read_b128 v[108:111], v9 offset:224
buffer_load_dwordx4 v12, s[88:91], s9 offen sc1 lds
s_add_u32 m0, m0, s11
s_add_u32 s9, s9, s12
s_waitcnt lgkmcnt(4)
v_mfma_f32_32x32x16_bf16 v[48:63], v[80:83], a[84:87], v[48:63]
ds_read_b128 v[96:99], v1 offset:23552
ds_read_b128 v[100:103], v1 offset:56320
ds_read_b128 v[112:115], v9 offset:352
ds_read_b128 v[116:119], v9 offset:480
s_waitcnt lgkmcnt(0)
v_mfma_f32_32x32x16_bf16 v[64:79], v[84:87], a[84:87], v[64:79]
v_fmac_f32 v108, v104, v144
v_fmac_f32 v109, v105, v144
v_fmac_f32 v110, v106, v144
v_mfma_f32_32x32x16_bf16 v[48:63], v[88:91], a[88:91], v[48:63]
ds_read_b128 v[80:83], v1 offset:24576
ds_read_b128 v[84:87], v1 offset:57344
v_fmac_f32 v111, v107, v144
v_fmac_f32 v108, v28, v146
v_fmac_f32 v109, v29, v146
v_mfma_f32_32x32x16_bf16 v[64:79], v[92:95], a[88:91], v[64:79]
v_fmac_f32 v110, v30, v146
v_fmac_f32 v111, v31, v146
v_exp_f32 v108, v108
buffer_load_dwordx4 v12, s[88:91], s9 offen sc1 lds
s_add_u32 m0, m0, s11
s_add_u32 s9, s9, s12
v_mfma_f32_32x32x16_bf16 v[48:63], v[96:99], a[92:95], v[48:63]
ds_read_b128 v[88:91], v1 offset:25600
ds_read_b128 v[92:95], v1 offset:58368
v_exp_f32 v109, v109
v_exp_f32 v110, v110
v_exp_f32 v111, v111
v_mfma_f32_32x32x16_bf16 v[64:79], v[100:103], a[92:95], v[64:79]
v_fmac_f32 v116, v112, v144
v_fmac_f32 v117, v113, v144
v_fmac_f32 v118, v114, v144
s_waitcnt lgkmcnt(2)
v_mfma_f32_32x32x16_bf16 v[48:63], v[80:83], a[96:99], v[48:63]
ds_read_b128 v[96:99], v1 offset:26624
ds_read_b128 v[100:103], v1 offset:59392
v_fmac_f32 v119, v115, v144
v_add_f32 v108, 1.0, v108
v_add_f32 v109, 1.0, v109
v_mfma_f32_32x32x16_bf16 v[64:79], v[84:87], a[96:99], v[64:79]
v_add_f32 v110, 1.0, v110
v_add_f32 v111, 1.0, v111
v_rcp_f32 v108, v108
buffer_load_dwordx4 v12, s[88:91], s9 offen sc1 lds
s_add_u32 m0, m0, s11
s_add_u32 s9, s9, s12
s_waitcnt lgkmcnt(2)
v_mfma_f32_32x32x16_bf16 v[48:63], v[88:91], a[100:103], v[48:63]
ds_read_b128 v[80:83], v1 offset:27648
ds_read_b128 v[84:87], v1 offset:60416
v_rcp_f32 v109, v109
v_rcp_f32 v110, v110
v_rcp_f32 v111, v111
v_mfma_f32_32x32x16_bf16 v[64:79], v[92:95], a[100:103], v[64:79]
v_fmac_f32 v116, v44, v145
v_fmac_f32 v117, v45, v145
v_fmac_f32 v118, v46, v145
s_waitcnt lgkmcnt(2)
v_mfma_f32_32x32x16_bf16 v[48:63], v[96:99], a[104:107], v[48:63]
ds_read_b128 v[88:91], v1 offset:28672
ds_read_b128 v[92:95], v1 offset:61440
v_fmac_f32 v119, v47, v145
v_mul_f32 v116, v116, v108
v_mul_f32 v117, v117, v109
v_mfma_f32_32x32x16_bf16 v[64:79], v[100:103], a[104:107], v[64:79]
v_mul_f32 v118, v118, v110
v_mul_f32 v119, v119, v111
v_cvt_pk_bf16_f32 v142, v116, v117
buffer_load_dwordx4 v12, s[88:91], s9 offen sc1 lds
s_add_u32 m0, m0, s11
s_add_u32 s9, s9, s12
s_waitcnt lgkmcnt(2)
v_mfma_f32_32x32x16_bf16 v[48:63], v[80:83], a[108:111], v[48:63]
ds_read_b128 v[96:99], v1 offset:29696
ds_read_b128 v[100:103], v1 offset:62464
v_cvt_pk_bf16_f32 v143, v118, v119
buffer_store_dwordx4 v[140:143], v1, s[84:87], s97 offen offset:1024 sc1
v_mfma_f32_32x32x16_bf16 v[64:79], v[84:87], a[108:111], v[64:79]
s_waitcnt lgkmcnt(2)
v_mfma_f32_32x32x16_bf16 v[48:63], v[88:91], a[112:115], v[48:63]
ds_read_b128 v[80:83], v1 offset:30720
ds_read_b128 v[84:87], v1 offset:63488
v_mfma_f32_32x32x16_bf16 v[64:79], v[92:95], a[112:115], v[64:79]
buffer_load_dwordx4 v12, s[88:91], s9 offen sc1 lds
s_add_u32 m0, m0, s11
s_add_u32 s9, s9, s12
s_waitcnt lgkmcnt(2)
v_mfma_f32_32x32x16_bf16 v[48:63], v[96:99], a[116:119], v[48:63]
ds_read_b128 v[88:91], v1 offset:31744
ds_read_b128 v[92:95], v1 offset:64512
v_mfma_f32_32x32x16_bf16 v[64:79], v[100:103], a[116:119], v[64:79]
s_waitcnt lgkmcnt(2)
v_mfma_f32_32x32x16_bf16 v[48:63], v[80:83], a[120:123], v[48:63]
v_mfma_f32_32x32x16_bf16 v[64:79], v[84:87], a[120:123], v[64:79]
buffer_load_dwordx4 v12, s[88:91], s9 offen sc1 lds
s_add_u32 m0, m0, s11
s_add_u32 s9, s9, s12
s_waitcnt lgkmcnt(0)
v_mfma_f32_32x32x16_bf16 v[48:63], v[88:91], a[124:127], v[48:63]
v_mfma_f32_32x32x16_bf16 v[64:79], v[92:95], a[124:127], v[64:79]
s_mov_b32 s8, 0
s_waitcnt vmcnt(0)
s_waitcnt lgkmcnt(0)
s_barrier
s_mov_b32 s88, s68
s_mov_b32 s89, s69
s_mov_b32 s90, s70
s_mov_b32 s91, 0x20000
s_lshr_b32 s4, s43, 1
s_and_b32 s5, s43, 1
s_mul_i32 s9, s4, 704512
s_lshl_b32 s7, s5, 13
s_add_u32 s9, s9, s7
s_and_b32 s7, s3, 7
s_lshl_b32 s7, s7, 7
s_add_u32 s9, s9, s7
s_add_u32 s9, s9, 0
s_mul_i32 s4, s4, 32768
s_lshl_b32 s5, s5, 10
s_add_u32 s4, s4, s5
s_add_u32 s10, s4, 0
s_mov_b32 s8, 16
s_mov_b32 s11, 2048
s_mov_b32 s12, 16384
v_lshrrev_b32 v12, 3, v0
v_and_b32 v15, 2, v12
v_lshlrev_b32 v15, 1, v15
v_xor_b32 v15, v15, v0
v_and_b32 v15, 7, v15
v_lshlrev_b32 v12, 10, v12
v_lshl_add_u32 v12, v15, 4, v12
ds_read_b128 v[80:83], v10 offset:0
ds_read_b128 v[84:87], v10 offset:32768
ds_read_b128 v[88:91], v10 offset:1024
ds_read_b128 v[92:95], v10 offset:33792
s_mov_b32 m0, s10
s_waitcnt lgkmcnt(2)
v_mfma_f32_32x32x16_bf16 v[16:31], v[80:83], a[0:3], 0
ds_read_b128 v[96:99], v10 offset:2048
ds_read_b128 v[100:103], v10 offset:34816
v_mfma_f32_32x32x16_bf16 v[32:47], v[84:87], a[0:3], 0
buffer_load_dwordx4 v12, s[88:91], s9 offen sc1 lds
s_add_u32 m0, m0, s11
s_add_u32 s9, s9, s12
s_waitcnt lgkmcnt(2)
v_mfma_f32_32x32x16_bf16 v[16:31], v[88:91], a[4:7], v[16:31]
ds_read_b128 v[80:83], v10 offset:3072
ds_read_b128 v[84:87], v10 offset:35840
ds_read_b128 v[104:107], v9 offset:512
ds_read_b128 v[108:111], v9 offset:640
ds_read_b128 v[112:115], v9 offset:768
v_mfma_f32_32x32x16_bf16 v[32:47], v[92:95], a[4:7], v[32:47]
ds_read_b128 v[116:119], v9 offset:896
s_waitcnt lgkmcnt(0)
v_fmac_f32 v108, v104, v144
v_mfma_f32_32x32x16_bf16 v[16:31], v[96:99], a[8:11], v[16:31]
ds_read_b128 v[88:91], v10 offset:4096
ds_read_b128 v[92:95], v10 offset:36864
v_fmac_f32 v109, v105, v144
v_fmac_f32 v110, v106, v144
v_fmac_f32 v111, v107, v144
v_mfma_f32_32x32x16_bf16 v[32:47], v[100:103], a[8:11], v[32:47]
v_fmac_f32 v108, v48, v146
v_fmac_f32 v109, v49, v146
v_fmac_f32 v110, v50, v146
buffer_load_dwordx4 v12, s[88:91], s9 offen sc1 lds
s_add_u32 m0, m0, s11
s_add_u32 s9, s9, s12
v_mfma_f32_32x32x16_bf16 v[16:31], v[80:83], a[12:15], v[16:31]
ds_read_b128 v[96:99], v10 offset:5120
ds_read_b128 v[100:103], v10 offset:37888
v_fmac_f32 v111, v51, v146
v_exp_f32 v108, v108
v_exp_f32 v109, v109
v_mfma_f32_32x32x16_bf16 v[32:47], v[84:87], a[12:15], v[32:47]
v_exp_f32 v110, v110
v_exp_f32 v111, v111
v_fmac_f32 v116, v112, v144
s_waitcnt lgkmcnt(2)
v_mfma_f32_32x32x16_bf16 v[16:31], v[88:91], a[16:19], v[16:31]
ds_read_b128 v[80:83], v10 offset:6144
ds_read_b128 v[84:87], v10 offset:38912
v_fmac_f32 v117, v113, v144
v_fmac_f32 v118, v114, v144
v_fmac_f32 v119, v115, v144
v_mfma_f32_32x32x16_bf16 v[32:47], v[92:95], a[16:19], v[32:47]
v_add_f32 v108, 1.0, v108
v_add_f32 v109, 1.0, v109
v_add_f32 v110, 1.0, v110
buffer_load_dwordx4 v12, s[88:91], s9 offen sc1 lds
s_add_u32 m0, m0, s11
s_add_u32 s9, s9, s12
s_waitcnt lgkmcnt(2)
v_mfma_f32_32x32x16_bf16 v[16:31], v[96:99], a[20:23], v[16:31]
ds_read_b128 v[88:91], v10 offset:7168
ds_read_b128 v[92:95], v10 offset:39936
v_add_f32 v111, 1.0, v111
v_rcp_f32 v108, v108
v_rcp_f32 v109, v109
v_mfma_f32_32x32x16_bf16 v[32:47], v[100:103], a[20:23], v[32:47]
v_rcp_f32 v110, v110
v_rcp_f32 v111, v111
v_fmac_f32 v116, v64, v145
s_waitcnt lgkmcnt(2)
v_mfma_f32_32x32x16_bf16 v[16:31], v[80:83], a[24:27], v[16:31]
ds_read_b128 v[96:99], v10 offset:8192
ds_read_b128 v[100:103], v10 offset:40960
v_fmac_f32 v117, v65, v145
v_fmac_f32 v118, v66, v145
v_fmac_f32 v119, v67, v145
v_mfma_f32_32x32x16_bf16 v[32:47], v[84:87], a[24:27], v[32:47]
v_mul_f32 v116, v116, v108
v_mul_f32 v117, v117, v109
v_mul_f32 v118, v118, v110
buffer_load_dwordx4 v12, s[88:91], s9 offen sc1 lds
s_add_u32 m0, m0, s11
s_add_u32 s9, s9, s12
s_waitcnt lgkmcnt(2)
v_mfma_f32_32x32x16_bf16 v[16:31], v[88:91], a[28:31], v[16:31]
ds_read_b128 v[80:83], v10 offset:9216
ds_read_b128 v[84:87], v10 offset:41984
v_mul_f32 v119, v119, v111
v_cvt_pk_bf16_f32 v136, v116, v117
v_cvt_pk_bf16_f32 v137, v118, v119
v_mfma_f32_32x32x16_bf16 v[32:47], v[92:95], a[28:31], v[32:47]
ds_read_b128 v[104:107], v9 offset:544
ds_read_b128 v[108:111], v9 offset:672
ds_read_b128 v[112:115], v9 offset:800
s_waitcnt lgkmcnt(5)
v_mfma_f32_32x32x16_bf16 v[16:31], v[96:99], a[32:35], v[16:31]
ds_read_b128 v[88:91], v10 offset:10240
ds_read_b128 v[92:95], v10 offset:43008
ds_read_b128 v[116:119], v9 offset:928
s_waitcnt lgkmcnt(0)
v_fmac_f32 v108, v104, v144
v_mfma_f32_32x32x16_bf16 v[32:47], v[100:103], a[32:35], v[32:47]
v_fmac_f32 v109, v105, v144
v_fmac_f32 v110, v106, v144
v_fmac_f32 v111, v107, v144
buffer_load_dwordx4 v12, s[88:91], s9 offen sc1 lds
s_add_u32 m0, m0, s11
s_add_u32 s9, s9, s12
v_mfma_f32_32x32x16_bf16 v[16:31], v[80:83], a[36:39], v[16:31]
ds_read_b128 v[96:99], v10 offset:11264
ds_read_b128 v[100:103], v10 offset:44032
v_fmac_f32 v108, v52, v146
v_fmac_f32 v109, v53, v146
v_fmac_f32 v110, v54, v146
v_mfma_f32_32x32x16_bf16 v[32:47], v[84:87], a[36:39], v[32:47]
v_fmac_f32 v111, v55, v146
v_exp_f32 v108, v108
v_exp_f32 v109, v109
v_mfma_f32_32x32x16_bf16 v[16:31], v[88:91], a[40:43], v[16:31]
ds_read_b128 v[80:83], v10 offset:12288
ds_read_b128 v[84:87], v10 offset:45056
v_exp_f32 v110, v110
v_exp_f32 v111, v111
v_fmac_f32 v116, v112, v144
v_mfma_f32_32x32x16_bf16 v[32:47], v[92:95], a[40:43], v[32:47]
v_fmac_f32 v117, v113, v144
v_fmac_f32 v118, v114, v144
v_fmac_f32 v119, v115, v144
buffer_load_dwordx4 v12, s[88:91], s9 offen sc1 lds
s_add_u32 m0, m0, s11
s_add_u32 s9, s9, s12
s_waitcnt lgkmcnt(2)
v_mfma_f32_32x32x16_bf16 v[16:31], v[96:99], a[44:47], v[16:31]
ds_read_b128 v[88:91], v10 offset:13312
ds_read_b128 v[92:95], v10 offset:46080
v_add_f32 v108, 1.0, v108
v_add_f32 v109, 1.0, v109
v_add_f32 v110, 1.0, v110
v_mfma_f32_32x32x16_bf16 v[32:47], v[100:103], a[44:47], v[32:47]
v_add_f32 v111, 1.0, v111
v_rcp_f32 v108, v108
v_rcp_f32 v109, v109
s_waitcnt lgkmcnt(2)
v_mfma_f32_32x32x16_bf16 v[16:31], v[80:83], a[48:51], v[16:31]
ds_read_b128 v[96:99], v10 offset:14336
ds_read_b128 v[100:103], v10 offset:47104
v_rcp_f32 v110, v110
v_rcp_f32 v111, v111
v_fmac_f32 v116, v68, v145
v_mfma_f32_32x32x16_bf16 v[32:47], v[84:87], a[48:51], v[32:47]
v_fmac_f32 v117, v69, v145
v_fmac_f32 v118, v70, v145
v_fmac_f32 v119, v71, v145
buffer_load_dwordx4 v12, s[88:91], s9 offen sc1 lds
s_add_u32 m0, m0, s11
s_add_u32 s9, s9, s12
s_waitcnt lgkmcnt(2)
v_mfma_f32_32x32x16_bf16 v[16:31], v[88:91], a[52:55], v[16:31]
ds_read_b128 v[80:83], v10 offset:15360
ds_read_b128 v[84:87], v10 offset:48128
v_mul_f32 v116, v116, v108
v_mul_f32 v117, v117, v109
v_mul_f32 v118, v118, v110
v_mfma_f32_32x32x16_bf16 v[32:47], v[92:95], a[52:55], v[32:47]
v_mul_f32 v119, v119, v111
v_cvt_pk_bf16_f32 v138, v116, v117
v_cvt_pk_bf16_f32 v139, v118, v119
s_waitcnt lgkmcnt(2)
v_mfma_f32_32x32x16_bf16 v[16:31], v[96:99], a[56:59], v[16:31]
ds_read_b128 v[88:91], v10 offset:16384
ds_read_b128 v[92:95], v10 offset:49152
buffer_store_dwordx4 v[136:139], v1, s[84:87], s97 offen offset:2048 sc1
ds_read_b128 v[104:107], v9 offset:576
ds_read_b128 v[108:111], v9 offset:704
v_mfma_f32_32x32x16_bf16 v[32:47], v[100:103], a[56:59], v[32:47]
ds_read_b128 v[112:115], v9 offset:832
ds_read_b128 v[116:119], v9 offset:960
s_waitcnt lgkmcnt(0)
buffer_load_dwordx4 v12, s[88:91], s9 offen sc1 lds
s_add_u32 m0, m0, s11
s_add_u32 s9, s9, s12
v_mfma_f32_32x32x16_bf16 v[16:31], v[80:83], a[60:63], v[16:31]
ds_read_b128 v[96:99], v10 offset:17408
ds_read_b128 v[100:103], v10 offset:50176
v_fmac_f32 v108, v104, v144
v_fmac_f32 v109, v105, v144
v_fmac_f32 v110, v106, v144
v_mfma_f32_32x32x16_bf16 v[32:47], v[84:87], a[60:63], v[32:47]
v_fmac_f32 v111, v107, v144
v_fmac_f32 v108, v56, v146
v_fmac_f32 v109, v57, v146
v_mfma_f32_32x32x16_bf16 v[16:31], v[88:91], a[64:67], v[16:31]
ds_read_b128 v[80:83], v10 offset:18432
ds_read_b128 v[84:87], v10 offset:51200
v_fmac_f32 v110, v58, v146
v_fmac_f32 v111, v59, v146
v_exp_f32 v108, v108
v_mfma_f32_32x32x16_bf16 v[32:47], v[92:95], a[64:67], v[32:47]
v_exp_f32 v109, v109
v_exp_f32 v110, v110
v_exp_f32 v111, v111
buffer_load_dwordx4 v12, s[88:91], s9 offen sc1 lds
s_add_u32 m0, m0, s11
s_add_u32 s9, s9, s12
s_waitcnt lgkmcnt(2)
v_mfma_f32_32x32x16_bf16 v[16:31], v[96:99], a[68:71], v[16:31]
ds_read_b128 v[88:91], v10 offset:19456
ds_read_b128 v[92:95], v10 offset:52224
v_fmac_f32 v116, v112, v144
v_fmac_f32 v117, v113, v144
v_fmac_f32 v118, v114, v144
v_mfma_f32_32x32x16_bf16 v[32:47], v[100:103], a[68:71], v[32:47]
v_fmac_f32 v119, v115, v144
v_add_f32 v108, 1.0, v108
v_add_f32 v109, 1.0, v109
s_waitcnt lgkmcnt(2)
v_mfma_f32_32x32x16_bf16 v[16:31], v[80:83], a[72:75], v[16:31]
ds_read_b128 v[96:99], v10 offset:20480
ds_read_b128 v[100:103], v10 offset:53248
v_add_f32 v110, 1.0, v110
v_add_f32 v111, 1.0, v111
v_rcp_f32 v108, v108
v_mfma_f32_32x32x16_bf16 v[32:47], v[84:87], a[72:75], v[32:47]
v_rcp_f32 v109, v109
v_rcp_f32 v110, v110
v_rcp_f32 v111, v111
buffer_load_dwordx4 v12, s[88:91], s9 offen sc1 lds
s_add_u32 m0, m0, s11
s_add_u32 s9, s9, s12
s_waitcnt lgkmcnt(2)
v_mfma_f32_32x32x16_bf16 v[16:31], v[88:91], a[76:79], v[16:31]
ds_read_b128 v[80:83], v10 offset:21504
ds_read_b128 v[84:87], v10 offset:54272
v_fmac_f32 v116, v72, v145
v_fmac_f32 v117, v73, v145
v_fmac_f32 v118, v74, v145
v_mfma_f32_32x32x16_bf16 v[32:47], v[92:95], a[76:79], v[32:47]
v_fmac_f32 v119, v75, v145
v_mul_f32 v116, v116, v108
v_mul_f32 v117, v117, v109
s_waitcnt lgkmcnt(2)
v_mfma_f32_32x32x16_bf16 v[16:31], v[96:99], a[80:83], v[16:31]
ds_read_b128 v[88:91], v10 offset:22528
ds_read_b128 v[92:95], v10 offset:55296
v_mul_f32 v118, v118, v110
v_mul_f32 v119, v119, v111
v_cvt_pk_bf16_f32 v140, v116, v117
v_mfma_f32_32x32x16_bf16 v[32:47], v[100:103], a[80:83], v[32:47]
v_cvt_pk_bf16_f32 v141, v118, v119
ds_read_b128 v[104:107], v9 offset:608
ds_read_b128 v[108:111], v9 offset:736
buffer_load_dwordx4 v12, s[88:91], s9 offen sc1 lds
s_add_u32 m0, m0, s11
s_add_u32 s9, s9, s12
s_waitcnt lgkmcnt(4)
v_mfma_f32_32x32x16_bf16 v[16:31], v[80:83], a[84:87], v[16:31]
ds_read_b128 v[96:99], v10 offset:23552
ds_read_b128 v[100:103], v10 offset:56320
ds_read_b128 v[112:115], v9 offset:864
ds_read_b128 v[116:119], v9 offset:992
s_waitcnt lgkmcnt(0)
v_mfma_f32_32x32x16_bf16 v[32:47], v[84:87], a[84:87], v[32:47]
v_fmac_f32 v108, v104, v144
v_fmac_f32 v109, v105, v144
v_fmac_f32 v110, v106, v144
v_mfma_f32_32x32x16_bf16 v[16:31], v[88:91], a[88:91], v[16:31]
ds_read_b128 v[80:83], v10 offset:24576
ds_read_b128 v[84:87], v10 offset:57344
v_fmac_f32 v111, v107, v144
v_fmac_f32 v108, v60, v146
v_fmac_f32 v109, v61, v146
v_mfma_f32_32x32x16_bf16 v[32:47], v[92:95], a[88:91], v[32:47]
v_fmac_f32 v110, v62, v146
v_fmac_f32 v111, v63, v146
v_exp_f32 v108, v108
buffer_load_dwordx4 v12, s[88:91], s9 offen sc1 lds
s_add_u32 m0, m0, s11
s_add_u32 s9, s9, s12
v_mfma_f32_32x32x16_bf16 v[16:31], v[96:99], a[92:95], v[16:31]
ds_read_b128 v[88:91], v10 offset:25600
ds_read_b128 v[92:95], v10 offset:58368
v_exp_f32 v109, v109
v_exp_f32 v110, v110
v_exp_f32 v111, v111
v_mfma_f32_32x32x16_bf16 v[32:47], v[100:103], a[92:95], v[32:47]
v_fmac_f32 v116, v112, v144
v_fmac_f32 v117, v113, v144
v_fmac_f32 v118, v114, v144
s_waitcnt lgkmcnt(2)
v_mfma_f32_32x32x16_bf16 v[16:31], v[80:83], a[96:99], v[16:31]
ds_read_b128 v[96:99], v10 offset:26624
ds_read_b128 v[100:103], v10 offset:59392
v_fmac_f32 v119, v115, v144
v_add_f32 v108, 1.0, v108
v_add_f32 v109, 1.0, v109
v_mfma_f32_32x32x16_bf16 v[32:47], v[84:87], a[96:99], v[32:47]
v_add_f32 v110, 1.0, v110
v_add_f32 v111, 1.0, v111
v_rcp_f32 v108, v108
buffer_load_dwordx4 v12, s[88:91], s9 offen sc1 lds
s_add_u32 m0, m0, s11
s_add_u32 s9, s9, s12
s_waitcnt lgkmcnt(2)
v_mfma_f32_32x32x16_bf16 v[16:31], v[88:91], a[100:103], v[16:31]
ds_read_b128 v[80:83], v10 offset:27648
ds_read_b128 v[84:87], v10 offset:60416
v_rcp_f32 v109, v109
v_rcp_f32 v110, v110
v_rcp_f32 v111, v111
v_mfma_f32_32x32x16_bf16 v[32:47], v[92:95], a[100:103], v[32:47]
v_fmac_f32 v116, v76, v145
v_fmac_f32 v117, v77, v145
v_fmac_f32 v118, v78, v145
s_waitcnt lgkmcnt(2)
v_mfma_f32_32x32x16_bf16 v[16:31], v[96:99], a[104:107], v[16:31]
ds_read_b128 v[88:91], v10 offset:28672
ds_read_b128 v[92:95], v10 offset:61440
v_fmac_f32 v119, v79, v145
v_mul_f32 v116, v116, v108
v_mul_f32 v117, v117, v109
v_mfma_f32_32x32x16_bf16 v[32:47], v[100:103], a[104:107], v[32:47]
v_mul_f32 v118, v118, v110
v_mul_f32 v119, v119, v111
v_cvt_pk_bf16_f32 v142, v116, v117
buffer_load_dwordx4 v12, s[88:91], s9 offen sc1 lds
s_add_u32 m0, m0, s11
s_add_u32 s9, s9, s12
s_waitcnt lgkmcnt(2)
v_mfma_f32_32x32x16_bf16 v[16:31], v[80:83], a[108:111], v[16:31]
ds_read_b128 v[96:99], v10 offset:29696
ds_read_b128 v[100:103], v10 offset:62464
v_cvt_pk_bf16_f32 v143, v118, v119
buffer_store_dwordx4 v[140:143], v1, s[84:87], s97 offen offset:3072 sc1
v_mfma_f32_32x32x16_bf16 v[32:47], v[84:87], a[108:111], v[32:47]
s_waitcnt lgkmcnt(2)
v_mfma_f32_32x32x16_bf16 v[16:31], v[88:91], a[112:115], v[16:31]
ds_read_b128 v[80:83], v10 offset:30720
ds_read_b128 v[84:87], v10 offset:63488
v_mfma_f32_32x32x16_bf16 v[32:47], v[92:95], a[112:115], v[32:47]
buffer_load_dwordx4 v12, s[88:91], s9 offen sc1 lds
s_add_u32 m0, m0, s11
s_add_u32 s9, s9, s12
s_waitcnt lgkmcnt(2)
v_mfma_f32_32x32x16_bf16 v[16:31], v[96:99], a[116:119], v[16:31]
ds_read_b128 v[88:91], v10 offset:31744
ds_read_b128 v[92:95], v10 offset:64512
v_mfma_f32_32x32x16_bf16 v[32:47], v[100:103], a[116:119], v[32:47]
s_waitcnt lgkmcnt(2)
v_mfma_f32_32x32x16_bf16 v[16:31], v[80:83], a[120:123], v[16:31]
v_mfma_f32_32x32x16_bf16 v[32:47], v[84:87], a[120:123], v[32:47]
buffer_load_dwordx4 v12, s[88:91], s9 offen sc1 lds
s_add_u32 m0, m0, s11
s_add_u32 s9, s9, s12
s_waitcnt lgkmcnt(0)
v_mfma_f32_32x32x16_bf16 v[16:31], v[88:91], a[124:127], v[16:31]
v_mfma_f32_32x32x16_bf16 v[32:47], v[92:95], a[124:127], v[32:47]
s_mov_b32 s8, 0
s_waitcnt vmcnt(0)
s_waitcnt lgkmcnt(0)
s_barrier
s_mov_b32 s88, s68
s_mov_b32 s89, s69
s_mov_b32 s90, s70
s_mov_b32 s91, 0x20000
s_lshr_b32 s4, s43, 1
s_and_b32 s5, s43, 1
s_mul_i32 s9, s4, 704512
s_lshl_b32 s7, s5, 13
s_add_u32 s9, s9, s7
s_and_b32 s7, s3, 7
s_lshl_b32 s7, s7, 7
s_add_u32 s9, s9, s7
s_add_u32 s9, s9, 262144
s_mul_i32 s4, s4, 32768
s_lshl_b32 s5, s5, 10
s_add_u32 s4, s4, s5
s_add_u32 s10, s4, 65536
s_mov_b32 s8, 16
s_mov_b32 s11, 2048
s_mov_b32 s12, 16384
v_lshrrev_b32 v12, 3, v0
v_and_b32 v15, 2, v12
v_lshlrev_b32 v15, 1, v15
v_xor_b32 v15, v15, v0
v_and_b32 v15, 7, v15
v_lshlrev_b32 v12, 10, v12
v_lshl_add_u32 v12, v15, 4, v12
s_lshl_b32 s4, s93, 15
v_add_u32 v8, s4, v13
v_xor_b32 v7, 64, v8
ds_read_b128 v[104:107], v9 offset:1024
ds_read_b128 v[108:111], v9 offset:1152
ds_read_b128 v[112:115], v9 offset:1280
ds_read_b128 v[116:119], v9 offset:1408
s_mov_b32 m0, s10
s_add_u32 s10, s10, s11
buffer_load_dwordx4 v12, s[88:91], s9 offen sc1 lds
s_add_u32 s9, s9, s12
s_sub_u32 s8, s8, 1
s_waitcnt lgkmcnt(0)
v_fmac_f32 v108, v104, v144
v_fmac_f32 v109, v105, v144
v_fmac_f32 v110, v106, v144
v_fmac_f32 v111, v107, v144
v_fmac_f32 v108, v16, v146
v_fmac_f32 v109, v17, v146
v_fmac_f32 v110, v18, v146
v_fmac_f32 v111, v19, v146
v_exp_f32 v108, v108
s_mov_b32 m0, s10
s_add_u32 s10, s10, s11
buffer_load_dwordx4 v12, s[88:91], s9 offen sc1 lds
s_add_u32 s9, s9, s12
s_sub_u32 s8, s8, 1
v_exp_f32 v109, v109
v_exp_f32 v110, v110
v_exp_f32 v111, v111
v_fmac_f32 v116, v112, v144
v_fmac_f32 v117, v113, v144
v_fmac_f32 v118, v114, v144
v_fmac_f32 v119, v115, v144
v_add_f32 v108, 1.0, v108
v_add_f32 v109, 1.0, v109
v_add_f32 v110, 1.0, v110
s_mov_b32 m0, s10
s_add_u32 s10, s10, s11
buffer_load_dwordx4 v12, s[88:91], s9 offen sc1 lds
s_add_u32 s9, s9, s12
s_sub_u32 s8, s8, 1
v_add_f32 v111, 1.0, v111
v_rcp_f32 v108, v108
v_rcp_f32 v109, v109
v_rcp_f32 v110, v110
v_rcp_f32 v111, v111
v_fmac_f32 v116, v32, v145
v_fmac_f32 v117, v33, v145
v_fmac_f32 v118, v34, v145
v_fmac_f32 v119, v35, v145
v_mul_f32 v116, v116, v108
s_mov_b32 m0, s10
s_add_u32 s10, s10, s11
buffer_load_dwordx4 v12, s[88:91], s9 offen sc1 lds
s_add_u32 s9, s9, s12
s_sub_u32 s8, s8, 1
v_mul_f32 v117, v117, v109
v_mul_f32 v118, v118, v110
v_mul_f32 v119, v119, v111
v_cvt_pk_bf16_f32 v136, v116, v117
v_cvt_pk_bf16_f32 v137, v118, v119
ds_read_b128 v[104:107], v9 offset:1056
ds_read_b128 v[108:111], v9 offset:1184
ds_read_b128 v[112:115], v9 offset:1312
ds_read_b128 v[116:119], v9 offset:1440
s_waitcnt lgkmcnt(0)
s_mov_b32 m0, s10
s_add_u32 s10, s10, s11
buffer_load_dwordx4 v12, s[88:91], s9 offen sc1 lds
s_add_u32 s9, s9, s12
s_sub_u32 s8, s8, 1
v_fmac_f32 v108, v104, v144
v_fmac_f32 v109, v105, v144
v_fmac_f32 v110, v106, v144
v_fmac_f32 v111, v107, v144
v_fmac_f32 v108, v20, v146
v_fmac_f32 v109, v21, v146
v_fmac_f32 v110, v22, v146
v_fmac_f32 v111, v23, v146
v_exp_f32 v108, v108
v_exp_f32 v109, v109
s_mov_b32 m0, s10
s_add_u32 s10, s10, s11
buffer_load_dwordx4 v12, s[88:91], s9 offen sc1 lds
s_add_u32 s9, s9, s12
s_sub_u32 s8, s8, 1
v_exp_f32 v110, v110
v_exp_f32 v111, v111
v_fmac_f32 v116, v112, v144
v_fmac_f32 v117, v113, v144
v_fmac_f32 v118, v114, v144
v_fmac_f32 v119, v115, v144
v_add_f32 v108, 1.0, v108
v_add_f32 v109, 1.0, v109
v_add_f32 v110, 1.0, v110
v_add_f32 v111, 1.0, v111
s_mov_b32 m0, s10
s_add_u32 s10, s10, s11
buffer_load_dwordx4 v12, s[88:91], s9 offen sc1 lds
s_add_u32 s9, s9, s12
s_sub_u32 s8, s8, 1
v_rcp_f32 v108, v108
v_rcp_f32 v109, v109
v_rcp_f32 v110, v110
v_rcp_f32 v111, v111
v_fmac_f32 v116, v36, v145
v_fmac_f32 v117, v37, v145
v_fmac_f32 v118, v38, v145
v_fmac_f32 v119, v39, v145
v_mul_f32 v116, v116, v108
v_mul_f32 v117, v117, v109
s_mov_b32 m0, s10
s_add_u32 s10, s10, s11
buffer_load_dwordx4 v12, s[88:91], s9 offen sc1 lds
s_add_u32 s9, s9, s12
s_sub_u32 s8, s8, 1
v_mul_f32 v118, v118, v110
v_mul_f32 v119, v119, v111
v_cvt_pk_bf16_f32 v138, v116, v117
v_cvt_pk_bf16_f32 v139, v118, v119
buffer_store_dwordx4 v[136:139], v1, s[84:87], s13 offen offset:0 sc1
ds_read_b128 v[104:107], v9 offset:1088
ds_read_b128 v[108:111], v9 offset:1216
ds_read_b128 v[112:115], v9 offset:1344
ds_read_b128 v[116:119], v9 offset:1472
s_waitcnt lgkmcnt(0)
s_mov_b32 m0, s10
s_add_u32 s10, s10, s11
buffer_load_dwordx4 v12, s[88:91], s9 offen sc1 lds
s_add_u32 s9, s9, s12
s_sub_u32 s8, s8, 1
v_fmac_f32 v108, v104, v144
v_fmac_f32 v109, v105, v144
v_fmac_f32 v110, v106, v144
v_fmac_f32 v111, v107, v144
v_fmac_f32 v108, v24, v146
v_fmac_f32 v109, v25, v146
v_fmac_f32 v110, v26, v146
v_fmac_f32 v111, v27, v146
v_exp_f32 v108, v108
v_exp_f32 v109, v109
s_mov_b32 m0, s10
s_add_u32 s10, s10, s11
buffer_load_dwordx4 v12, s[88:91], s9 offen sc1 lds
s_add_u32 s9, s9, s12
s_sub_u32 s8, s8, 1
v_exp_f32 v110, v110
v_exp_f32 v111, v111
v_fmac_f32 v116, v112, v144
v_fmac_f32 v117, v113, v144
v_fmac_f32 v118, v114, v144
v_fmac_f32 v119, v115, v144
v_add_f32 v108, 1.0, v108
v_add_f32 v109, 1.0, v109
v_add_f32 v110, 1.0, v110
v_add_f32 v111, 1.0, v111
s_mov_b32 m0, s10
s_add_u32 s10, s10, s11
buffer_load_dwordx4 v12, s[88:91], s9 offen sc1 lds
s_add_u32 s9, s9, s12
s_sub_u32 s8, s8, 1
v_rcp_f32 v108, v108
v_rcp_f32 v109, v109
v_rcp_f32 v110, v110
v_rcp_f32 v111, v111
v_fmac_f32 v116, v40, v145
v_fmac_f32 v117, v41, v145
v_fmac_f32 v118, v42, v145
v_fmac_f32 v119, v43, v145
v_mul_f32 v116, v116, v108
v_mul_f32 v117, v117, v109
s_mov_b32 m0, s10
s_add_u32 s10, s10, s11
buffer_load_dwordx4 v12, s[88:91], s9 offen sc1 lds
s_add_u32 s9, s9, s12
s_sub_u32 s8, s8, 1
v_mul_f32 v118, v118, v110
v_mul_f32 v119, v119, v111
v_cvt_pk_bf16_f32 v140, v116, v117
v_cvt_pk_bf16_f32 v141, v118, v119
ds_read_b128 v[104:107], v9 offset:1120
ds_read_b128 v[108:111], v9 offset:1248
ds_read_b128 v[112:115], v9 offset:1376
ds_read_b128 v[116:119], v9 offset:1504
s_waitcnt lgkmcnt(0)
v_fmac_f32 v108, v104, v144
v_fmac_f32 v109, v105, v144
v_fmac_f32 v110, v106, v144
v_fmac_f32 v111, v107, v144
v_fmac_f32 v108, v28, v146
v_fmac_f32 v109, v29, v146
v_fmac_f32 v110, v30, v146
v_fmac_f32 v111, v31, v146
v_exp_f32 v108, v108
v_exp_f32 v109, v109
v_exp_f32 v110, v110
v_exp_f32 v111, v111
v_fmac_f32 v116, v112, v144
v_fmac_f32 v117, v113, v144
v_fmac_f32 v118, v114, v144
v_fmac_f32 v119, v115, v144
v_add_f32 v108, 1.0, v108
v_add_f32 v109, 1.0, v109
v_add_f32 v110, 1.0, v110
v_add_f32 v111, 1.0, v111
v_rcp_f32 v108, v108
v_rcp_f32 v109, v109
v_rcp_f32 v110, v110
v_rcp_f32 v111, v111
v_fmac_f32 v116, v44, v145
v_fmac_f32 v117, v45, v145
v_fmac_f32 v118, v46, v145
v_fmac_f32 v119, v47, v145
v_mul_f32 v116, v116, v108
v_mul_f32 v117, v117, v109
v_mul_f32 v118, v118, v110
v_mul_f32 v119, v119, v111
v_cvt_pk_bf16_f32 v142, v116, v117
v_cvt_pk_bf16_f32 v143, v118, v119
buffer_store_dwordx4 v[140:143], v1, s[84:87], s13 offen offset:1024 sc1
s_add_u32 s7, s96, s3
s_waitcnt vmcnt(0)
s_lshl_b32 s4, s7, 2
s_add_u32 s4, s4, 45056
v_mov_b32 v14, s40
v_mov_b32 v15, 0
s_mov_b64 exec, 1
buffer_store_dword v14, v15, s[84:87], s4 offen sc1
s_mov_b64 exec, -1
ds_read_b64_tr_b16 a[0:1], v8 offset:0
s_mov_b32 m0, s10
s_add_u32 s10, s10, s11
buffer_load_dwordx4 v12, s[88:91], s9 offen sc1 lds
s_add_u32 s9, s9, s12
s_sub_u32 s8, s8, 1
ds_read_b64_tr_b16 a[2:3], v8 offset:1024
ds_read_b64_tr_b16 a[4:5], v7 offset:0
ds_read_b64_tr_b16 a[6:7], v7 offset:1024
ds_read_b64_tr_b16 a[8:9], v8 offset:2048
ds_read_b64_tr_b16 a[10:11], v8 offset:3072
ds_read_b64_tr_b16 a[12:13], v7 offset:2048
ds_read_b64_tr_b16 a[14:15], v7 offset:3072
ds_read_b64_tr_b16 a[16:17], v8 offset:4096
ds_read_b64_tr_b16 a[18:19], v8 offset:5120
ds_read_b64_tr_b16 a[20:21], v7 offset:4096
ds_read_b64_tr_b16 a[22:23], v7 offset:5120
ds_read_b64_tr_b16 a[24:25], v8 offset:6144
ds_read_b64_tr_b16 a[26:27], v8 offset:7168
ds_read_b64_tr_b16 a[28:29], v7 offset:6144
s_waitcnt lgkmcnt(11)
ds_read_b64_tr_b16 a[30:31], v7 offset:7168
ds_read_b64_tr_b16 a[32:33], v8 offset:8192
s_mov_b32 m0, s10
s_add_u32 s10, s10, s11
buffer_load_dwordx4 v12, s[88:91], s9 offen sc1 lds
s_add_u32 s9, s9, s12
s_sub_u32 s8, s8, 1
ds_read_b64_tr_b16 a[34:35], v8 offset:9216
ds_read_b64_tr_b16 a[36:37], v7 offset:8192
s_waitcnt lgkmcnt(11)
ds_read_b64_tr_b16 a[38:39], v7 offset:9216
ds_read_b64_tr_b16 a[40:41], v8 offset:10240
ds_read_b64_tr_b16 a[42:43], v8 offset:11264
ds_read_b64_tr_b16 a[44:45], v7 offset:10240
s_waitcnt lgkmcnt(11)
ds_read_b64_tr_b16 a[46:47], v7 offset:11264
ds_read_b64_tr_b16 a[48:49], v8 offset:12288
ds_read_b64_tr_b16 a[50:51], v8 offset:13312
ds_read_b64_tr_b16 a[52:53], v7 offset:12288
s_waitcnt lgkmcnt(11)
ds_read_b64_tr_b16 a[54:55], v7 offset:13312
ds_read_b64_tr_b16 a[56:57], v8 offset:14336
ds_read_b64_tr_b16 a[58:59], v8 offset:15360
ds_read_b64_tr_b16 a[60:61], v7 offset:14336
s_waitcnt lgkmcnt(11)
ds_read_b64_tr_b16 a[62:63], v7 offset:15360
ds_read_b64_tr_b16 a[64:65], v8 offset:16384
s_mov_b32 m0, s10
s_add_u32 s10, s10, s11
buffer_load_dwordx4 v12, s[88:91], s9 offen sc1 lds
s_add_u32 s9, s9, s12
s_sub_u32 s8, s8, 1
ds_read_b64_tr_b16 a[66:67], v8 offset:17408
ds_read_b64_tr_b16 a[68:69], v7 offset:16384
s_waitcnt lgkmcnt(11)
ds_read_b64_tr_b16 a[70:71], v7 offset:17408
ds_read_b64_tr_b16 a[72:73], v8 offset:18432
ds_read_b64_tr_b16 a[74:75], v8 offset:19456
ds_read_b64_tr_b16 a[76:77], v7 offset:18432
s_waitcnt lgkmcnt(11)
ds_read_b64_tr_b16 a[78:79], v7 offset:19456
ds_read_b64_tr_b16 a[80:81], v8 offset:20480
ds_read_b64_tr_b16 a[82:83], v8 offset:21504
ds_read_b64_tr_b16 a[84:85], v7 offset:20480
s_waitcnt lgkmcnt(11)
ds_read_b64_tr_b16 a[86:87], v7 offset:21504
ds_read_b64_tr_b16 a[88:89], v8 offset:22528
ds_read_b64_tr_b16 a[90:91], v8 offset:23552
ds_read_b64_tr_b16 a[92:93], v7 offset:22528
s_waitcnt lgkmcnt(11)
ds_read_b64_tr_b16 a[94:95], v7 offset:23552
ds_read_b64_tr_b16 a[96:97], v8 offset:24576
s_mov_b32 m0, s10
s_add_u32 s10, s10, s11
buffer_load_dwordx4 v12, s[88:91], s9 offen sc1 lds
s_add_u32 s9, s9, s12
s_sub_u32 s8, s8, 1
ds_read_b64_tr_b16 a[98:99], v8 offset:25600
ds_read_b64_tr_b16 a[100:101], v7 offset:24576
s_waitcnt lgkmcnt(11)
ds_read_b64_tr_b16 a[102:103], v7 offset:25600
ds_read_b64_tr_b16 a[104:105], v8 offset:26624
ds_read_b64_tr_b16 a[106:107], v8 offset:27648
ds_read_b64_tr_b16 a[108:109], v7 offset:26624
s_waitcnt lgkmcnt(11)
ds_read_b64_tr_b16 a[110:111], v7 offset:27648
ds_read_b64_tr_b16 a[112:113], v8 offset:28672
ds_read_b64_tr_b16 a[114:115], v8 offset:29696
ds_read_b64_tr_b16 a[116:117], v7 offset:28672
s_waitcnt lgkmcnt(11)
ds_read_b64_tr_b16 a[118:119], v7 offset:29696
ds_read_b64_tr_b16 a[120:121], v8 offset:30720
ds_read_b64_tr_b16 a[122:123], v8 offset:31744
ds_read_b64_tr_b16 a[124:125], v7 offset:30720
s_waitcnt lgkmcnt(11)
ds_read_b64_tr_b16 a[126:127], v7 offset:31744
s_branch L_p4e
L_two:
s_mov_b32 s88, s68
s_mov_b32 s89, s69
s_mov_b32 s90, s70
s_mov_b32 s91, 0x20000
s_lshr_b32 s4, s43, 1
s_and_b32 s5, s43, 1
s_mul_i32 s9, s4, 704512
s_lshl_b32 s7, s5, 13
s_add_u32 s9, s9, s7
s_and_b32 s7, s3, 7
s_lshl_b32 s7, s7, 7
s_add_u32 s9, s9, s7
s_add_u32 s9, s9, 262144
s_mul_i32 s4, s4, 32768
s_lshl_b32 s5, s5, 10
s_add_u32 s4, s4, s5
s_add_u32 s10, s4, 65536
s_mov_b32 s8, 16
s_mov_b32 s11, 2048
s_mov_b32 s12, 16384
v_lshrrev_b32 v12, 3, v0
v_and_b32 v15, 2, v12
v_lshlrev_b32 v15, 1, v15
v_xor_b32 v15, v15, v0
v_and_b32 v15, 7, v15
v_lshlrev_b32 v12, 10, v12
v_lshl_add_u32 v12, v15, 4, v12
ds_read_b128 v[80:83], v1 offset:0
ds_read_b128 v[84:87], v1 offset:32768
ds_read_b128 v[88:91], v1 offset:1024
ds_read_b128 v[92:95], v1 offset:33792
s_mov_b32 m0, s10
s_waitcnt lgkmcnt(2)
v_mfma_f32_32x32x16_bf16 v[48:63], v[80:83], a[0:3], 0
ds_read_b128 v[96:99], v1 offset:2048
ds_read_b128 v[100:103], v1 offset:34816
v_mfma_f32_32x32x16_bf16 v[64:79], v[84:87], a[0:3], 0
buffer_load_dwordx4 v12, s[88:91], s9 offen sc1 lds
s_add_u32 m0, m0, s11
s_add_u32 s9, s9, s12
s_waitcnt lgkmcnt(2)
v_mfma_f32_32x32x16_bf16 v[48:63], v[88:91], a[4:7], v[48:63]
ds_read_b128 v[80:83], v1 offset:3072
ds_read_b128 v[84:87], v1 offset:35840
ds_read_b128 v[104:107], v9 offset:0
ds_read_b128 v[108:111], v9 offset:128
ds_read_b128 v[112:115], v9 offset:256
v_mfma_f32_32x32x16_bf16 v[64:79], v[92:95], a[4:7], v[64:79]
ds_read_b128 v[116:119], v9 offset:384
s_waitcnt lgkmcnt(0)
v_fmac_f32 v108, v104, v144
v_mfma_f32_32x32x16_bf16 v[48:63], v[96:99], a[8:11], v[48:63]
ds_read_b128 v[88:91], v1 offset:4096
ds_read_b128 v[92:95], v1 offset:36864
v_fmac_f32 v109, v105, v144
v_fmac_f32 v110, v106, v144
v_fmac_f32 v111, v107, v144
v_mfma_f32_32x32x16_bf16 v[64:79], v[100:103], a[8:11], v[64:79]
v_fmac_f32 v108, v16, v146
v_fmac_f32 v109, v17, v146
v_fmac_f32 v110, v18, v146
buffer_load_dwordx4 v12, s[88:91], s9 offen sc1 lds
s_add_u32 m0, m0, s11
s_add_u32 s9, s9, s12
v_mfma_f32_32x32x16_bf16 v[48:63], v[80:83], a[12:15], v[48:63]
ds_read_b128 v[96:99], v1 offset:5120
ds_read_b128 v[100:103], v1 offset:37888
v_fmac_f32 v111, v19, v146
v_exp_f32 v108, v108
v_exp_f32 v109, v109
v_mfma_f32_32x32x16_bf16 v[64:79], v[84:87], a[12:15], v[64:79]
v_exp_f32 v110, v110
v_exp_f32 v111, v111
v_fmac_f32 v116, v112, v144
s_waitcnt lgkmcnt(2)
v_mfma_f32_32x32x16_bf16 v[48:63], v[88:91], a[16:19], v[48:63]
ds_read_b128 v[80:83], v1 offset:6144
ds_read_b128 v[84:87], v1 offset:38912
v_fmac_f32 v117, v113, v144
v_fmac_f32 v118, v114, v144
v_fmac_f32 v119, v115, v144
v_mfma_f32_32x32x16_bf16 v[64:79], v[92:95], a[16:19], v[64:79]
v_add_f32 v108, 1.0, v108
v_add_f32 v109, 1.0, v109
v_add_f32 v110, 1.0, v110
buffer_load_dwordx4 v12, s[88:91], s9 offen sc1 lds
s_add_u32 m0, m0, s11
s_add_u32 s9, s9, s12
s_waitcnt lgkmcnt(2)
v_mfma_f32_32x32x16_bf16 v[48:63], v[96:99], a[20:23], v[48:63]
ds_read_b128 v[88:91], v1 offset:7168
ds_read_b128 v[92:95], v1 offset:39936
v_add_f32 v111, 1.0, v111
v_rcp_f32 v108, v108
v_rcp_f32 v109, v109
v_mfma_f32_32x32x16_bf16 v[64:79], v[100:103], a[20:23], v[64:79]
v_rcp_f32 v110, v110
v_rcp_f32 v111, v111
v_fmac_f32 v116, v32, v145
s_waitcnt lgkmcnt(2)
v_mfma_f32_32x32x16_bf16 v[48:63], v[80:83], a[24:27], v[48:63]
ds_read_b128 v[96:99], v1 offset:8192
ds_read_b128 v[100:103], v1 offset:40960
v_fmac_f32 v117, v33, v145
v_fmac_f32 v118, v34, v145
v_fmac_f32 v119, v35, v145
v_mfma_f32_32x32x16_bf16 v[64:79], v[84:87], a[24:27], v[64:79]
v_mul_f32 v116, v116, v108
v_mul_f32 v117, v117, v109
v_mul_f32 v118, v118, v110
buffer_load_dwordx4 v12, s[88:91], s9 offen sc1 lds
s_add_u32 m0, m0, s11
s_add_u32 s9, s9, s12
s_waitcnt lgkmcnt(2)
v_mfma_f32_32x32x16_bf16 v[48:63], v[88:91], a[28:31], v[48:63]
ds_read_b128 v[80:83], v1 offset:9216
ds_read_b128 v[84:87], v1 offset:41984
v_mul_f32 v119, v119, v111
v_cvt_pk_bf16_f32 v136, v116, v117
v_cvt_pk_bf16_f32 v137, v118, v119
v_mfma_f32_32x32x16_bf16 v[64:79], v[92:95], a[28:31], v[64:79]
ds_read_b128 v[104:107], v9 offset:32
ds_read_b128 v[108:111], v9 offset:160
ds_read_b128 v[112:115], v9 offset:288
s_waitcnt lgkmcnt(5)
v_mfma_f32_32x32x16_bf16 v[48:63], v[96:99], a[32:35], v[48:63]
ds_read_b128 v[88:91], v1 offset:10240
ds_read_b128 v[92:95], v1 offset:43008
ds_read_b128 v[116:119], v9 offset:416
s_waitcnt lgkmcnt(0)
v_fmac_f32 v108, v104, v144
v_mfma_f32_32x32x16_bf16 v[64:79], v[100:103], a[32:35], v[64:79]
v_fmac_f32 v109, v105, v144
v_fmac_f32 v110, v106, v144
v_fmac_f32 v111, v107, v144
buffer_load_dwordx4 v12, s[88:91], s9 offen sc1 lds
s_add_u32 m0, m0, s11
s_add_u32 s9, s9, s12
v_mfma_f32_32x32x16_bf16 v[48:63], v[80:83], a[36:39], v[48:63]
ds_read_b128 v[96:99], v1 offset:11264
ds_read_b128 v[100:103], v1 offset:44032
v_fmac_f32 v108, v20, v146
v_fmac_f32 v109, v21, v146
v_fmac_f32 v110, v22, v146
v_mfma_f32_32x32x16_bf16 v[64:79], v[84:87], a[36:39], v[64:79]
v_fmac_f32 v111, v23, v146
v_exp_f32 v108, v108
v_exp_f32 v109, v109
v_mfma_f32_32x32x16_bf16 v[48:63], v[88:91], a[40:43], v[48:63]
ds_read_b128 v[80:83], v1 offset:12288
ds_read_b128 v[84:87], v1 offset:45056
v_exp_f32 v110, v110
v_exp_f32 v111, v111
v_fmac_f32 v116, v112, v144
v_mfma_f32_32x32x16_bf16 v[64:79], v[92:95], a[40:43], v[64:79]
v_fmac_f32 v117, v113, v144
v_fmac_f32 v118, v114, v144
v_fmac_f32 v119, v115, v144
buffer_load_dwordx4 v12, s[88:91], s9 offen sc1 lds
s_add_u32 m0, m0, s11
s_add_u32 s9, s9, s12
s_waitcnt lgkmcnt(2)
v_mfma_f32_32x32x16_bf16 v[48:63], v[96:99], a[44:47], v[48:63]
ds_read_b128 v[88:91], v1 offset:13312
ds_read_b128 v[92:95], v1 offset:46080
v_add_f32 v108, 1.0, v108
v_add_f32 v109, 1.0, v109
v_add_f32 v110, 1.0, v110
v_mfma_f32_32x32x16_bf16 v[64:79], v[100:103], a[44:47], v[64:79]
v_add_f32 v111, 1.0, v111
v_rcp_f32 v108, v108
v_rcp_f32 v109, v109
s_waitcnt lgkmcnt(2)
v_mfma_f32_32x32x16_bf16 v[48:63], v[80:83], a[48:51], v[48:63]
ds_read_b128 v[96:99], v1 offset:14336
ds_read_b128 v[100:103], v1 offset:47104
v_rcp_f32 v110, v110
v_rcp_f32 v111, v111
v_fmac_f32 v116, v36, v145
v_mfma_f32_32x32x16_bf16 v[64:79], v[84:87], a[48:51], v[64:79]
v_fmac_f32 v117, v37, v145
v_fmac_f32 v118, v38, v145
v_fmac_f32 v119, v39, v145
buffer_load_dwordx4 v12, s[88:91], s9 offen sc1 lds
s_add_u32 m0, m0, s11
s_add_u32 s9, s9, s12
s_waitcnt lgkmcnt(2)
v_mfma_f32_32x32x16_bf16 v[48:63], v[88:91], a[52:55], v[48:63]
ds_read_b128 v[80:83], v1 offset:15360
ds_read_b128 v[84:87], v1 offset:48128
v_mul_f32 v116, v116, v108
v_mul_f32 v117, v117, v109
v_mul_f32 v118, v118, v110
v_mfma_f32_32x32x16_bf16 v[64:79], v[92:95], a[52:55], v[64:79]
v_mul_f32 v119, v119, v111
v_cvt_pk_bf16_f32 v138, v116, v117
v_cvt_pk_bf16_f32 v139, v118, v119
s_waitcnt lgkmcnt(2)
v_mfma_f32_32x32x16_bf16 v[48:63], v[96:99], a[56:59], v[48:63]
ds_read_b128 v[88:91], v1 offset:16384
ds_read_b128 v[92:95], v1 offset:49152
buffer_store_dwordx4 v[136:139], v1, s[84:87], s97 offen offset:0 sc1
ds_read_b128 v[104:107], v9 offset:64
ds_read_b128 v[108:111], v9 offset:192
v_mfma_f32_32x32x16_bf16 v[64:79], v[100:103], a[56:59], v[64:79]
ds_read_b128 v[112:115], v9 offset:320
ds_read_b128 v[116:119], v9 offset:448
s_waitcnt lgkmcnt(0)
buffer_load_dwordx4 v12, s[88:91], s9 offen sc1 lds
s_add_u32 m0, m0, s11
s_add_u32 s9, s9, s12
v_mfma_f32_32x32x16_bf16 v[48:63], v[80:83], a[60:63], v[48:63]
ds_read_b128 v[96:99], v1 offset:17408
ds_read_b128 v[100:103], v1 offset:50176
v_fmac_f32 v108, v104, v144
v_fmac_f32 v109, v105, v144
v_fmac_f32 v110, v106, v144
v_mfma_f32_32x32x16_bf16 v[64:79], v[84:87], a[60:63], v[64:79]
v_fmac_f32 v111, v107, v144
v_fmac_f32 v108, v24, v146
v_fmac_f32 v109, v25, v146
v_mfma_f32_32x32x16_bf16 v[48:63], v[88:91], a[64:67], v[48:63]
ds_read_b128 v[80:83], v1 offset:18432
ds_read_b128 v[84:87], v1 offset:51200
v_fmac_f32 v110, v26, v146
v_fmac_f32 v111, v27, v146
v_exp_f32 v108, v108
v_mfma_f32_32x32x16_bf16 v[64:79], v[92:95], a[64:67], v[64:79]
v_exp_f32 v109, v109
v_exp_f32 v110, v110
v_exp_f32 v111, v111
buffer_load_dwordx4 v12, s[88:91], s9 offen sc1 lds
s_add_u32 m0, m0, s11
s_add_u32 s9, s9, s12
s_waitcnt lgkmcnt(2)
v_mfma_f32_32x32x16_bf16 v[48:63], v[96:99], a[68:71], v[48:63]
ds_read_b128 v[88:91], v1 offset:19456
ds_read_b128 v[92:95], v1 offset:52224
v_fmac_f32 v116, v112, v144
v_fmac_f32 v117, v113, v144
v_fmac_f32 v118, v114, v144
v_mfma_f32_32x32x16_bf16 v[64:79], v[100:103], a[68:71], v[64:79]
v_fmac_f32 v119, v115, v144
v_add_f32 v108, 1.0, v108
v_add_f32 v109, 1.0, v109
s_waitcnt lgkmcnt(2)
v_mfma_f32_32x32x16_bf16 v[48:63], v[80:83], a[72:75], v[48:63]
ds_read_b128 v[96:99], v1 offset:20480
ds_read_b128 v[100:103], v1 offset:53248
v_add_f32 v110, 1.0, v110
v_add_f32 v111, 1.0, v111
v_rcp_f32 v108, v108
v_mfma_f32_32x32x16_bf16 v[64:79], v[84:87], a[72:75], v[64:79]
v_rcp_f32 v109, v109
v_rcp_f32 v110, v110
v_rcp_f32 v111, v111
buffer_load_dwordx4 v12, s[88:91], s9 offen sc1 lds
s_add_u32 m0, m0, s11
s_add_u32 s9, s9, s12
s_waitcnt lgkmcnt(2)
v_mfma_f32_32x32x16_bf16 v[48:63], v[88:91], a[76:79], v[48:63]
ds_read_b128 v[80:83], v1 offset:21504
ds_read_b128 v[84:87], v1 offset:54272
v_fmac_f32 v116, v40, v145
v_fmac_f32 v117, v41, v145
v_fmac_f32 v118, v42, v145
v_mfma_f32_32x32x16_bf16 v[64:79], v[92:95], a[76:79], v[64:79]
v_fmac_f32 v119, v43, v145
v_mul_f32 v116, v116, v108
v_mul_f32 v117, v117, v109
s_waitcnt lgkmcnt(2)
v_mfma_f32_32x32x16_bf16 v[48:63], v[96:99], a[80:83], v[48:63]
ds_read_b128 v[88:91], v1 offset:22528
ds_read_b128 v[92:95], v1 offset:55296
v_mul_f32 v118, v118, v110
v_mul_f32 v119, v119, v111
v_cvt_pk_bf16_f32 v140, v116, v117
v_mfma_f32_32x32x16_bf16 v[64:79], v[100:103], a[80:83], v[64:79]
v_cvt_pk_bf16_f32 v141, v118, v119
ds_read_b128 v[104:107], v9 offset:96
ds_read_b128 v[108:111], v9 offset:224
buffer_load_dwordx4 v12, s[88:91], s9 offen sc1 lds
s_add_u32 m0, m0, s11
s_add_u32 s9, s9, s12
s_waitcnt lgkmcnt(4)
v_mfma_f32_32x32x16_bf16 v[48:63], v[80:83], a[84:87], v[48:63]
ds_read_b128 v[96:99], v1 offset:23552
ds_read_b128 v[100:103], v1 offset:56320
ds_read_b128 v[112:115], v9 offset:352
ds_read_b128 v[116:119], v9 offset:480
s_waitcnt lgkmcnt(0)
v_mfma_f32_32x32x16_bf16 v[64:79], v[84:87], a[84:87], v[64:79]
v_fmac_f32 v108, v104, v144
v_fmac_f32 v109, v105, v144
v_fmac_f32 v110, v106, v144
v_mfma_f32_32x32x16_bf16 v[48:63], v[88:91], a[88:91], v[48:63]
ds_read_b128 v[80:83], v1 offset:24576
ds_read_b128 v[84:87], v1 offset:57344
v_fmac_f32 v111, v107, v144
v_fmac_f32 v108, v28, v146
v_fmac_f32 v109, v29, v146
v_mfma_f32_32x32x16_bf16 v[64:79], v[92:95], a[88:91], v[64:79]
v_fmac_f32 v110, v30, v146
v_fmac_f32 v111, v31, v146
v_exp_f32 v108, v108
buffer_load_dwordx4 v12, s[88:91], s9 offen sc1 lds
s_add_u32 m0, m0, s11
s_add_u32 s9, s9, s12
v_mfma_f32_32x32x16_bf16 v[48:63], v[96:99], a[92:95], v[48:63]
ds_read_b128 v[88:91], v1 offset:25600
ds_read_b128 v[92:95], v1 offset:58368
v_exp_f32 v109, v109
v_exp_f32 v110, v110
v_exp_f32 v111, v111
v_mfma_f32_32x32x16_bf16 v[64:79], v[100:103], a[92:95], v[64:79]
v_fmac_f32 v116, v112, v144
v_fmac_f32 v117, v113, v144
v_fmac_f32 v118, v114, v144
s_waitcnt lgkmcnt(2)
v_mfma_f32_32x32x16_bf16 v[48:63], v[80:83], a[96:99], v[48:63]
ds_read_b128 v[96:99], v1 offset:26624
ds_read_b128 v[100:103], v1 offset:59392
v_fmac_f32 v119, v115, v144
v_add_f32 v108, 1.0, v108
v_add_f32 v109, 1.0, v109
v_mfma_f32_32x32x16_bf16 v[64:79], v[84:87], a[96:99], v[64:79]
v_add_f32 v110, 1.0, v110
v_add_f32 v111, 1.0, v111
v_rcp_f32 v108, v108
buffer_load_dwordx4 v12, s[88:91], s9 offen sc1 lds
s_add_u32 m0, m0, s11
s_add_u32 s9, s9, s12
s_waitcnt lgkmcnt(2)
v_mfma_f32_32x32x16_bf16 v[48:63], v[88:91], a[100:103], v[48:63]
ds_read_b128 v[80:83], v1 offset:27648
ds_read_b128 v[84:87], v1 offset:60416
v_rcp_f32 v109, v109
v_rcp_f32 v110, v110
v_rcp_f32 v111, v111
v_mfma_f32_32x32x16_bf16 v[64:79], v[92:95], a[100:103], v[64:79]
v_fmac_f32 v116, v44, v145
v_fmac_f32 v117, v45, v145
v_fmac_f32 v118, v46, v145
s_waitcnt lgkmcnt(2)
v_mfma_f32_32x32x16_bf16 v[48:63], v[96:99], a[104:107], v[48:63]
ds_read_b128 v[88:91], v1 offset:28672
ds_read_b128 v[92:95], v1 offset:61440
v_fmac_f32 v119, v47, v145
v_mul_f32 v116, v116, v108
v_mul_f32 v117, v117, v109
v_mfma_f32_32x32x16_bf16 v[64:79], v[100:103], a[104:107], v[64:79]
v_mul_f32 v118, v118, v110
v_mul_f32 v119, v119, v111
v_cvt_pk_bf16_f32 v142, v116, v117
buffer_load_dwordx4 v12, s[88:91], s9 offen sc1 lds
s_add_u32 m0, m0, s11
s_add_u32 s9, s9, s12
s_waitcnt lgkmcnt(2)
v_mfma_f32_32x32x16_bf16 v[48:63], v[80:83], a[108:111], v[48:63]
ds_read_b128 v[96:99], v1 offset:29696
ds_read_b128 v[100:103], v1 offset:62464
v_cvt_pk_bf16_f32 v143, v118, v119
buffer_store_dwordx4 v[140:143], v1, s[84:87], s97 offen offset:1024 sc1
v_mfma_f32_32x32x16_bf16 v[64:79], v[84:87], a[108:111], v[64:79]
s_waitcnt lgkmcnt(2)
v_mfma_f32_32x32x16_bf16 v[48:63], v[88:91], a[112:115], v[48:63]
ds_read_b128 v[80:83], v1 offset:30720
ds_read_b128 v[84:87], v1 offset:63488
v_mfma_f32_32x32x16_bf16 v[64:79], v[92:95], a[112:115], v[64:79]
buffer_load_dwordx4 v12, s[88:91], s9 offen sc1 lds
s_add_u32 m0, m0, s11
s_add_u32 s9, s9, s12
s_waitcnt lgkmcnt(2)
v_mfma_f32_32x32x16_bf16 v[48:63], v[96:99], a[116:119], v[48:63]
ds_read_b128 v[88:91], v1 offset:31744
ds_read_b128 v[92:95], v1 offset:64512
v_mfma_f32_32x32x16_bf16 v[64:79], v[100:103], a[116:119], v[64:79]
s_waitcnt lgkmcnt(2)
v_mfma_f32_32x32x16_bf16 v[48:63], v[80:83], a[120:123], v[48:63]
v_mfma_f32_32x32x16_bf16 v[64:79], v[84:87], a[120:123], v[64:79]
buffer_load_dwordx4 v12, s[88:91], s9 offen sc1 lds
s_add_u32 m0, m0, s11
s_add_u32 s9, s9, s12
s_waitcnt lgkmcnt(0)
v_mfma_f32_32x32x16_bf16 v[48:63], v[88:91], a[124:127], v[48:63]
v_mfma_f32_32x32x16_bf16 v[64:79], v[92:95], a[124:127], v[64:79]
s_mov_b32 s8, 0
s_waitcnt vmcnt(0)
s_waitcnt lgkmcnt(0)
s_barrier
s_mov_b32 s88, s68
s_mov_b32 s89, s69
s_mov_b32 s90, s70
s_mov_b32 s91, 0x20000
s_lshr_b32 s4, s43, 1
s_and_b32 s5, s43, 1
s_mul_i32 s9, s4, 704512
s_lshl_b32 s7, s5, 13
s_add_u32 s9, s9, s7
s_and_b32 s7, s3, 7
s_lshl_b32 s7, s7, 7
s_add_u32 s9, s9, s7
s_add_u32 s9, s9, 0
s_mul_i32 s4, s4, 32768
s_lshl_b32 s5, s5, 10
s_add_u32 s4, s4, s5
s_add_u32 s10, s4, 0
s_mov_b32 s8, 16
s_mov_b32 s11, 2048
s_mov_b32 s12, 16384
v_lshrrev_b32 v12, 3, v0
v_and_b32 v15, 2, v12
v_lshlrev_b32 v15, 1, v15
v_xor_b32 v15, v15, v0
v_and_b32 v15, 7, v15
v_lshlrev_b32 v12, 10, v12
v_lshl_add_u32 v12, v15, 4, v12
s_lshl_b32 s4, s93, 15
v_add_u32 v8, s4, v13
v_xor_b32 v7, 64, v8
ds_read_b128 v[104:107], v9 offset:512
ds_read_b128 v[108:111], v9 offset:640
ds_read_b128 v[112:115], v9 offset:768
ds_read_b128 v[116:119], v9 offset:896
s_mov_b32 m0, s10
s_add_u32 s10, s10, s11
buffer_load_dwordx4 v12, s[88:91], s9 offen sc1 lds
s_add_u32 s9, s9, s12
s_sub_u32 s8, s8, 1
s_waitcnt lgkmcnt(0)
v_fmac_f32 v108, v104, v144
v_fmac_f32 v109, v105, v144
v_fmac_f32 v110, v106, v144
v_fmac_f32 v111, v107, v144
v_fmac_f32 v108, v48, v146
v_fmac_f32 v109, v49, v146
v_fmac_f32 v110, v50, v146
v_fmac_f32 v111, v51, v146
v_exp_f32 v108, v108
s_mov_b32 m0, s10
s_add_u32 s10, s10, s11
buffer_load_dwordx4 v12, s[88:91], s9 offen sc1 lds
s_add_u32 s9, s9, s12
s_sub_u32 s8, s8, 1
v_exp_f32 v109, v109
v_exp_f32 v110, v110
v_exp_f32 v111, v111
v_fmac_f32 v116, v112, v144
v_fmac_f32 v117, v113, v144
v_fmac_f32 v118, v114, v144
v_fmac_f32 v119, v115, v144
v_add_f32 v108, 1.0, v108
v_add_f32 v109, 1.0, v109
v_add_f32 v110, 1.0, v110
s_mov_b32 m0, s10
s_add_u32 s10, s10, s11
buffer_load_dwordx4 v12, s[88:91], s9 offen sc1 lds
s_add_u32 s9, s9, s12
s_sub_u32 s8, s8, 1
v_add_f32 v111, 1.0, v111
v_rcp_f32 v108, v108
v_rcp_f32 v109, v109
v_rcp_f32 v110, v110
v_rcp_f32 v111, v111
v_fmac_f32 v116, v64, v145
v_fmac_f32 v117, v65, v145
v_fmac_f32 v118, v66, v145
v_fmac_f32 v119, v67, v145
v_mul_f32 v116, v116, v108
s_mov_b32 m0, s10
s_add_u32 s10, s10, s11
buffer_load_dwordx4 v12, s[88:91], s9 offen sc1 lds
s_add_u32 s9, s9, s12
s_sub_u32 s8, s8, 1
v_mul_f32 v117, v117, v109
v_mul_f32 v118, v118, v110
v_mul_f32 v119, v119, v111
v_cvt_pk_bf16_f32 v136, v116, v117
v_cvt_pk_bf16_f32 v137, v118, v119
ds_read_b128 v[104:107], v9 offset:544
ds_read_b128 v[108:111], v9 offset:672
ds_read_b128 v[112:115], v9 offset:800
ds_read_b128 v[116:119], v9 offset:928
s_waitcnt lgkmcnt(0)
s_mov_b32 m0, s10
s_add_u32 s10, s10, s11
buffer_load_dwordx4 v12, s[88:91], s9 offen sc1 lds
s_add_u32 s9, s9, s12
s_sub_u32 s8, s8, 1
v_fmac_f32 v108, v104, v144
v_fmac_f32 v109, v105, v144
v_fmac_f32 v110, v106, v144
v_fmac_f32 v111, v107, v144
v_fmac_f32 v108, v52, v146
v_fmac_f32 v109, v53, v146
v_fmac_f32 v110, v54, v146
v_fmac_f32 v111, v55, v146
v_exp_f32 v108, v108
v_exp_f32 v109, v109
s_mov_b32 m0, s10
s_add_u32 s10, s10, s11
buffer_load_dwordx4 v12, s[88:91], s9 offen sc1 lds
s_add_u32 s9, s9, s12
s_sub_u32 s8, s8, 1
v_exp_f32 v110, v110
v_exp_f32 v111, v111
v_fmac_f32 v116, v112, v144
v_fmac_f32 v117, v113, v144
v_fmac_f32 v118, v114, v144
v_fmac_f32 v119, v115, v144
v_add_f32 v108, 1.0, v108
v_add_f32 v109, 1.0, v109
v_add_f32 v110, 1.0, v110
v_add_f32 v111, 1.0, v111
s_mov_b32 m0, s10
s_add_u32 s10, s10, s11
buffer_load_dwordx4 v12, s[88:91], s9 offen sc1 lds
s_add_u32 s9, s9, s12
s_sub_u32 s8, s8, 1
v_rcp_f32 v108, v108
v_rcp_f32 v109, v109
v_rcp_f32 v110, v110
v_rcp_f32 v111, v111
v_fmac_f32 v116, v68, v145
v_fmac_f32 v117, v69, v145
v_fmac_f32 v118, v70, v145
v_fmac_f32 v119, v71, v145
v_mul_f32 v116, v116, v108
v_mul_f32 v117, v117, v109
s_mov_b32 m0, s10
s_add_u32 s10, s10, s11
buffer_load_dwordx4 v12, s[88:91], s9 offen sc1 lds
s_add_u32 s9, s9, s12
s_sub_u32 s8, s8, 1
v_mul_f32 v118, v118, v110
v_mul_f32 v119, v119, v111
v_cvt_pk_bf16_f32 v138, v116, v117
v_cvt_pk_bf16_f32 v139, v118, v119
buffer_store_dwordx4 v[136:139], v1, s[84:87], s97 offen offset:2048 sc1
ds_read_b128 v[104:107], v9 offset:576
ds_read_b128 v[108:111], v9 offset:704
ds_read_b128 v[112:115], v9 offset:832
ds_read_b128 v[116:119], v9 offset:960
s_waitcnt lgkmcnt(0)
s_mov_b32 m0, s10
s_add_u32 s10, s10, s11
buffer_load_dwordx4 v12, s[88:91], s9 offen sc1 lds
s_add_u32 s9, s9, s12
s_sub_u32 s8, s8, 1
v_fmac_f32 v108, v104, v144
v_fmac_f32 v109, v105, v144
v_fmac_f32 v110, v106, v144
v_fmac_f32 v111, v107, v144
v_fmac_f32 v108, v56, v146
v_fmac_f32 v109, v57, v146
v_fmac_f32 v110, v58, v146
v_fmac_f32 v111, v59, v146
v_exp_f32 v108, v108
v_exp_f32 v109, v109
s_mov_b32 m0, s10
s_add_u32 s10, s10, s11
buffer_load_dwordx4 v12, s[88:91], s9 offen sc1 lds
s_add_u32 s9, s9, s12
s_sub_u32 s8, s8, 1
v_exp_f32 v110, v110
v_exp_f32 v111, v111
v_fmac_f32 v116, v112, v144
v_fmac_f32 v117, v113, v144
v_fmac_f32 v118, v114, v144
v_fmac_f32 v119, v115, v144
v_add_f32 v108, 1.0, v108
v_add_f32 v109, 1.0, v109
v_add_f32 v110, 1.0, v110
v_add_f32 v111, 1.0, v111
s_mov_b32 m0, s10
s_add_u32 s10, s10, s11
buffer_load_dwordx4 v12, s[88:91], s9 offen sc1 lds
s_add_u32 s9, s9, s12
s_sub_u32 s8, s8, 1
v_rcp_f32 v108, v108
v_rcp_f32 v109, v109
v_rcp_f32 v110, v110
v_rcp_f32 v111, v111
v_fmac_f32 v116, v72, v145
v_fmac_f32 v117, v73, v145
v_fmac_f32 v118, v74, v145
v_fmac_f32 v119, v75, v145
v_mul_f32 v116, v116, v108
v_mul_f32 v117, v117, v109
s_mov_b32 m0, s10
s_add_u32 s10, s10, s11
buffer_load_dwordx4 v12, s[88:91], s9 offen sc1 lds
s_add_u32 s9, s9, s12
s_sub_u32 s8, s8, 1
v_mul_f32 v118, v118, v110
v_mul_f32 v119, v119, v111
v_cvt_pk_bf16_f32 v140, v116, v117
v_cvt_pk_bf16_f32 v141, v118, v119
ds_read_b128 v[104:107], v9 offset:608
ds_read_b128 v[108:111], v9 offset:736
ds_read_b128 v[112:115], v9 offset:864
ds_read_b128 v[116:119], v9 offset:992
s_waitcnt lgkmcnt(0)
v_fmac_f32 v108, v104, v144
v_fmac_f32 v109, v105, v144
v_fmac_f32 v110, v106, v144
v_fmac_f32 v111, v107, v144
v_fmac_f32 v108, v60, v146
v_fmac_f32 v109, v61, v146
v_fmac_f32 v110, v62, v146
v_fmac_f32 v111, v63, v146
v_exp_f32 v108, v108
v_exp_f32 v109, v109
v_exp_f32 v110, v110
v_exp_f32 v111, v111
v_fmac_f32 v116, v112, v144
v_fmac_f32 v117, v113, v144
v_fmac_f32 v118, v114, v144
v_fmac_f32 v119, v115, v144
v_add_f32 v108, 1.0, v108
v_add_f32 v109, 1.0, v109
v_add_f32 v110, 1.0, v110
v_add_f32 v111, 1.0, v111
v_rcp_f32 v108, v108
v_rcp_f32 v109, v109
v_rcp_f32 v110, v110
v_rcp_f32 v111, v111
v_fmac_f32 v116, v76, v145
v_fmac_f32 v117, v77, v145
v_fmac_f32 v118, v78, v145
v_fmac_f32 v119, v79, v145
v_mul_f32 v116, v116, v108
v_mul_f32 v117, v117, v109
v_mul_f32 v118, v118, v110
v_mul_f32 v119, v119, v111
v_cvt_pk_bf16_f32 v142, v116, v117
v_cvt_pk_bf16_f32 v143, v118, v119
buffer_store_dwordx4 v[140:143], v1, s[84:87], s97 offen offset:3072 sc1
s_add_u32 s7, s96, s3
s_waitcnt vmcnt(0)
s_lshl_b32 s4, s7, 2
s_add_u32 s4, s4, 45056
v_mov_b32 v14, s40
v_mov_b32 v15, 0
s_mov_b64 exec, 1
buffer_store_dword v14, v15, s[84:87], s4 offen sc1
s_mov_b64 exec, -1
br_140:
s_cmp_eq_u32 s8, 0
s_cbranch_scc1 bd_141
s_mov_b32 m0, s10
s_add_u32 s10, s10, s11
buffer_load_dwordx4 v12, s[88:91], s9 offen sc1 lds
s_add_u32 s9, s9, s12
s_sub_u32 s8, s8, 1
s_branch br_140
bd_141:
s_waitcnt vmcnt(0)
s_waitcnt lgkmcnt(0)
s_barrier
ds_read_b64_tr_b16 a[0:1], v8 offset:0
ds_read_b64_tr_b16 a[2:3], v8 offset:1024
ds_read_b64_tr_b16 a[4:5], v7 offset:0
ds_read_b64_tr_b16 a[6:7], v7 offset:1024
ds_read_b64_tr_b16 a[8:9], v8 offset:2048
ds_read_b64_tr_b16 a[10:11], v8 offset:3072
ds_read_b64_tr_b16 a[12:13], v7 offset:2048
ds_read_b64_tr_b16 a[14:15], v7 offset:3072
ds_read_b64_tr_b16 a[16:17], v8 offset:4096
ds_read_b64_tr_b16 a[18:19], v8 offset:5120
ds_read_b64_tr_b16 a[20:21], v7 offset:4096
ds_read_b64_tr_b16 a[22:23], v7 offset:5120
ds_read_b64_tr_b16 a[24:25], v8 offset:6144
ds_read_b64_tr_b16 a[26:27], v8 offset:7168
ds_read_b64_tr_b16 a[28:29], v7 offset:6144
s_waitcnt lgkmcnt(11)
ds_read_b64_tr_b16 a[30:31], v7 offset:7168
ds_read_b64_tr_b16 a[32:33], v8 offset:8192
ds_read_b64_tr_b16 a[34:35], v8 offset:9216
ds_read_b64_tr_b16 a[36:37], v7 offset:8192
s_waitcnt lgkmcnt(11)
ds_read_b64_tr_b16 a[38:39], v7 offset:9216
ds_read_b64_tr_b16 a[40:41], v8 offset:10240
ds_read_b64_tr_b16 a[42:43], v8 offset:11264
ds_read_b64_tr_b16 a[44:45], v7 offset:10240
s_waitcnt lgkmcnt(11)
ds_read_b64_tr_b16 a[46:47], v7 offset:11264
ds_read_b64_tr_b16 a[48:49], v8 offset:12288
ds_read_b64_tr_b16 a[50:51], v8 offset:13312
ds_read_b64_tr_b16 a[52:53], v7 offset:12288
s_waitcnt lgkmcnt(11)
ds_read_b64_tr_b16 a[54:55], v7 offset:13312
ds_read_b64_tr_b16 a[56:57], v8 offset:14336
ds_read_b64_tr_b16 a[58:59], v8 offset:15360
ds_read_b64_tr_b16 a[60:61], v7 offset:14336
s_waitcnt lgkmcnt(11)
ds_read_b64_tr_b16 a[62:63], v7 offset:15360
ds_read_b64_tr_b16 a[64:65], v8 offset:16384
ds_read_b64_tr_b16 a[66:67], v8 offset:17408
ds_read_b64_tr_b16 a[68:69], v7 offset:16384
s_waitcnt lgkmcnt(11)
ds_read_b64_tr_b16 a[70:71], v7 offset:17408
ds_read_b64_tr_b16 a[72:73], v8 offset:18432
ds_read_b64_tr_b16 a[74:75], v8 offset:19456
ds_read_b64_tr_b16 a[76:77], v7 offset:18432
s_waitcnt lgkmcnt(11)
ds_read_b64_tr_b16 a[78:79], v7 offset:19456
ds_read_b64_tr_b16 a[80:81], v8 offset:20480
ds_read_b64_tr_b16 a[82:83], v8 offset:21504
ds_read_b64_tr_b16 a[84:85], v7 offset:20480
s_waitcnt lgkmcnt(11)
ds_read_b64_tr_b16 a[86:87], v7 offset:21504
ds_read_b64_tr_b16 a[88:89], v8 offset:22528
ds_read_b64_tr_b16 a[90:91], v8 offset:23552
ds_read_b64_tr_b16 a[92:93], v7 offset:22528
s_waitcnt lgkmcnt(11)
ds_read_b64_tr_b16 a[94:95], v7 offset:23552
ds_read_b64_tr_b16 a[96:97], v8 offset:24576
ds_read_b64_tr_b16 a[98:99], v8 offset:25600
ds_read_b64_tr_b16 a[100:101], v7 offset:24576
s_waitcnt lgkmcnt(11)
ds_read_b64_tr_b16 a[102:103], v7 offset:25600
ds_read_b64_tr_b16 a[104:105], v8 offset:26624
ds_read_b64_tr_b16 a[106:107], v8 offset:27648
ds_read_b64_tr_b16 a[108:109], v7 offset:26624
s_waitcnt lgkmcnt(11)
ds_read_b64_tr_b16 a[110:111], v7 offset:27648
ds_read_b64_tr_b16 a[112:113], v8 offset:28672
ds_read_b64_tr_b16 a[114:115], v8 offset:29696
ds_read_b64_tr_b16 a[116:117], v7 offset:28672
s_waitcnt lgkmcnt(11)
ds_read_b64_tr_b16 a[118:119], v7 offset:29696
ds_read_b64_tr_b16 a[120:121], v8 offset:30720
ds_read_b64_tr_b16 a[122:123], v8 offset:31744
ds_read_b64_tr_b16 a[124:125], v7 offset:30720
s_waitcnt lgkmcnt(11)
ds_read_b64_tr_b16 a[126:127], v7 offset:31744
L_p4e:
s_waitcnt lgkmcnt(0)
s_barrier
s_lshl_b32 s4, s93, 15
v_add_u32 v9, s4, v13
v_xor_b32 v10, 64, v9
s_mov_b32 s88, s68
s_mov_b32 s89, s69
s_mov_b32 s90, s70
s_mov_b32 s91, 0x20000
s_lshr_b32 s4, s43, 1
s_and_b32 s5, s43, 1
s_mul_i32 s9, s4, 704512
s_lshl_b32 s7, s5, 13
s_add_u32 s9, s9, s7
s_and_b32 s7, s3, 7
s_lshl_b32 s7, s7, 7
s_add_u32 s9, s9, s7
s_add_u32 s9, s9, 524288
s_mul_i32 s4, s4, 22528
s_lshl_b32 s5, s5, 10
s_add_u32 s4, s4, s5
s_add_u32 s10, s4, 0
s_mov_b32 s8, 11
s_mov_b32 s11, 2048
s_mov_b32 s12, 16384
v_lshrrev_b32 v12, 3, v0
v_and_b32 v15, 2, v12
v_lshlrev_b32 v15, 1, v15
v_xor_b32 v15, v15, v0
v_and_b32 v15, 7, v15
v_lshlrev_b32 v12, 10, v12
v_lshl_add_u32 v12, v15, 4, v12
s_lshl_b32 s4, s41, 6
s_lshl_b32 s5, s46, 4
s_add_u32 s4, s4, s5
s_lshl_b32 s4, s4, 2
s_add_u32 s5, s4, 45056
v_and_b32 v14, 15, v0
v_lshlrev_b32 v14, 2, v14
s_mov_b32 s47, 0x8000
poll_142:
s_cmp_eq_u32 s8, 0
s_cbranch_scc1 pb_144
s_mov_b32 m0, s10
s_add_u32 s10, s10, s11
buffer_load_dwordx4 v12, s[88:91], s9 offen sc1 lds
s_add_u32 s9, s9, s12
s_sub_u32 s8, s8, 1
s_cmp_eq_u32 s8, 0
s_cbranch_scc1 pb_144
s_mov_b32 m0, s10
s_add_u32 s10, s10, s11
buffer_load_dwordx4 v12, s[88:91], s9 offen sc1 lds
s_add_u32 s9, s9, s12
s_sub_u32 s8, s8, 1
s_cmp_eq_u32 s8, 0
s_cbranch_scc1 pb_144
s_mov_b32 m0, s10
s_add_u32 s10, s10, s11
buffer_load_dwordx4 v12, s[88:91], s9 offen sc1 lds
s_add_u32 s9, s9, s12
s_sub_u32 s8, s8, 1
s_cmp_eq_u32 s8, 0
s_cbranch_scc1 pb_144
s_mov_b32 m0, s10
s_add_u32 s10, s10, s11
buffer_load_dwordx4 v12, s[88:91], s9 offen sc1 lds
s_add_u32 s9, s9, s12
s_sub_u32 s8, s8, 1
s_cmp_eq_u32 s8, 0
s_cbranch_scc1 pb_144
s_mov_b32 m0, s10
s_add_u32 s10, s10, s11
buffer_load_dwordx4 v12, s[88:91], s9 offen sc1 lds
s_add_u32 s9, s9, s12
s_sub_u32 s8, s8, 1
s_cmp_eq_u32 s8, 0
s_cbranch_scc1 pb_144
s_mov_b32 m0, s10
s_add_u32 s10, s10, s11
buffer_load_dwordx4 v12, s[88:91], s9 offen sc1 lds
s_add_u32 s9, s9, s12
s_sub_u32 s8, s8, 1
s_cmp_eq_u32 s8, 0
s_cbranch_scc1 pb_144
s_mov_b32 m0, s10
s_add_u32 s10, s10, s11
buffer_load_dwordx4 v12, s[88:91], s9 offen sc1 lds
s_add_u32 s9, s9, s12
s_sub_u32 s8, s8, 1
s_cmp_eq_u32 s8, 0
s_cbranch_scc1 pb_144
s_mov_b32 m0, s10
s_add_u32 s10, s10, s11
buffer_load_dwordx4 v12, s[88:91], s9 offen sc1 lds
s_add_u32 s9, s9, s12
s_sub_u32 s8, s8, 1
s_cmp_eq_u32 s8, 0
s_cbranch_scc1 pb_144
s_mov_b32 m0, s10
s_add_u32 s10, s10, s11
buffer_load_dwordx4 v12, s[88:91], s9 offen sc1 lds
s_add_u32 s9, s9, s12
s_sub_u32 s8, s8, 1
s_cmp_eq_u32 s8, 0
s_cbranch_scc1 pb_144
s_mov_b32 m0, s10
s_add_u32 s10, s10, s11
buffer_load_dwordx4 v12, s[88:91], s9 offen sc1 lds
s_add_u32 s9, s9, s12
s_sub_u32 s8, s8, 1
s_cmp_eq_u32 s8, 0
s_cbranch_scc1 pb_144
s_mov_b32 m0, s10
s_add_u32 s10, s10, s11
buffer_load_dwordx4 v12, s[88:91], s9 offen sc1 lds
s_add_u32 s9, s9, s12
s_sub_u32 s8, s8, 1
pb_144:
buffer_load_dword v15, v14, s[84:87], s5 offen sc1
s_waitcnt vmcnt(0)
v_cmp_ne_u32 vcc, s40, v15
s_cbranch_vccz pd_143
s_sub_u32 s47, s47, 1
s_cbranch_scc0 poll_142
pd_143:
br_145:
s_cmp_eq_u32 s8, 0
s_cbranch_scc1 bd_146
s_mov_b32 m0, s10
s_add_u32 s10, s10, s11
buffer_load_dwordx4 v12, s[88:91], s9 offen sc1 lds
s_add_u32 s9, s9, s12
s_sub_u32 s8, s8, 1
s_branch br_145
bd_146:
s_waitcnt vmcnt(0)
s_mul_i32 s6, s45, 98304
s_mul_i32 s5, s93, 44032
s_add_u32 s6, s6, s5
s_add_u32 s6, s6, 20971520
buffer_load_dwordx4 a[128:131], v1, s[84:87], s6 offen offset:0 sc1
buffer_load_dwordx4 a[132:135], v1, s[84:87], s6 offen offset:1024 sc1
buffer_load_dwordx4 a[136:139], v1, s[84:87], s6 offen offset:2048 sc1
buffer_load_dwordx4 a[140:143], v1, s[84:87], s6 offen offset:3072 sc1
s_add_u32 s6, s6, 4096
buffer_load_dwordx4 a[144:147], v1, s[84:87], s6 offen offset:0 sc1
buffer_load_dwordx4 a[148:151], v1, s[84:87], s6 offen offset:1024 sc1
buffer_load_dwordx4 a[152:155], v1, s[84:87], s6 offen offset:2048 sc1
buffer_load_dwordx4 a[156:159], v1, s[84:87], s6 offen offset:3072 sc1
s_add_u32 s6, s6, 4096
buffer_load_dwordx4 a[160:163], v1, s[84:87], s6 offen offset:0 sc1
buffer_load_dwordx4 a[164:167], v1, s[84:87], s6 offen offset:1024 sc1
s_barrier
v_add_u32 v9, 65536, v9
v_add_u32 v10, 65536, v10
s_mul_i32 s4, s93, 22528
v_add_u32 v8, s4, v13
v_xor_b32 v7, 64, v8
ds_read_b64_tr_b16 v[56:57], v9 offset:0
ds_read_b64_tr_b16 v[58:59], v9 offset:1024
ds_read_b64_tr_b16 v[60:61], v10 offset:0
ds_read_b64_tr_b16 v[62:63], v10 offset:1024
ds_read_b64_tr_b16 v[64:65], v9 offset:2048
ds_read_b64_tr_b16 v[66:67], v9 offset:3072
ds_read_b64_tr_b16 v[68:69], v10 offset:2048
ds_read_b64_tr_b16 v[70:71], v10 offset:3072
buffer_load_dwordx4 a[168:171], v1, s[84:87], s6 offen offset:2048 sc1
s_waitcnt vmcnt(10)
v_mfma_f32_32x32x16_bf16 v[16:31], a[0:3], a[128:131], 0
v_mfma_f32_32x32x16_bf16 v[32:47], a[4:7], a[128:131], 0
buffer_load_dwordx4 a[172:175], v1, s[84:87], s6 offen offset:3072 sc1
s_waitcnt vmcnt(10)
v_mfma_f32_32x32x16_bf16 v[16:31], a[8:11], a[132:135], v[16:31]
v_mfma_f32_32x32x16_bf16 v[32:47], a[12:15], a[132:135], v[32:47]
s_add_u32 s6, s6, 4096
buffer_load_dwordx4 a[176:179], v1, s[84:87], s6 offen offset:0 sc1
s_waitcnt vmcnt(10)
v_mfma_f32_32x32x16_bf16 v[16:31], a[16:19], a[136:139], v[16:31]
v_mfma_f32_32x32x16_bf16 v[32:47], a[20:23], a[136:139], v[32:47]
buffer_load_dwordx4 a[180:183], v1, s[84:87], s6 offen offset:1024 sc1
s_waitcnt vmcnt(10)
v_mfma_f32_32x32x16_bf16 v[16:31], a[24:27], a[140:143], v[16:31]
v_mfma_f32_32x32x16_bf16 v[32:47], a[28:31], a[140:143], v[32:47]
buffer_load_dwordx4 a[184:187], v1, s[84:87], s6 offen offset:2048 sc1
s_waitcnt vmcnt(10)
v_mfma_f32_32x32x16_bf16 v[16:31], a[32:35], a[144:147], v[16:31]
v_mfma_f32_32x32x16_bf16 v[32:47], a[36:39], a[144:147], v[32:47]
buffer_load_dwordx4 a[188:191], v1, s[84:87], s6 offen offset:3072 sc1
s_waitcnt vmcnt(10)
v_mfma_f32_32x32x16_bf16 v[16:31], a[40:43], a[148:151], v[16:31]
v_mfma_f32_32x32x16_bf16 v[32:47], a[44:47], a[148:151], v[32:47]
s_add_u32 s6, s6, 4096
buffer_load_dwordx4 a[192:195], v1, s[84:87], s6 offen offset:0 sc1
s_waitcnt vmcnt(10)
v_mfma_f32_32x32x16_bf16 v[16:31], a[48:51], a[152:155], v[16:31]
v_mfma_f32_32x32x16_bf16 v[32:47], a[52:55], a[152:155], v[32:47]
buffer_load_dwordx4 a[196:199], v1, s[84:87], s6 offen offset:1024 sc1
s_waitcnt vmcnt(10)
v_mfma_f32_32x32x16_bf16 v[16:31], a[56:59], a[156:159], v[16:31]
v_mfma_f32_32x32x16_bf16 v[32:47], a[60:63], a[156:159], v[32:47]
buffer_load_dwordx4 a[200:203], v1, s[84:87], s6 offen offset:2048 sc1
s_waitcnt vmcnt(10)
v_mfma_f32_32x32x16_bf16 v[16:31], a[64:67], a[160:163], v[16:31]
v_mfma_f32_32x32x16_bf16 v[32:47], a[68:71], a[160:163], v[32:47]
buffer_load_dwordx4 a[204:207], v1, s[84:87], s6 offen offset:3072 sc1
s_waitcnt vmcnt(10)
v_mfma_f32_32x32x16_bf16 v[16:31], a[72:75], a[164:167], v[16:31]
v_mfma_f32_32x32x16_bf16 v[32:47], a[76:79], a[164:167], v[32:47]
s_add_u32 s6, s6, 4096
buffer_load_dwordx4 a[208:211], v1, s[84:87], s6 offen offset:0 sc1
s_waitcnt vmcnt(10)
v_mfma_f32_32x32x16_bf16 v[16:31], a[80:83], a[168:171], v[16:31]
v_mfma_f32_32x32x16_bf16 v[32:47], a[84:87], a[168:171], v[32:47]
buffer_load_dwordx4 a[212:215], v1, s[84:87], s6 offen offset:1024 sc1
s_waitcnt vmcnt(10)
v_mfma_f32_32x32x16_bf16 v[16:31], a[88:91], a[172:175], v[16:31]
v_mfma_f32_32x32x16_bf16 v[32:47], a[92:95], a[172:175], v[32:47]
buffer_load_dwordx4 a[216:219], v1, s[84:87], s6 offen offset:2048 sc1
s_waitcnt vmcnt(10)
v_mfma_f32_32x32x16_bf16 v[16:31], a[96:99], a[176:179], v[16:31]
v_mfma_f32_32x32x16_bf16 v[32:47], a[100:103], a[176:179], v[32:47]
buffer_load_dwordx4 a[220:223], v1, s[84:87], s6 offen offset:3072 sc1
s_waitcnt vmcnt(10)
v_mfma_f32_32x32x16_bf16 v[16:31], a[104:107], a[180:183], v[16:31]
v_mfma_f32_32x32x16_bf16 v[32:47], a[108:111], a[180:183], v[32:47]
s_add_u32 s6, s6, 4096
buffer_load_dwordx4 a[224:227], v1, s[84:87], s6 offen offset:0 sc1
s_waitcnt vmcnt(10)
v_mfma_f32_32x32x16_bf16 v[16:31], a[112:115], a[184:187], v[16:31]
v_mfma_f32_32x32x16_bf16 v[32:47], a[116:119], a[184:187], v[32:47]
buffer_load_dwordx4 a[228:231], v1, s[84:87], s6 offen offset:1024 sc1
s_waitcnt vmcnt(10)
v_mfma_f32_32x32x16_bf16 v[16:31], a[120:123], a[188:191], v[16:31]
v_mfma_f32_32x32x16_bf16 v[32:47], a[124:127], a[188:191], v[32:47]
buffer_load_dwordx4 a[232:235], v1, s[84:87], s6 offen offset:2048 sc1
ds_read_b64_tr_b16 v[48:49], v9 offset:4096
ds_read_b64_tr_b16 v[50:51], v9 offset:5120
ds_read_b64_tr_b16 v[52:53], v10 offset:4096
ds_read_b64_tr_b16 v[54:55], v10 offset:5120
s_waitcnt vmcnt(10)
s_waitcnt lgkmcnt(8)
v_mfma_f32_32x32x16_bf16 v[16:31], v[56:59], a[192:195], v[16:31]
v_mfma_f32_32x32x16_bf16 v[32:47], v[60:63], a[192:195], v[32:47]
buffer_load_dwordx4 a[236:239], v1, s[84:87], s6 offen offset:3072 sc1
ds_read_b64_tr_b16 v[56:57], v9 offset:6144
ds_read_b64_tr_b16 v[58:59], v9 offset:7168
ds_read_b64_tr_b16 v[60:61], v10 offset:6144
ds_read_b64_tr_b16 v[62:63], v10 offset:7168
s_waitcnt vmcnt(10)
s_waitcnt lgkmcnt(8)
v_mfma_f32_32x32x16_bf16 v[16:31], v[64:67], a[196:199], v[16:31]
v_mfma_f32_32x32x16_bf16 v[32:47], v[68:71], a[196:199], v[32:47]
s_add_u32 s6, s6, 4096
buffer_load_dwordx4 a[240:243], v1, s[84:87], s6 offen offset:0 sc1
ds_read_b64_tr_b16 v[64:65], v9 offset:8192
ds_read_b64_tr_b16 v[66:67], v9 offset:9216
ds_read_b64_tr_b16 v[68:69], v10 offset:8192
ds_read_b64_tr_b16 v[70:71], v10 offset:9216
s_waitcnt vmcnt(10)
s_waitcnt lgkmcnt(8)
v_mfma_f32_32x32x16_bf16 v[16:31], v[48:51], a[200:203], v[16:31]
v_mfma_f32_32x32x16_bf16 v[32:47], v[52:55], a[200:203], v[32:47]
buffer_load_dwordx4 a[244:247], v1, s[84:87], s6 offen offset:1024 sc1
ds_read_b64_tr_b16 v[48:49], v9 offset:10240
ds_read_b64_tr_b16 v[50:51], v9 offset:11264
ds_read_b64_tr_b16 v[52:53], v10 offset:10240
ds_read_b64_tr_b16 v[54:55], v10 offset:11264
s_waitcnt vmcnt(10)
s_waitcnt lgkmcnt(8)
v_mfma_f32_32x32x16_bf16 v[16:31], v[56:59], a[204:207], v[16:31]
v_mfma_f32_32x32x16_bf16 v[32:47], v[60:63], a[204:207], v[32:47]
buffer_load_dwordx4 a[248:251], v1, s[84:87], s6 offen offset:2048 sc1
ds_read_b64_tr_b16 v[56:57], v9 offset:12288
ds_read_b64_tr_b16 v[58:59], v9 offset:13312
ds_read_b64_tr_b16 v[60:61], v10 offset:12288
ds_read_b64_tr_b16 v[62:63], v10 offset:13312
s_waitcnt vmcnt(10)
s_waitcnt lgkmcnt(8)
v_mfma_f32_32x32x16_bf16 v[16:31], v[64:67], a[208:211], v[16:31]
v_mfma_f32_32x32x16_bf16 v[32:47], v[68:71], a[208:211], v[32:47]
buffer_load_dwordx4 a[252:255], v1, s[84:87], s6 offen offset:3072 sc1
ds_read_b64_tr_b16 v[64:65], v9 offset:14336
ds_read_b64_tr_b16 v[66:67], v9 offset:15360
ds_read_b64_tr_b16 v[68:69], v10 offset:14336
ds_read_b64_tr_b16 v[70:71], v10 offset:15360
s_waitcnt vmcnt(10)
s_waitcnt lgkmcnt(8)
v_mfma_f32_32x32x16_bf16 v[16:31], v[48:51], a[212:215], v[16:31]
v_mfma_f32_32x32x16_bf16 v[32:47], v[52:55], a[212:215], v[32:47]
s_add_u32 s6, s6, 4096
buffer_load_dwordx4 a[128:131], v1, s[84:87], s6 offen offset:0 sc1
ds_read_b64_tr_b16 v[48:49], v9 offset:16384
ds_read_b64_tr_b16 v[50:51], v9 offset:17408
ds_read_b64_tr_b16 v[52:53], v10 offset:16384
ds_read_b64_tr_b16 v[54:55], v10 offset:17408
s_waitcnt vmcnt(10)
s_waitcnt lgkmcnt(8)
v_mfma_f32_32x32x16_bf16 v[16:31], v[56:59], a[216:219], v[16:31]
v_mfma_f32_32x32x16_bf16 v[32:47], v[60:63], a[216:219], v[32:47]
buffer_load_dwordx4 a[132:135], v1, s[84:87], s6 offen offset:1024 sc1
ds_read_b64_tr_b16 v[56:57], v9 offset:18432
ds_read_b64_tr_b16 v[58:59], v9 offset:19456
ds_read_b64_tr_b16 v[60:61], v10 offset:18432
ds_read_b64_tr_b16 v[62:63], v10 offset:19456
s_waitcnt vmcnt(10)
s_waitcnt lgkmcnt(8)
v_mfma_f32_32x32x16_bf16 v[16:31], v[64:67], a[220:223], v[16:31]
v_mfma_f32_32x32x16_bf16 v[32:47], v[68:71], a[220:223], v[32:47]
buffer_load_dwordx4 a[136:139], v1, s[84:87], s6 offen offset:2048 sc1
ds_read_b64_tr_b16 v[64:65], v9 offset:20480
ds_read_b64_tr_b16 v[66:67], v9 offset:21504
ds_read_b64_tr_b16 v[68:69], v10 offset:20480
ds_read_b64_tr_b16 v[70:71], v10 offset:21504
s_waitcnt vmcnt(10)
s_waitcnt lgkmcnt(8)
v_mfma_f32_32x32x16_bf16 v[16:31], v[48:51], a[224:227], v[16:31]
v_mfma_f32_32x32x16_bf16 v[32:47], v[52:55], a[224:227], v[32:47]
buffer_load_dwordx4 a[140:143], v1, s[84:87], s6 offen offset:3072 sc1
ds_read_b64_tr_b16 v[48:49], v9 offset:22528
ds_read_b64_tr_b16 v[50:51], v9 offset:23552
ds_read_b64_tr_b16 v[52:53], v10 offset:22528
ds_read_b64_tr_b16 v[54:55], v10 offset:23552
s_waitcnt vmcnt(10)
s_waitcnt lgkmcnt(8)
v_mfma_f32_32x32x16_bf16 v[16:31], v[56:59], a[228:231], v[16:31]
v_mfma_f32_32x32x16_bf16 v[32:47], v[60:63], a[228:231], v[32:47]
s_add_u32 s6, s6, 4096
buffer_load_dwordx4 a[144:147], v1, s[84:87], s6 offen offset:0 sc1
ds_read_b64_tr_b16 v[56:57], v9 offset:24576
ds_read_b64_tr_b16 v[58:59], v9 offset:25600
ds_read_b64_tr_b16 v[60:61], v10 offset:24576
ds_read_b64_tr_b16 v[62:63], v10 offset:25600
s_waitcnt vmcnt(10)
s_waitcnt lgkmcnt(8)
v_mfma_f32_32x32x16_bf16 v[16:31], v[64:67], a[232:235], v[16:31]
v_mfma_f32_32x32x16_bf16 v[32:47], v[68:71], a[232:235], v[32:47]
buffer_load_dwordx4 a[148:151], v1, s[84:87], s6 offen offset:1024 sc1
ds_read_b64_tr_b16 v[64:65], v9 offset:26624
ds_read_b64_tr_b16 v[66:67], v9 offset:27648
ds_read_b64_tr_b16 v[68:69], v10 offset:26624
ds_read_b64_tr_b16 v[70:71], v10 offset:27648
s_waitcnt vmcnt(10)
s_waitcnt lgkmcnt(8)
v_mfma_f32_32x32x16_bf16 v[16:31], v[48:51], a[236:239], v[16:31]
v_mfma_f32_32x32x16_bf16 v[32:47], v[52:55], a[236:239], v[32:47]
buffer_load_dwordx4 a[152:155], v1, s[84:87], s6 offen offset:2048 sc1
ds_read_b64_tr_b16 v[48:49], v9 offset:28672
ds_read_b64_tr_b16 v[50:51], v9 offset:29696
ds_read_b64_tr_b16 v[52:53], v10 offset:28672
ds_read_b64_tr_b16 v[54:55], v10 offset:29696
s_waitcnt vmcnt(10)
s_waitcnt lgkmcnt(8)
v_mfma_f32_32x32x16_bf16 v[16:31], v[56:59], a[240:243], v[16:31]
v_mfma_f32_32x32x16_bf16 v[32:47], v[60:63], a[240:243], v[32:47]
buffer_load_dwordx4 a[156:159], v1, s[84:87], s6 offen offset:3072 sc1
ds_read_b64_tr_b16 v[56:57], v9 offset:30720
ds_read_b64_tr_b16 v[58:59], v9 offset:31744
ds_read_b64_tr_b16 v[60:61], v10 offset:30720
ds_read_b64_tr_b16 v[62:63], v10 offset:31744
s_waitcnt vmcnt(10)
s_waitcnt lgkmcnt(8)
v_mfma_f32_32x32x16_bf16 v[16:31], v[64:67], a[244:247], v[16:31]
v_mfma_f32_32x32x16_bf16 v[32:47], v[68:71], a[244:247], v[32:47]
s_add_u32 s6, s6, 4096
buffer_load_dwordx4 a[160:163], v1, s[84:87], s6 offen offset:0 sc1
ds_read_b64_tr_b16 v[64:65], v8 offset:0
ds_read_b64_tr_b16 v[66:67], v8 offset:1024
ds_read_b64_tr_b16 v[68:69], v7 offset:0
ds_read_b64_tr_b16 v[70:71], v7 offset:1024
s_waitcnt vmcnt(10)
s_waitcnt lgkmcnt(8)
v_mfma_f32_32x32x16_bf16 v[16:31], v[48:51], a[248:251], v[16:31]
v_mfma_f32_32x32x16_bf16 v[32:47], v[52:55], a[248:251], v[32:47]
buffer_load_dwordx4 a[164:167], v1, s[84:87], s6 offen offset:1024 sc1
ds_read_b64_tr_b16 v[48:49], v8 offset:2048
ds_read_b64_tr_b16 v[50:51], v8 offset:3072
ds_read_b64_tr_b16 v[52:53], v7 offset:2048
ds_read_b64_tr_b16 v[54:55], v7 offset:3072
s_waitcnt vmcnt(10)
s_waitcnt lgkmcnt(8)
v_mfma_f32_32x32x16_bf16 v[16:31], v[56:59], a[252:255], v[16:31]
v_mfma_f32_32x32x16_bf16 v[32:47], v[60:63], a[252:255], v[32:47]
buffer_load_dwordx4 a[168:171], v1, s[84:87], s6 offen offset:2048 sc1
ds_read_b64_tr_b16 v[56:57], v8 offset:4096
ds_read_b64_tr_b16 v[58:59], v8 offset:5120
ds_read_b64_tr_b16 v[60:61], v7 offset:4096
ds_read_b64_tr_b16 v[62:63], v7 offset:5120
s_waitcnt vmcnt(10)
s_waitcnt lgkmcnt(8)
v_mfma_f32_32x32x16_bf16 v[16:31], v[64:67], a[128:131], v[16:31]
v_mfma_f32_32x32x16_bf16 v[32:47], v[68:71], a[128:131], v[32:47]
ds_read_b64_tr_b16 v[64:65], v8 offset:6144
ds_read_b64_tr_b16 v[66:67], v8 offset:7168
ds_read_b64_tr_b16 v[68:69], v7 offset:6144
ds_read_b64_tr_b16 v[70:71], v7 offset:7168
s_waitcnt vmcnt(9)
s_waitcnt lgkmcnt(8)
v_mfma_f32_32x32x16_bf16 v[16:31], v[48:51], a[132:135], v[16:31]
v_mfma_f32_32x32x16_bf16 v[32:47], v[52:55], a[132:135], v[32:47]
ds_read_b64_tr_b16 v[48:49], v8 offset:8192
ds_read_b64_tr_b16 v[50:51], v8 offset:9216
ds_read_b64_tr_b16 v[52:53], v7 offset:8192
ds_read_b64_tr_b16 v[54:55], v7 offset:9216
s_waitcnt vmcnt(8)
s_waitcnt lgkmcnt(8)
v_mfma_f32_32x32x16_bf16 v[16:31], v[56:59], a[136:139], v[16:31]
v_mfma_f32_32x32x16_bf16 v[32:47], v[60:63], a[136:139], v[32:47]
ds_read_b64_tr_b16 v[56:57], v8 offset:10240
ds_read_b64_tr_b16 v[58:59], v8 offset:11264
ds_read_b64_tr_b16 v[60:61], v7 offset:10240
ds_read_b64_tr_b16 v[62:63], v7 offset:11264
s_waitcnt vmcnt(7)
s_waitcnt lgkmcnt(8)
v_mfma_f32_32x32x16_bf16 v[16:31], v[64:67], a[140:143], v[16:31]
v_mfma_f32_32x32x16_bf16 v[32:47], v[68:71], a[140:143], v[32:47]
ds_read_b64_tr_b16 v[64:65], v8 offset:12288
ds_read_b64_tr_b16 v[66:67], v8 offset:13312
ds_read_b64_tr_b16 v[68:69], v7 offset:12288
ds_read_b64_tr_b16 v[70:71], v7 offset:13312
s_waitcnt vmcnt(6)
s_waitcnt lgkmcnt(8)
v_mfma_f32_32x32x16_bf16 v[16:31], v[48:51], a[144:147], v[16:31]
v_mfma_f32_32x32x16_bf16 v[32:47], v[52:55], a[144:147], v[32:47]
ds_read_b64_tr_b16 v[48:49], v8 offset:14336
ds_read_b64_tr_b16 v[50:51], v8 offset:15360
ds_read_b64_tr_b16 v[52:53], v7 offset:14336
ds_read_b64_tr_b16 v[54:55], v7 offset:15360
s_waitcnt vmcnt(5)
s_waitcnt lgkmcnt(8)
v_mfma_f32_32x32x16_bf16 v[16:31], v[56:59], a[148:151], v[16:31]
v_mfma_f32_32x32x16_bf16 v[32:47], v[60:63], a[148:151], v[32:47]
ds_read_b64_tr_b16 v[56:57], v8 offset:16384
ds_read_b64_tr_b16 v[58:59], v8 offset:17408
ds_read_b64_tr_b16 v[60:61], v7 offset:16384
ds_read_b64_tr_b16 v[62:63], v7 offset:17408
s_waitcnt vmcnt(4)
s_waitcnt lgkmcnt(8)
v_mfma_f32_32x32x16_bf16 v[16:31], v[64:67], a[152:155], v[16:31]
v_mfma_f32_32x32x16_bf16 v[32:47], v[68:71], a[152:155], v[32:47]
ds_read_b64_tr_b16 v[64:65], v8 offset:18432
ds_read_b64_tr_b16 v[66:67], v8 offset:19456
ds_read_b64_tr_b16 v[68:69], v7 offset:18432
ds_read_b64_tr_b16 v[70:71], v7 offset:19456
s_waitcnt vmcnt(3)
s_waitcnt lgkmcnt(8)
v_mfma_f32_32x32x16_bf16 v[16:31], v[48:51], a[156:159], v[16:31]
v_mfma_f32_32x32x16_bf16 v[32:47], v[52:55], a[156:159], v[32:47]
ds_read_b64_tr_b16 v[48:49], v8 offset:20480
ds_read_b64_tr_b16 v[50:51], v8 offset:21504
ds_read_b64_tr_b16 v[52:53], v7 offset:20480
ds_read_b64_tr_b16 v[54:55], v7 offset:21504
s_waitcnt vmcnt(2)
s_waitcnt lgkmcnt(8)
v_mfma_f32_32x32x16_bf16 v[16:31], v[56:59], a[160:163], v[16:31]
v_mfma_f32_32x32x16_bf16 v[32:47], v[60:63], a[160:163], v[32:47]
s_waitcnt vmcnt(1)
s_waitcnt lgkmcnt(4)
v_mfma_f32_32x32x16_bf16 v[16:31], v[64:67], a[164:167], v[16:31]
v_mfma_f32_32x32x16_bf16 v[32:47], v[68:71], a[164:167], v[32:47]
s_waitcnt vmcnt(0)
s_waitcnt lgkmcnt(0)
v_mfma_f32_32x32x16_bf16 v[16:31], v[48:51], a[168:171], v[16:31]
v_mfma_f32_32x32x16_bf16 v[32:47], v[52:55], a[168:171], v[32:47]
s_nop 7
s_nop 3
s_cmp_eq_u32 s93, 0
s_cbranch_scc1 x_147
v_swap_b32 v16, v32
v_swap_b32 v17, v33
v_swap_b32 v18, v34
v_swap_b32 v19, v35
v_swap_b32 v20, v36
v_swap_b32 v21, v37
v_swap_b32 v22, v38
v_swap_b32 v23, v39
v_swap_b32 v24, v40
v_swap_b32 v25, v41
v_swap_b32 v26, v42
v_swap_b32 v27, v43
v_swap_b32 v28, v44
v_swap_b32 v29, v45
v_swap_b32 v30, v46
v_swap_b32 v31, v47
x_147:
s_lshl_b32 s4, s43, 12
s_add_u32 s4, s4, 131072
v_add_u32 v14, s4, v1
s_xor_b32 s4, s4, 0x2000
v_add_u32 v15, s4, v1
ds_write_b128 v14, v[32:35] offset:0
ds_write_b128 v14, v[36:39] offset:1024
ds_write_b128 v14, v[40:43] offset:2048
ds_write_b128 v14, v[44:47] offset:3072
s_waitcnt lgkmcnt(0)
s_barrier
ds_read_b128 v[32:35], v15 offset:0
ds_read_b128 v[36:39], v15 offset:1024
ds_read_b128 v[40:43], v15 offset:2048
ds_read_b128 v[44:47], v15 offset:3072
s_and_b32 s4, s3, 7
s_lshl_b32 s4, s4, 1
s_add_u32 s4, s4, s93
s_lshl_b32 s4, s4, 7
s_add_u32 s4, s4, 151552
v_lshlrev_b32 v14, 4, v5
v_add_u32 v9, s4, v14
ds_read_b128 v[48:51], v9 offset:0
ds_read_b128 v[52:55], v9 offset:32
ds_read_b128 v[56:59], v9 offset:64
ds_read_b128 v[60:63], v9 offset:96
s_waitcnt lgkmcnt(0)
v_add_f32 v16, v16, v32
v_fmac_f32 v232, v16, v48
v_add_f32 v17, v17, v33
v_fmac_f32 v233, v17, v49
v_add_f32 v18, v18, v34
v_fmac_f32 v234, v18, v50
v_add_f32 v19, v19, v35
v_fmac_f32 v235, v19, v51
v_add_f32 v20, v20, v36
v_fmac_f32 v236, v20, v52
v_add_f32 v21, v21, v37
v_fmac_f32 v237, v21, v53
v_add_f32 v22, v22, v38
v_fmac_f32 v238, v22, v54
v_add_f32 v23, v23, v39
v_fmac_f32 v239, v23, v55
v_add_f32 v24, v24, v40
v_fmac_f32 v240, v24, v56
v_add_f32 v25, v25, v41
v_fmac_f32 v241, v25, v57
v_add_f32 v26, v26, v42
v_fmac_f32 v242, v26, v58
v_add_f32 v27, v27, v43
v_fmac_f32 v243, v27, v59
v_add_f32 v28, v28, v44
v_fmac_f32 v244, v28, v60
v_add_f32 v29, v29, v45
v_fmac_f32 v245, v29, v61
v_add_f32 v30, v30, v46
v_fmac_f32 v246, v30, v62
v_add_f32 v31, v31, v47
v_fmac_f32 v247, v31, v63
v_cvt_pk_bf16_f32 v16, v232, v233
v_cvt_pk_bf16_f32 v17, v234, v235
v_cvt_pk_bf16_f32 v18, v236, v237
v_cvt_pk_bf16_f32 v19, v238, v239
v_cvt_pk_bf16_f32 v20, v240, v241
v_cvt_pk_bf16_f32 v21, v242, v243
v_cvt_pk_bf16_f32 v22, v244, v245
v_cvt_pk_bf16_f32 v23, v246, v247
v_permlane32_swap_b32 v16, v18
v_permlane32_swap_b32 v17, v19
v_permlane32_swap_b32 v20, v22
v_permlane32_swap_b32 v21, v23
v_lshl_add_u32 v11, v5, 3, v11
buffer_store_dwordx4 v[16:19], v11, s[80:83], s100 offen offset:0 sc1
buffer_store_dwordx4 v[20:23], v11, s[80:83], s100 offen offset:32 sc1
s_cmp_lg_u32 s2, 0
s_cbranch_scc1 L_ne
v_mov_b32 v14, s40
v_mov_b32 v15, 0
s_mov_b64 exec, 1
buffer_store_dword v14, v15, s[84:87], 0 offen sc1
s_mov_b64 exec, -1
L_ne:
L_end:
s_endpgm
.section .rodata,"a"
.p2align 6
.amdhsa_kernel adaLN_cond__sliding_block__glu_gated_glu__prompt_kernel
  .amdhsa_next_free_vgpr 512
  .amdhsa_next_free_sgpr 102
  .amdhsa_accum_offset 256
  .amdhsa_group_segment_fixed_size 0
  .amdhsa_kernarg_size 96
  .amdhsa_user_sgpr_count 2
  .amdhsa_user_sgpr_kernarg_segment_ptr 1
  .amdhsa_system_sgpr_workgroup_id_x 1
.end_amdhsa_kernel
```
